```python
import torch

def _softmax(x, axis=-1):
    return torch.softmax(x, dim=axis)

def _gelu(x):
    return torch.nn.functional.gelu(x, approximate='tanh')

def _silu(x):
    return torch.nn.functional.silu(x)

def _sigmoid(x):
    return torch.sigmoid(x)

def _layernorm(x, axis=-1, eps=1e-05):
    m = x.mean(dim=axis, keepdim=True)
    v = x.var(dim=axis, keepdim=True, unbiased=False)
    return (x - m) / torch.sqrt(v + eps)

def _scatter_add(tgt, idx, src, axis=0):
    return tgt.clone().index_add_(axis, idx, src)

def _segment_sum(src, seg, n):
    out = torch.zeros((n,) + src.shape[1:], dtype=src.dtype)
    return out.index_add_(0, seg, src)

def _pad(x, pw):
    flat = tuple((v for pair in reversed(pw) for v in pair))
    return torch.nn.functional.pad(x, flat)
kernel_name = 'adaLN_cond__spectral_gfnet__dense_activation_silu__prompt'

def setup_inputs():

    _w = lambda a: (lambda t: t.to(torch.bfloat16) if t.is_floating_point() else t)(torch.as_tensor(a))

    def _A_setup():
        B, S, D = (1, 2048, 576)
        Df = D // 2 + 1
        return {'x': _w((lambda *s: torch.randn(*s, dtype=torch.bfloat16) * 0.05)(B, S, D)), 'w_r': _w((lambda *s: torch.randn(*s, dtype=torch.bfloat16) * 1.6)(S, Df) * 0.02), 'w_i': _w((lambda *s: torch.randn(*s, dtype=torch.bfloat16) * 1.6)(S, Df) * 0.02)}
    _A_in = _A_setup()

    def _B_setup():
        B, S, D, F = (1, 2048, 576, 4608)
        return {'x': _w((lambda *s: torch.randn(*s, dtype=torch.bfloat16) * 0.05)(B, S, D)), 'w1': _w((lambda *s: torch.randn(*s, dtype=torch.bfloat16) * 0.8)(D, F) * D ** (-0.5)), 'w2': _w((lambda *s: torch.randn(*s, dtype=torch.bfloat16) * 0.2)(F, D) * F ** (-0.5))}
    _B_in = _B_setup()
    return {'A_x': _A_in['x'], 'A_w_r': _A_in['w_r'], 'A_w_i': _A_in['w_i'], 'B_x': _B_in['x'], 'B_w1': _B_in['w1'], 'B_w2': _B_in['w2'], 'c': _w((lambda *s: torch.randn(*s, dtype=torch.bfloat16) * 0.2)(1, 576) * 8.0), 'w_mod': _w((lambda *s: torch.randn(*s, dtype=torch.bfloat16) * 0.2)(576, 6 * 576) * 576 ** (-0.5) * 8.0)}

def reference(A_x, A_w_r, A_w_i, B_x, B_w1, B_w2, c, w_mod):

    def _A_ref(x, w_r, w_i):
        B, S, D = x.shape
        X = (lambda x, axes=(-2, -1): torch.fft.rfft2(x.float(), dim=axes))(x, axes=(-2, -1))
        W = w_r + 1j * w_i
        X = X * W
        y = (lambda x, s, axes=(-2, -1): torch.fft.irfft2(x, s=s, dim=axes).to(torch.bfloat16))(X, (S, D), axes=(-2, -1))
        return y

    def _B_ref(x, w1, w2):
        h = torch.einsum('bsd,df->bsf', x, w1)
        h = _silu(h)
        out = torch.einsum('bsf,fd->bsd', h, w2)
        return out
    x = A_x
    mod = (_silu(c) @ w_mod).reshape(c.shape[0], 6, 1, -1)
    sa, ca, ga, sb, cb, gb = (mod[:, 0].clone(), mod[:, 1].clone(), mod[:, 2].clone(), mod[:, 3].clone(), mod[:, 4].clone(), mod[:, 5].clone())
    h = _layernorm(x, axis=-1) * (1 + ca) + sa
    x = x + ga * _A_ref(h, A_w_r, A_w_i)
    h = _layernorm(x, axis=-1) * (1 + cb) + sb
    x = x + gb * _B_ref(h, B_w1, B_w2)
    return x
```

```asm
; @launch kernel=k1_prep_kernel grid=(268,1,1) block=(256,1,1) lds=16896
; @launch kernel=k2_rowfft_kernel grid=(256,1,1) block=(256,1,1) lds=36864
; @launch kernel=k3_colfft_kernel grid=(289,1,1) block=(256,1,1) lds=32768
; @launch kernel=k4_rowifft_kernel grid=(256,1,1) block=(256,1,1) lds=36864
; @launch kernel=k5_gemm1_kernel grid=(256,1,1) block=(256,1,1) lds=159744
; @launch kernel=k6_gemm2_kernel grid=(256,1,1) block=(256,1,1) lds=139264
; @launch kernel=k7_final_kernel grid=(576,1,1) block=(256,1,1) lds=0
.amdgcn_target "amdgcn-amd-amdhsa--gfx950"
.text
.globl k1_prep_kernel
.p2align 8
.type k1_prep_kernel,@function
k1_prep_kernel:
    s_cmp_ge_u32 s2, 268
    s_cbranch_scc1 Lk1_end
    s_load_dwordx2 s[4:5], s[0:1], 48
    s_load_dwordx2 s[6:7], s[0:1], 56
    s_load_dwordx2 s[12:13], s[0:1], 80
    s_load_dwordx4 s[16:19], s[0:1], 8
    s_waitcnt lgkmcnt(0)
    s_cmp_ge_u32 s2, 108
    s_cbranch_scc1 Lk1_tr
    s_mov_b32 s8, s6
    s_and_b32 s9, s7, 0xffff
    s_mov_b32 s10, 3981312
    s_mov_b32 s11, 0x00020000
    v_and_b32 v1, 3, v0
    v_lshrrev_b32 v2, 2, v0
    s_movk_i32 s14, 6912
    v_mul_lo_u32 v3, v2, s14
    v_lshl_add_u32 v3, v1, 4, v3
    s_lshl_b32 s15, s2, 6
    v_add_u32 v3, s15, v3
    v_lshlrev_b32 v4, 1, v2
    global_load_ushort v10, v4, s[4:5] offset:0
    global_load_ushort v11, v4, s[4:5] offset:128
    global_load_ushort v12, v4, s[4:5] offset:256
    global_load_ushort v13, v4, s[4:5] offset:384
    global_load_ushort v14, v4, s[4:5] offset:512
    global_load_ushort v15, v4, s[4:5] offset:640
    global_load_ushort v16, v4, s[4:5] offset:768
    global_load_ushort v17, v4, s[4:5] offset:896
    global_load_ushort v18, v4, s[4:5] offset:1024
    s_mov_b32 s20, 0
    buffer_load_dwordx4 v[20:23], v3, s[8:11], s20 offen
    s_mov_b32 s20, 442368
    buffer_load_dwordx4 v[24:27], v3, s[8:11], s20 offen
    s_mov_b32 s20, 884736
    buffer_load_dwordx4 v[28:31], v3, s[8:11], s20 offen
    s_mov_b32 s20, 1327104
    buffer_load_dwordx4 v[32:35], v3, s[8:11], s20 offen
    s_mov_b32 s20, 1769472
    buffer_load_dwordx4 v[36:39], v3, s[8:11], s20 offen
    s_mov_b32 s20, 2211840
    buffer_load_dwordx4 v[40:43], v3, s[8:11], s20 offen
    s_mov_b32 s20, 2654208
    buffer_load_dwordx4 v[44:47], v3, s[8:11], s20 offen
    s_mov_b32 s20, 3096576
    buffer_load_dwordx4 v[48:51], v3, s[8:11], s20 offen
    s_mov_b32 s20, 3538944
    buffer_load_dwordx4 v[52:55], v3, s[8:11], s20 offen
    s_waitcnt vmcnt(9)
    v_lshlrev_b32 v10, 16, v10
    v_mul_f32 v60, 0xbfb8aa3b, v10
    v_exp_f32 v60, v60
    s_nop 0
    v_add_f32 v60, 1.0, v60
    v_rcp_f32 v60, v60
    s_nop 0
    v_mul_f32 v10, v10, v60
    v_lshlrev_b32 v11, 16, v11
    v_mul_f32 v60, 0xbfb8aa3b, v11
    v_exp_f32 v60, v60
    s_nop 0
    v_add_f32 v60, 1.0, v60
    v_rcp_f32 v60, v60
    s_nop 0
    v_mul_f32 v11, v11, v60
    v_lshlrev_b32 v12, 16, v12
    v_mul_f32 v60, 0xbfb8aa3b, v12
    v_exp_f32 v60, v60
    s_nop 0
    v_add_f32 v60, 1.0, v60
    v_rcp_f32 v60, v60
    s_nop 0
    v_mul_f32 v12, v12, v60
    v_lshlrev_b32 v13, 16, v13
    v_mul_f32 v60, 0xbfb8aa3b, v13
    v_exp_f32 v60, v60
    s_nop 0
    v_add_f32 v60, 1.0, v60
    v_rcp_f32 v60, v60
    s_nop 0
    v_mul_f32 v13, v13, v60
    v_lshlrev_b32 v14, 16, v14
    v_mul_f32 v60, 0xbfb8aa3b, v14
    v_exp_f32 v60, v60
    s_nop 0
    v_add_f32 v60, 1.0, v60
    v_rcp_f32 v60, v60
    s_nop 0
    v_mul_f32 v14, v14, v60
    v_lshlrev_b32 v15, 16, v15
    v_mul_f32 v60, 0xbfb8aa3b, v15
    v_exp_f32 v60, v60
    s_nop 0
    v_add_f32 v60, 1.0, v60
    v_rcp_f32 v60, v60
    s_nop 0
    v_mul_f32 v15, v15, v60
    v_lshlrev_b32 v16, 16, v16
    v_mul_f32 v60, 0xbfb8aa3b, v16
    v_exp_f32 v60, v60
    s_nop 0
    v_add_f32 v60, 1.0, v60
    v_rcp_f32 v60, v60
    s_nop 0
    v_mul_f32 v16, v16, v60
    v_lshlrev_b32 v17, 16, v17
    v_mul_f32 v60, 0xbfb8aa3b, v17
    v_exp_f32 v60, v60
    s_nop 0
    v_add_f32 v60, 1.0, v60
    v_rcp_f32 v60, v60
    s_nop 0
    v_mul_f32 v17, v17, v60
    v_lshlrev_b32 v18, 16, v18
    v_mul_f32 v60, 0xbfb8aa3b, v18
    v_exp_f32 v60, v60
    s_nop 0
    v_add_f32 v60, 1.0, v60
    v_rcp_f32 v60, v60
    s_nop 0
    v_mul_f32 v18, v18, v60
    v_cvt_pk_bf16_f32 v60, v10, v11
    v_lshlrev_b32 v10, 16, v60
    v_and_b32 v11, 0xffff0000, v60
    v_cvt_pk_bf16_f32 v60, v12, v13
    v_lshlrev_b32 v12, 16, v60
    v_and_b32 v13, 0xffff0000, v60
    v_cvt_pk_bf16_f32 v60, v14, v15
    v_lshlrev_b32 v14, 16, v60
    v_and_b32 v15, 0xffff0000, v60
    v_cvt_pk_bf16_f32 v60, v16, v17
    v_lshlrev_b32 v16, 16, v60
    v_and_b32 v17, 0xffff0000, v60
    v_cvt_pk_bf16_f32 v60, v18, v18
    v_lshlrev_b32 v18, 16, v60
    v_mov_b32 v62, 0
    v_mov_b32 v63, 0
    v_mov_b32 v64, 0
    v_mov_b32 v65, 0
    v_mov_b32 v66, 0
    v_mov_b32 v67, 0
    v_mov_b32 v68, 0
    v_mov_b32 v69, 0
    s_waitcnt vmcnt(8)
    v_lshlrev_b32 v60, 16, v20
    v_and_b32 v61, 0xffff0000, v20
    v_fmac_f32 v62, v10, v60
    v_fmac_f32 v63, v10, v61
    v_lshlrev_b32 v60, 16, v21
    v_and_b32 v61, 0xffff0000, v21
    v_fmac_f32 v64, v10, v60
    v_fmac_f32 v65, v10, v61
    v_lshlrev_b32 v60, 16, v22
    v_and_b32 v61, 0xffff0000, v22
    v_fmac_f32 v66, v10, v60
    v_fmac_f32 v67, v10, v61
    v_lshlrev_b32 v60, 16, v23
    v_and_b32 v61, 0xffff0000, v23
    v_fmac_f32 v68, v10, v60
    v_fmac_f32 v69, v10, v61
    s_waitcnt vmcnt(7)
    v_lshlrev_b32 v60, 16, v24
    v_and_b32 v61, 0xffff0000, v24
    v_fmac_f32 v62, v11, v60
    v_fmac_f32 v63, v11, v61
    v_lshlrev_b32 v60, 16, v25
    v_and_b32 v61, 0xffff0000, v25
    v_fmac_f32 v64, v11, v60
    v_fmac_f32 v65, v11, v61
    v_lshlrev_b32 v60, 16, v26
    v_and_b32 v61, 0xffff0000, v26
    v_fmac_f32 v66, v11, v60
    v_fmac_f32 v67, v11, v61
    v_lshlrev_b32 v60, 16, v27
    v_and_b32 v61, 0xffff0000, v27
    v_fmac_f32 v68, v11, v60
    v_fmac_f32 v69, v11, v61
    s_waitcnt vmcnt(6)
    v_lshlrev_b32 v60, 16, v28
    v_and_b32 v61, 0xffff0000, v28
    v_fmac_f32 v62, v12, v60
    v_fmac_f32 v63, v12, v61
    v_lshlrev_b32 v60, 16, v29
    v_and_b32 v61, 0xffff0000, v29
    v_fmac_f32 v64, v12, v60
    v_fmac_f32 v65, v12, v61
    v_lshlrev_b32 v60, 16, v30
    v_and_b32 v61, 0xffff0000, v30
    v_fmac_f32 v66, v12, v60
    v_fmac_f32 v67, v12, v61
    v_lshlrev_b32 v60, 16, v31
    v_and_b32 v61, 0xffff0000, v31
    v_fmac_f32 v68, v12, v60
    v_fmac_f32 v69, v12, v61
    s_waitcnt vmcnt(5)
    v_lshlrev_b32 v60, 16, v32
    v_and_b32 v61, 0xffff0000, v32
    v_fmac_f32 v62, v13, v60
    v_fmac_f32 v63, v13, v61
    v_lshlrev_b32 v60, 16, v33
    v_and_b32 v61, 0xffff0000, v33
    v_fmac_f32 v64, v13, v60
    v_fmac_f32 v65, v13, v61
    v_lshlrev_b32 v60, 16, v34
    v_and_b32 v61, 0xffff0000, v34
    v_fmac_f32 v66, v13, v60
    v_fmac_f32 v67, v13, v61
    v_lshlrev_b32 v60, 16, v35
    v_and_b32 v61, 0xffff0000, v35
    v_fmac_f32 v68, v13, v60
    v_fmac_f32 v69, v13, v61
    s_waitcnt vmcnt(4)
    v_lshlrev_b32 v60, 16, v36
    v_and_b32 v61, 0xffff0000, v36
    v_fmac_f32 v62, v14, v60
    v_fmac_f32 v63, v14, v61
    v_lshlrev_b32 v60, 16, v37
    v_and_b32 v61, 0xffff0000, v37
    v_fmac_f32 v64, v14, v60
    v_fmac_f32 v65, v14, v61
    v_lshlrev_b32 v60, 16, v38
    v_and_b32 v61, 0xffff0000, v38
    v_fmac_f32 v66, v14, v60
    v_fmac_f32 v67, v14, v61
    v_lshlrev_b32 v60, 16, v39
    v_and_b32 v61, 0xffff0000, v39
    v_fmac_f32 v68, v14, v60
    v_fmac_f32 v69, v14, v61
    s_waitcnt vmcnt(3)
    v_lshlrev_b32 v60, 16, v40
    v_and_b32 v61, 0xffff0000, v40
    v_fmac_f32 v62, v15, v60
    v_fmac_f32 v63, v15, v61
    v_lshlrev_b32 v60, 16, v41
    v_and_b32 v61, 0xffff0000, v41
    v_fmac_f32 v64, v15, v60
    v_fmac_f32 v65, v15, v61
    v_lshlrev_b32 v60, 16, v42
    v_and_b32 v61, 0xffff0000, v42
    v_fmac_f32 v66, v15, v60
    v_fmac_f32 v67, v15, v61
    v_lshlrev_b32 v60, 16, v43
    v_and_b32 v61, 0xffff0000, v43
    v_fmac_f32 v68, v15, v60
    v_fmac_f32 v69, v15, v61
    s_waitcnt vmcnt(2)
    v_lshlrev_b32 v60, 16, v44
    v_and_b32 v61, 0xffff0000, v44
    v_fmac_f32 v62, v16, v60
    v_fmac_f32 v63, v16, v61
    v_lshlrev_b32 v60, 16, v45
    v_and_b32 v61, 0xffff0000, v45
    v_fmac_f32 v64, v16, v60
    v_fmac_f32 v65, v16, v61
    v_lshlrev_b32 v60, 16, v46
    v_and_b32 v61, 0xffff0000, v46
    v_fmac_f32 v66, v16, v60
    v_fmac_f32 v67, v16, v61
    v_lshlrev_b32 v60, 16, v47
    v_and_b32 v61, 0xffff0000, v47
    v_fmac_f32 v68, v16, v60
    v_fmac_f32 v69, v16, v61
    s_waitcnt vmcnt(1)
    v_lshlrev_b32 v60, 16, v48
    v_and_b32 v61, 0xffff0000, v48
    v_fmac_f32 v62, v17, v60
    v_fmac_f32 v63, v17, v61
    v_lshlrev_b32 v60, 16, v49
    v_and_b32 v61, 0xffff0000, v49
    v_fmac_f32 v64, v17, v60
    v_fmac_f32 v65, v17, v61
    v_lshlrev_b32 v60, 16, v50
    v_and_b32 v61, 0xffff0000, v50
    v_fmac_f32 v66, v17, v60
    v_fmac_f32 v67, v17, v61
    v_lshlrev_b32 v60, 16, v51
    v_and_b32 v61, 0xffff0000, v51
    v_fmac_f32 v68, v17, v60
    v_fmac_f32 v69, v17, v61
    s_waitcnt vmcnt(0)
    v_lshlrev_b32 v60, 16, v52
    v_and_b32 v61, 0xffff0000, v52
    v_fmac_f32 v62, v18, v60
    v_fmac_f32 v63, v18, v61
    v_lshlrev_b32 v60, 16, v53
    v_and_b32 v61, 0xffff0000, v53
    v_fmac_f32 v64, v18, v60
    v_fmac_f32 v65, v18, v61
    v_lshlrev_b32 v60, 16, v54
    v_and_b32 v61, 0xffff0000, v54
    v_fmac_f32 v66, v18, v60
    v_fmac_f32 v67, v18, v61
    v_lshlrev_b32 v60, 16, v55
    v_and_b32 v61, 0xffff0000, v55
    v_fmac_f32 v68, v18, v60
    v_fmac_f32 v69, v18, v61
    v_lshlrev_b32 v5, 7, v2
    v_lshl_add_u32 v5, v1, 5, v5
    ds_write_b128 v5, v[62:65]
    ds_write_b128 v5, v[66:69] offset:16
    s_waitcnt lgkmcnt(0)
    s_barrier
    v_cmp_gt_u32 vcc, 32, v0
    s_and_saveexec_b64 s[22:23], vcc
    s_cbranch_execz Lk1_g_done
    v_lshlrev_b32 v5, 2, v0
    v_mov_b32 v6, 0
    ds_read_b32 v20, v5 offset:0
    ds_read_b32 v21, v5 offset:128
    ds_read_b32 v22, v5 offset:256
    ds_read_b32 v23, v5 offset:384
    ds_read_b32 v24, v5 offset:512
    ds_read_b32 v25, v5 offset:640
    ds_read_b32 v26, v5 offset:768
    ds_read_b32 v27, v5 offset:896
    ds_read_b32 v28, v5 offset:1024
    ds_read_b32 v29, v5 offset:1152
    ds_read_b32 v30, v5 offset:1280
    ds_read_b32 v31, v5 offset:1408
    ds_read_b32 v32, v5 offset:1536
    ds_read_b32 v33, v5 offset:1664
    ds_read_b32 v34, v5 offset:1792
    ds_read_b32 v35, v5 offset:1920
    s_waitcnt lgkmcnt(0)
    v_add_f32 v6, v6, v20
    v_add_f32 v6, v6, v21
    v_add_f32 v6, v6, v22
    v_add_f32 v6, v6, v23
    v_add_f32 v6, v6, v24
    v_add_f32 v6, v6, v25
    v_add_f32 v6, v6, v26
    v_add_f32 v6, v6, v27
    v_add_f32 v6, v6, v28
    v_add_f32 v6, v6, v29
    v_add_f32 v6, v6, v30
    v_add_f32 v6, v6, v31
    v_add_f32 v6, v6, v32
    v_add_f32 v6, v6, v33
    v_add_f32 v6, v6, v34
    v_add_f32 v6, v6, v35
    ds_read_b32 v20, v5 offset:2048
    ds_read_b32 v21, v5 offset:2176
    ds_read_b32 v22, v5 offset:2304
    ds_read_b32 v23, v5 offset:2432
    ds_read_b32 v24, v5 offset:2560
    ds_read_b32 v25, v5 offset:2688
    ds_read_b32 v26, v5 offset:2816
    ds_read_b32 v27, v5 offset:2944
    ds_read_b32 v28, v5 offset:3072
    ds_read_b32 v29, v5 offset:3200
    ds_read_b32 v30, v5 offset:3328
    ds_read_b32 v31, v5 offset:3456
    ds_read_b32 v32, v5 offset:3584
    ds_read_b32 v33, v5 offset:3712
    ds_read_b32 v34, v5 offset:3840
    ds_read_b32 v35, v5 offset:3968
    s_waitcnt lgkmcnt(0)
    v_add_f32 v6, v6, v20
    v_add_f32 v6, v6, v21
    v_add_f32 v6, v6, v22
    v_add_f32 v6, v6, v23
    v_add_f32 v6, v6, v24
    v_add_f32 v6, v6, v25
    v_add_f32 v6, v6, v26
    v_add_f32 v6, v6, v27
    v_add_f32 v6, v6, v28
    v_add_f32 v6, v6, v29
    v_add_f32 v6, v6, v30
    v_add_f32 v6, v6, v31
    v_add_f32 v6, v6, v32
    v_add_f32 v6, v6, v33
    v_add_f32 v6, v6, v34
    v_add_f32 v6, v6, v35
    ds_read_b32 v20, v5 offset:4096
    ds_read_b32 v21, v5 offset:4224
    ds_read_b32 v22, v5 offset:4352
    ds_read_b32 v23, v5 offset:4480
    ds_read_b32 v24, v5 offset:4608
    ds_read_b32 v25, v5 offset:4736
    ds_read_b32 v26, v5 offset:4864
    ds_read_b32 v27, v5 offset:4992
    ds_read_b32 v28, v5 offset:5120
    ds_read_b32 v29, v5 offset:5248
    ds_read_b32 v30, v5 offset:5376
    ds_read_b32 v31, v5 offset:5504
    ds_read_b32 v32, v5 offset:5632
    ds_read_b32 v33, v5 offset:5760
    ds_read_b32 v34, v5 offset:5888
    ds_read_b32 v35, v5 offset:6016
    s_waitcnt lgkmcnt(0)
    v_add_f32 v6, v6, v20
    v_add_f32 v6, v6, v21
    v_add_f32 v6, v6, v22
    v_add_f32 v6, v6, v23
    v_add_f32 v6, v6, v24
    v_add_f32 v6, v6, v25
    v_add_f32 v6, v6, v26
    v_add_f32 v6, v6, v27
    v_add_f32 v6, v6, v28
    v_add_f32 v6, v6, v29
    v_add_f32 v6, v6, v30
    v_add_f32 v6, v6, v31
    v_add_f32 v6, v6, v32
    v_add_f32 v6, v6, v33
    v_add_f32 v6, v6, v34
    v_add_f32 v6, v6, v35
    ds_read_b32 v20, v5 offset:6144
    ds_read_b32 v21, v5 offset:6272
    ds_read_b32 v22, v5 offset:6400
    ds_read_b32 v23, v5 offset:6528
    ds_read_b32 v24, v5 offset:6656
    ds_read_b32 v25, v5 offset:6784
    ds_read_b32 v26, v5 offset:6912
    ds_read_b32 v27, v5 offset:7040
    ds_read_b32 v28, v5 offset:7168
    ds_read_b32 v29, v5 offset:7296
    ds_read_b32 v30, v5 offset:7424
    ds_read_b32 v31, v5 offset:7552
    ds_read_b32 v32, v5 offset:7680
    ds_read_b32 v33, v5 offset:7808
    ds_read_b32 v34, v5 offset:7936
    ds_read_b32 v35, v5 offset:8064
    s_waitcnt lgkmcnt(0)
    v_add_f32 v6, v6, v20
    v_add_f32 v6, v6, v21
    v_add_f32 v6, v6, v22
    v_add_f32 v6, v6, v23
    v_add_f32 v6, v6, v24
    v_add_f32 v6, v6, v25
    v_add_f32 v6, v6, v26
    v_add_f32 v6, v6, v27
    v_add_f32 v6, v6, v28
    v_add_f32 v6, v6, v29
    v_add_f32 v6, v6, v30
    v_add_f32 v6, v6, v31
    v_add_f32 v6, v6, v32
    v_add_f32 v6, v6, v33
    v_add_f32 v6, v6, v34
    v_add_f32 v6, v6, v35
    v_cvt_pk_bf16_f32 v60, v6, v6
    v_lshlrev_b32 v6, 16, v60
    s_cmp_ge_u32 s2, 18
    s_cselect_b32 s24, 1, 0
    s_cmp_ge_u32 s2, 36
    s_cselect_b32 s24, 0, s24
    s_cmp_ge_u32 s2, 72
    s_cselect_b32 s24, 1, s24
    s_cmp_ge_u32 s2, 90
    s_cselect_b32 s24, 0, s24
    s_cmp_eq_u32 s24, 0
    s_cbranch_scc1 Lk1_g_st
    v_add_f32 v6, 1.0, v6
    v_cvt_pk_bf16_f32 v60, v6, v6
    v_lshlrev_b32 v6, 16, v60
Lk1_g_st:
    s_lshl_b32 s15, s2, 7
    v_lshl_add_u32 v5, v0, 2, s15
    global_store_dword v5, v6, s[12:13]
Lk1_g_done:
    s_waitcnt vmcnt(0)
    s_branch Lk1_end
Lk1_tr:
    s_sub_u32 s3, s2, 108
    s_mul_i32 s25, s3, 0xcccd
    s_lshr_b32 s25, s25, 18
    s_mul_i32 s26, s25, 5
    s_sub_u32 s26, s3, s26
    v_and_b32 v1, 63, v0
    v_lshrrev_b32 v2, 6, v0
    s_lshl_b32 s27, s26, 6
    v_add_u32 v3, s27, v1
    v_cmp_gt_u32 vcc, 289, v3
    s_lshl_b32 s28, s25, 6
    v_lshlrev_b32 v4, 4, v2
    v_add_u32 v4, s28, v4
    s_movk_i32 s14, 578
    v_mul_lo_u32 v5, v4, s14
    v_lshl_add_u32 v5, v3, 1, v5
    s_and_saveexec_b64 s[22:23], vcc
    s_cbranch_execz Lk1_tr_ld_done
    v_add_u32 v50, 4624, v5
    global_load_ushort v10, v5, s[16:17] offset:0
    global_load_ushort v30, v5, s[18:19] offset:0
    global_load_ushort v11, v5, s[16:17] offset:578
    global_load_ushort v31, v5, s[18:19] offset:578
    global_load_ushort v12, v5, s[16:17] offset:1156
    global_load_ushort v32, v5, s[18:19] offset:1156
    global_load_ushort v13, v5, s[16:17] offset:1734
    global_load_ushort v33, v5, s[18:19] offset:1734
    global_load_ushort v14, v5, s[16:17] offset:2312
    global_load_ushort v34, v5, s[18:19] offset:2312
    global_load_ushort v15, v5, s[16:17] offset:2890
    global_load_ushort v35, v5, s[18:19] offset:2890
    global_load_ushort v16, v5, s[16:17] offset:3468
    global_load_ushort v36, v5, s[18:19] offset:3468
    global_load_ushort v17, v5, s[16:17] offset:4046
    global_load_ushort v37, v5, s[18:19] offset:4046
    global_load_ushort v18, v50, s[16:17] offset:0
    global_load_ushort v38, v50, s[18:19] offset:0
    global_load_ushort v19, v50, s[16:17] offset:578
    global_load_ushort v39, v50, s[18:19] offset:578
    global_load_ushort v20, v50, s[16:17] offset:1156
    global_load_ushort v40, v50, s[18:19] offset:1156
    global_load_ushort v21, v50, s[16:17] offset:1734
    global_load_ushort v41, v50, s[18:19] offset:1734
    global_load_ushort v22, v50, s[16:17] offset:2312
    global_load_ushort v42, v50, s[18:19] offset:2312
    global_load_ushort v23, v50, s[16:17] offset:2890
    global_load_ushort v43, v50, s[18:19] offset:2890
    global_load_ushort v24, v50, s[16:17] offset:3468
    global_load_ushort v44, v50, s[18:19] offset:3468
    global_load_ushort v25, v50, s[16:17] offset:4046
    global_load_ushort v45, v50, s[18:19] offset:4046
    s_waitcnt vmcnt(0)
    v_mul_u32_u24 v6, 65, v1
    v_lshl_add_u32 v6, v2, 4, v6
    v_lshlrev_b32 v6, 2, v6
    v_lshl_or_b32 v10, v30, 16, v10
    ds_write_b32 v6, v10 offset:0
    v_lshl_or_b32 v11, v31, 16, v11
    ds_write_b32 v6, v11 offset:4
    v_lshl_or_b32 v12, v32, 16, v12
    ds_write_b32 v6, v12 offset:8
    v_lshl_or_b32 v13, v33, 16, v13
    ds_write_b32 v6, v13 offset:12
    v_lshl_or_b32 v14, v34, 16, v14
    ds_write_b32 v6, v14 offset:16
    v_lshl_or_b32 v15, v35, 16, v15
    ds_write_b32 v6, v15 offset:20
    v_lshl_or_b32 v16, v36, 16, v16
    ds_write_b32 v6, v16 offset:24
    v_lshl_or_b32 v17, v37, 16, v17
    ds_write_b32 v6, v17 offset:28
    v_lshl_or_b32 v18, v38, 16, v18
    ds_write_b32 v6, v18 offset:32
    v_lshl_or_b32 v19, v39, 16, v19
    ds_write_b32 v6, v19 offset:36
    v_lshl_or_b32 v20, v40, 16, v20
    ds_write_b32 v6, v20 offset:40
    v_lshl_or_b32 v21, v41, 16, v21
    ds_write_b32 v6, v21 offset:44
    v_lshl_or_b32 v22, v42, 16, v22
    ds_write_b32 v6, v22 offset:48
    v_lshl_or_b32 v23, v43, 16, v23
    ds_write_b32 v6, v23 offset:52
    v_lshl_or_b32 v24, v44, 16, v24
    ds_write_b32 v6, v24 offset:56
    v_lshl_or_b32 v25, v45, 16, v25
    ds_write_b32 v6, v25 offset:60
Lk1_tr_ld_done:
    s_mov_b64 exec, s[22:23]
    s_waitcnt lgkmcnt(0)
    s_barrier
    v_lshlrev_b32 v6, 4, v2
    v_mul_u32_u24 v7, 65, v6
    v_add_u32 v7, v7, v1
    v_lshlrev_b32 v7, 2, v7
    ds_read_b32 v10, v7 offset:0
    ds_read_b32 v11, v7 offset:260
    ds_read_b32 v12, v7 offset:520
    ds_read_b32 v13, v7 offset:780
    ds_read_b32 v14, v7 offset:1040
    ds_read_b32 v15, v7 offset:1300
    ds_read_b32 v16, v7 offset:1560
    ds_read_b32 v17, v7 offset:1820
    ds_read_b32 v18, v7 offset:2080
    ds_read_b32 v19, v7 offset:2340
    ds_read_b32 v20, v7 offset:2600
    ds_read_b32 v21, v7 offset:2860
    ds_read_b32 v22, v7 offset:3120
    ds_read_b32 v23, v7 offset:3380
    ds_read_b32 v24, v7 offset:3640
    ds_read_b32 v25, v7 offset:3900
    v_add_u32 v8, s27, v6
    v_lshlrev_b32 v9, 11, v8
    v_add_u32 v9, v9, v1
    v_add_u32 v9, s28, v9
    v_lshlrev_b32 v9, 2, v9
    v_add_u32 v9, 1048576, v9
    s_waitcnt lgkmcnt(0)
    v_readfirstlane_b32 s29, v8
    s_cmp_ge_u32 s29, 289
    s_cbranch_scc1 Lk1_tr_done
    global_store_dword v9, v10, s[12:13]
    v_add_u32 v9, 0x2000, v9
    v_add_u32 v8, 1, v8
    s_nop 0
    v_readfirstlane_b32 s29, v8
    s_cmp_ge_u32 s29, 289
    s_cbranch_scc1 Lk1_tr_done
    global_store_dword v9, v11, s[12:13]
    v_add_u32 v9, 0x2000, v9
    v_add_u32 v8, 1, v8
    s_nop 0
    v_readfirstlane_b32 s29, v8
    s_cmp_ge_u32 s29, 289
    s_cbranch_scc1 Lk1_tr_done
    global_store_dword v9, v12, s[12:13]
    v_add_u32 v9, 0x2000, v9
    v_add_u32 v8, 1, v8
    s_nop 0
    v_readfirstlane_b32 s29, v8
    s_cmp_ge_u32 s29, 289
    s_cbranch_scc1 Lk1_tr_done
    global_store_dword v9, v13, s[12:13]
    v_add_u32 v9, 0x2000, v9
    v_add_u32 v8, 1, v8
    s_nop 0
    v_readfirstlane_b32 s29, v8
    s_cmp_ge_u32 s29, 289
    s_cbranch_scc1 Lk1_tr_done
    global_store_dword v9, v14, s[12:13]
    v_add_u32 v9, 0x2000, v9
    v_add_u32 v8, 1, v8
    s_nop 0
    v_readfirstlane_b32 s29, v8
    s_cmp_ge_u32 s29, 289
    s_cbranch_scc1 Lk1_tr_done
    global_store_dword v9, v15, s[12:13]
    v_add_u32 v9, 0x2000, v9
    v_add_u32 v8, 1, v8
    s_nop 0
    v_readfirstlane_b32 s29, v8
    s_cmp_ge_u32 s29, 289
    s_cbranch_scc1 Lk1_tr_done
    global_store_dword v9, v16, s[12:13]
    v_add_u32 v9, 0x2000, v9
    v_add_u32 v8, 1, v8
    s_nop 0
    v_readfirstlane_b32 s29, v8
    s_cmp_ge_u32 s29, 289
    s_cbranch_scc1 Lk1_tr_done
    global_store_dword v9, v17, s[12:13]
    v_add_u32 v9, 0x2000, v9
    v_add_u32 v8, 1, v8
    s_nop 0
    v_readfirstlane_b32 s29, v8
    s_cmp_ge_u32 s29, 289
    s_cbranch_scc1 Lk1_tr_done
    global_store_dword v9, v18, s[12:13]
    v_add_u32 v9, 0x2000, v9
    v_add_u32 v8, 1, v8
    s_nop 0
    v_readfirstlane_b32 s29, v8
    s_cmp_ge_u32 s29, 289
    s_cbranch_scc1 Lk1_tr_done
    global_store_dword v9, v19, s[12:13]
    v_add_u32 v9, 0x2000, v9
    v_add_u32 v8, 1, v8
    s_nop 0
    v_readfirstlane_b32 s29, v8
    s_cmp_ge_u32 s29, 289
    s_cbranch_scc1 Lk1_tr_done
    global_store_dword v9, v20, s[12:13]
    v_add_u32 v9, 0x2000, v9
    v_add_u32 v8, 1, v8
    s_nop 0
    v_readfirstlane_b32 s29, v8
    s_cmp_ge_u32 s29, 289
    s_cbranch_scc1 Lk1_tr_done
    global_store_dword v9, v21, s[12:13]
    v_add_u32 v9, 0x2000, v9
    v_add_u32 v8, 1, v8
    s_nop 0
    v_readfirstlane_b32 s29, v8
    s_cmp_ge_u32 s29, 289
    s_cbranch_scc1 Lk1_tr_done
    global_store_dword v9, v22, s[12:13]
    v_add_u32 v9, 0x2000, v9
    v_add_u32 v8, 1, v8
    s_nop 0
    v_readfirstlane_b32 s29, v8
    s_cmp_ge_u32 s29, 289
    s_cbranch_scc1 Lk1_tr_done
    global_store_dword v9, v23, s[12:13]
    v_add_u32 v9, 0x2000, v9
    v_add_u32 v8, 1, v8
    s_nop 0
    v_readfirstlane_b32 s29, v8
    s_cmp_ge_u32 s29, 289
    s_cbranch_scc1 Lk1_tr_done
    global_store_dword v9, v24, s[12:13]
    v_add_u32 v9, 0x2000, v9
    v_add_u32 v8, 1, v8
    s_nop 0
    v_readfirstlane_b32 s29, v8
    s_cmp_ge_u32 s29, 289
    s_cbranch_scc1 Lk1_tr_done
    global_store_dword v9, v25, s[12:13]
    v_add_u32 v9, 0x2000, v9
Lk1_tr_done:
    s_waitcnt vmcnt(0)
Lk1_end:
    s_endpgm
.globl k2_rowfft_kernel
.p2align 8
.type k2_rowfft_kernel,@function
k2_rowfft_kernel:
    s_cmp_ge_u32 s2, 256
    s_cbranch_scc1 Lk2_end
    s_load_dwordx2 s[4:5], s[0:1], 0
    s_load_dwordx2 s[6:7], s[0:1], 80
    v_and_b32 v1, 63, v0
    v_lshrrev_b32 v2, 6, v0
    s_lshl_b32 s8, s2, 3
    v_lshl_add_u32 v3, v2, 1, s8
    s_movk_i32 s9, 1152
    v_mul_lo_u32 v4, v3, s9
    v_lshl_add_u32 v4, v1, 1, v4
    v_lshlrev_b32 v5, 2, v1
    s_waitcnt lgkmcnt(0)
    s_add_u32 s10, s6, 2304
    s_addc_u32 s11, s7, 0
    global_load_ushort v10, v4, s[4:5] offset:0
    global_load_ushort v19, v4, s[4:5] offset:1152
    global_load_ushort v11, v4, s[4:5] offset:128
    global_load_ushort v20, v4, s[4:5] offset:1280
    global_load_ushort v12, v4, s[4:5] offset:256
    global_load_ushort v21, v4, s[4:5] offset:1408
    global_load_ushort v13, v4, s[4:5] offset:384
    global_load_ushort v22, v4, s[4:5] offset:1536
    global_load_ushort v14, v4, s[4:5] offset:512
    global_load_ushort v23, v4, s[4:5] offset:1664
    global_load_ushort v15, v4, s[4:5] offset:640
    global_load_ushort v24, v4, s[4:5] offset:1792
    global_load_ushort v16, v4, s[4:5] offset:768
    global_load_ushort v25, v4, s[4:5] offset:1920
    global_load_ushort v17, v4, s[4:5] offset:896
    global_load_ushort v26, v4, s[4:5] offset:2048
    global_load_ushort v18, v4, s[4:5] offset:1024
    global_load_ushort v27, v4, s[4:5] offset:2176
    global_load_dword v37, v5, s[6:7] offset:0
    global_load_dword v28, v5, s[10:11] offset:0
    global_load_dword v38, v5, s[6:7] offset:256
    global_load_dword v29, v5, s[10:11] offset:256
    global_load_dword v39, v5, s[6:7] offset:512
    global_load_dword v30, v5, s[10:11] offset:512
    global_load_dword v40, v5, s[6:7] offset:768
    global_load_dword v31, v5, s[10:11] offset:768
    global_load_dword v41, v5, s[6:7] offset:1024
    global_load_dword v32, v5, s[10:11] offset:1024
    global_load_dword v42, v5, s[6:7] offset:1280
    global_load_dword v33, v5, s[10:11] offset:1280
    global_load_dword v43, v5, s[6:7] offset:1536
    global_load_dword v34, v5, s[10:11] offset:1536
    global_load_dword v44, v5, s[6:7] offset:1792
    global_load_dword v35, v5, s[10:11] offset:1792
    global_load_dword v45, v5, s[6:7] offset:2048
    global_load_dword v36, v5, s[10:11] offset:2048
    s_waitcnt vmcnt(18)
    v_lshlrev_b32 v10, 16, v10
    v_lshlrev_b32 v11, 16, v11
    v_lshlrev_b32 v12, 16, v12
    v_lshlrev_b32 v13, 16, v13
    v_lshlrev_b32 v14, 16, v14
    v_lshlrev_b32 v15, 16, v15
    v_lshlrev_b32 v16, 16, v16
    v_lshlrev_b32 v17, 16, v17
    v_lshlrev_b32 v18, 16, v18
    v_lshlrev_b32 v19, 16, v19
    v_lshlrev_b32 v20, 16, v20
    v_lshlrev_b32 v21, 16, v21
    v_lshlrev_b32 v22, 16, v22
    v_lshlrev_b32 v23, 16, v23
    v_lshlrev_b32 v24, 16, v24
    v_lshlrev_b32 v25, 16, v25
    v_lshlrev_b32 v26, 16, v26
    v_lshlrev_b32 v27, 16, v27
    s_waitcnt vmcnt(0)
    v_add_f32 v46, v10, v11
    v_add_f32 v46, v46, v12
    v_add_f32 v46, v46, v13
    v_add_f32 v46, v46, v14
    v_add_f32 v46, v46, v15
    v_add_f32 v46, v46, v16
    v_add_f32 v46, v46, v17
    v_add_f32 v46, v46, v18
    s_nop 1
    v_add_f32 v46, v46, v46 quad_perm:[1,0,3,2] row_mask:0xf bank_mask:0xf
    s_nop 1
    v_add_f32 v46, v46, v46 quad_perm:[2,3,0,1] row_mask:0xf bank_mask:0xf
    s_nop 1
    v_add_f32 v46, v46, v46 row_half_mirror row_mask:0xf bank_mask:0xf
    s_nop 1
    v_add_f32 v46, v46, v46 row_mirror row_mask:0xf bank_mask:0xf
    s_nop 0
    v_readlane_b32 s20, v46, 0
    v_readlane_b32 s21, v46, 16
    v_readlane_b32 s22, v46, 32
    v_readlane_b32 s23, v46, 48
    v_mov_b32 v46, s20
    v_add_f32 v46, s21, v46
    v_add_f32 v46, s22, v46
    v_add_f32 v46, s23, v46
    v_mul_f32 v46, 0x3ae38e39, v46
    v_sub_f32 v47, v10, v46
    v_mul_f32 v48, v47, v47
    v_sub_f32 v47, v11, v46
    v_fmac_f32 v48, v47, v47
    v_sub_f32 v47, v12, v46
    v_fmac_f32 v48, v47, v47
    v_sub_f32 v47, v13, v46
    v_fmac_f32 v48, v47, v47
    v_sub_f32 v47, v14, v46
    v_fmac_f32 v48, v47, v47
    v_sub_f32 v47, v15, v46
    v_fmac_f32 v48, v47, v47
    v_sub_f32 v47, v16, v46
    v_fmac_f32 v48, v47, v47
    v_sub_f32 v47, v17, v46
    v_fmac_f32 v48, v47, v47
    v_sub_f32 v47, v18, v46
    v_fmac_f32 v48, v47, v47
    s_nop 1
    v_add_f32 v48, v48, v48 quad_perm:[1,0,3,2] row_mask:0xf bank_mask:0xf
    s_nop 1
    v_add_f32 v48, v48, v48 quad_perm:[2,3,0,1] row_mask:0xf bank_mask:0xf
    s_nop 1
    v_add_f32 v48, v48, v48 row_half_mirror row_mask:0xf bank_mask:0xf
    s_nop 1
    v_add_f32 v48, v48, v48 row_mirror row_mask:0xf bank_mask:0xf
    s_nop 0
    v_readlane_b32 s20, v48, 0
    v_readlane_b32 s21, v48, 16
    v_readlane_b32 s22, v48, 32
    v_readlane_b32 s23, v48, 48
    v_mov_b32 v48, s20
    v_add_f32 v48, s21, v48
    v_add_f32 v48, s22, v48
    v_add_f32 v48, s23, v48
    v_mul_f32 v48, 0x3ae38e39, v48
    v_cvt_pk_bf16_f32 v47, v46, v48
    v_lshlrev_b32 v46, 16, v47
    v_and_b32 v48, 0xffff0000, v47
    v_add_f32 v48, 0x3727c5ac, v48
    v_cvt_pk_bf16_f32 v47, v48, v48
    v_lshlrev_b32 v48, 16, v47
    v_sqrt_f32 v48, v48
    s_nop 0
    v_cvt_pk_bf16_f32 v47, v48, v48
    v_lshlrev_b32 v48, 16, v47
    v_rcp_f32 v48, v48
    v_sub_f32 v10, v10, v46
    v_sub_f32 v11, v11, v46
    v_sub_f32 v12, v12, v46
    v_sub_f32 v13, v13, v46
    v_sub_f32 v14, v14, v46
    v_sub_f32 v15, v15, v46
    v_sub_f32 v16, v16, v46
    v_sub_f32 v17, v17, v46
    v_sub_f32 v18, v18, v46
    v_cvt_pk_bf16_f32 v47, v10, v11
    v_lshlrev_b32 v10, 16, v47
    v_and_b32 v11, 0xffff0000, v47
    v_cvt_pk_bf16_f32 v47, v12, v13
    v_lshlrev_b32 v12, 16, v47
    v_and_b32 v13, 0xffff0000, v47
    v_cvt_pk_bf16_f32 v47, v14, v15
    v_lshlrev_b32 v14, 16, v47
    v_and_b32 v15, 0xffff0000, v47
    v_cvt_pk_bf16_f32 v47, v16, v17
    v_lshlrev_b32 v16, 16, v47
    v_and_b32 v17, 0xffff0000, v47
    v_cvt_pk_bf16_f32 v47, v18, v18
    v_lshlrev_b32 v18, 16, v47
    v_mul_f32 v10, v10, v48
    v_mul_f32 v11, v11, v48
    v_mul_f32 v12, v12, v48
    v_mul_f32 v13, v13, v48
    v_mul_f32 v14, v14, v48
    v_mul_f32 v15, v15, v48
    v_mul_f32 v16, v16, v48
    v_mul_f32 v17, v17, v48
    v_mul_f32 v18, v18, v48
    v_cvt_pk_bf16_f32 v47, v10, v11
    v_lshlrev_b32 v10, 16, v47
    v_and_b32 v11, 0xffff0000, v47
    v_cvt_pk_bf16_f32 v47, v12, v13
    v_lshlrev_b32 v12, 16, v47
    v_and_b32 v13, 0xffff0000, v47
    v_cvt_pk_bf16_f32 v47, v14, v15
    v_lshlrev_b32 v14, 16, v47
    v_and_b32 v15, 0xffff0000, v47
    v_cvt_pk_bf16_f32 v47, v16, v17
    v_lshlrev_b32 v16, 16, v47
    v_and_b32 v17, 0xffff0000, v47
    v_cvt_pk_bf16_f32 v47, v18, v18
    v_lshlrev_b32 v18, 16, v47
    v_mul_f32 v10, v10, v28
    v_mul_f32 v11, v11, v29
    v_mul_f32 v12, v12, v30
    v_mul_f32 v13, v13, v31
    v_mul_f32 v14, v14, v32
    v_mul_f32 v15, v15, v33
    v_mul_f32 v16, v16, v34
    v_mul_f32 v17, v17, v35
    v_mul_f32 v18, v18, v36
    v_cvt_pk_bf16_f32 v47, v10, v11
    v_lshlrev_b32 v10, 16, v47
    v_and_b32 v11, 0xffff0000, v47
    v_cvt_pk_bf16_f32 v47, v12, v13
    v_lshlrev_b32 v12, 16, v47
    v_and_b32 v13, 0xffff0000, v47
    v_cvt_pk_bf16_f32 v47, v14, v15
    v_lshlrev_b32 v14, 16, v47
    v_and_b32 v15, 0xffff0000, v47
    v_cvt_pk_bf16_f32 v47, v16, v17
    v_lshlrev_b32 v16, 16, v47
    v_and_b32 v17, 0xffff0000, v47
    v_cvt_pk_bf16_f32 v47, v18, v18
    v_lshlrev_b32 v18, 16, v47
    v_add_f32 v10, v10, v37
    v_add_f32 v11, v11, v38
    v_add_f32 v12, v12, v39
    v_add_f32 v13, v13, v40
    v_add_f32 v14, v14, v41
    v_add_f32 v15, v15, v42
    v_add_f32 v16, v16, v43
    v_add_f32 v17, v17, v44
    v_add_f32 v18, v18, v45
    v_cvt_pk_bf16_f32 v47, v10, v11
    v_lshlrev_b32 v10, 16, v47
    v_and_b32 v11, 0xffff0000, v47
    v_cvt_pk_bf16_f32 v47, v12, v13
    v_lshlrev_b32 v12, 16, v47
    v_and_b32 v13, 0xffff0000, v47
    v_cvt_pk_bf16_f32 v47, v14, v15
    v_lshlrev_b32 v14, 16, v47
    v_and_b32 v15, 0xffff0000, v47
    v_cvt_pk_bf16_f32 v47, v16, v17
    v_lshlrev_b32 v16, 16, v47
    v_and_b32 v17, 0xffff0000, v47
    v_cvt_pk_bf16_f32 v47, v18, v18
    v_lshlrev_b32 v18, 16, v47
    v_add_f32 v46, v19, v20
    v_add_f32 v46, v46, v21
    v_add_f32 v46, v46, v22
    v_add_f32 v46, v46, v23
    v_add_f32 v46, v46, v24
    v_add_f32 v46, v46, v25
    v_add_f32 v46, v46, v26
    v_add_f32 v46, v46, v27
    s_nop 1
    v_add_f32 v46, v46, v46 quad_perm:[1,0,3,2] row_mask:0xf bank_mask:0xf
    s_nop 1
    v_add_f32 v46, v46, v46 quad_perm:[2,3,0,1] row_mask:0xf bank_mask:0xf
    s_nop 1
    v_add_f32 v46, v46, v46 row_half_mirror row_mask:0xf bank_mask:0xf
    s_nop 1
    v_add_f32 v46, v46, v46 row_mirror row_mask:0xf bank_mask:0xf
    s_nop 0
    v_readlane_b32 s20, v46, 0
    v_readlane_b32 s21, v46, 16
    v_readlane_b32 s22, v46, 32
    v_readlane_b32 s23, v46, 48
    v_mov_b32 v46, s20
    v_add_f32 v46, s21, v46
    v_add_f32 v46, s22, v46
    v_add_f32 v46, s23, v46
    v_mul_f32 v46, 0x3ae38e39, v46
    v_sub_f32 v47, v19, v46
    v_mul_f32 v48, v47, v47
    v_sub_f32 v47, v20, v46
    v_fmac_f32 v48, v47, v47
    v_sub_f32 v47, v21, v46
    v_fmac_f32 v48, v47, v47
    v_sub_f32 v47, v22, v46
    v_fmac_f32 v48, v47, v47
    v_sub_f32 v47, v23, v46
    v_fmac_f32 v48, v47, v47
    v_sub_f32 v47, v24, v46
    v_fmac_f32 v48, v47, v47
    v_sub_f32 v47, v25, v46
    v_fmac_f32 v48, v47, v47
    v_sub_f32 v47, v26, v46
    v_fmac_f32 v48, v47, v47
    v_sub_f32 v47, v27, v46
    v_fmac_f32 v48, v47, v47
    s_nop 1
    v_add_f32 v48, v48, v48 quad_perm:[1,0,3,2] row_mask:0xf bank_mask:0xf
    s_nop 1
    v_add_f32 v48, v48, v48 quad_perm:[2,3,0,1] row_mask:0xf bank_mask:0xf
    s_nop 1
    v_add_f32 v48, v48, v48 row_half_mirror row_mask:0xf bank_mask:0xf
    s_nop 1
    v_add_f32 v48, v48, v48 row_mirror row_mask:0xf bank_mask:0xf
    s_nop 0
    v_readlane_b32 s20, v48, 0
    v_readlane_b32 s21, v48, 16
    v_readlane_b32 s22, v48, 32
    v_readlane_b32 s23, v48, 48
    v_mov_b32 v48, s20
    v_add_f32 v48, s21, v48
    v_add_f32 v48, s22, v48
    v_add_f32 v48, s23, v48
    v_mul_f32 v48, 0x3ae38e39, v48
    v_cvt_pk_bf16_f32 v47, v46, v48
    v_lshlrev_b32 v46, 16, v47
    v_and_b32 v48, 0xffff0000, v47
    v_add_f32 v48, 0x3727c5ac, v48
    v_cvt_pk_bf16_f32 v47, v48, v48
    v_lshlrev_b32 v48, 16, v47
    v_sqrt_f32 v48, v48
    s_nop 0
    v_cvt_pk_bf16_f32 v47, v48, v48
    v_lshlrev_b32 v48, 16, v47
    v_rcp_f32 v48, v48
    v_sub_f32 v19, v19, v46
    v_sub_f32 v20, v20, v46
    v_sub_f32 v21, v21, v46
    v_sub_f32 v22, v22, v46
    v_sub_f32 v23, v23, v46
    v_sub_f32 v24, v24, v46
    v_sub_f32 v25, v25, v46
    v_sub_f32 v26, v26, v46
    v_sub_f32 v27, v27, v46
    v_cvt_pk_bf16_f32 v47, v19, v20
    v_lshlrev_b32 v19, 16, v47
    v_and_b32 v20, 0xffff0000, v47
    v_cvt_pk_bf16_f32 v47, v21, v22
    v_lshlrev_b32 v21, 16, v47
    v_and_b32 v22, 0xffff0000, v47
    v_cvt_pk_bf16_f32 v47, v23, v24
    v_lshlrev_b32 v23, 16, v47
    v_and_b32 v24, 0xffff0000, v47
    v_cvt_pk_bf16_f32 v47, v25, v26
    v_lshlrev_b32 v25, 16, v47
    v_and_b32 v26, 0xffff0000, v47
    v_cvt_pk_bf16_f32 v47, v27, v27
    v_lshlrev_b32 v27, 16, v47
    v_mul_f32 v19, v19, v48
    v_mul_f32 v20, v20, v48
    v_mul_f32 v21, v21, v48
    v_mul_f32 v22, v22, v48
    v_mul_f32 v23, v23, v48
    v_mul_f32 v24, v24, v48
    v_mul_f32 v25, v25, v48
    v_mul_f32 v26, v26, v48
    v_mul_f32 v27, v27, v48
    v_cvt_pk_bf16_f32 v47, v19, v20
    v_lshlrev_b32 v19, 16, v47
    v_and_b32 v20, 0xffff0000, v47
    v_cvt_pk_bf16_f32 v47, v21, v22
    v_lshlrev_b32 v21, 16, v47
    v_and_b32 v22, 0xffff0000, v47
    v_cvt_pk_bf16_f32 v47, v23, v24
    v_lshlrev_b32 v23, 16, v47
    v_and_b32 v24, 0xffff0000, v47
    v_cvt_pk_bf16_f32 v47, v25, v26
    v_lshlrev_b32 v25, 16, v47
    v_and_b32 v26, 0xffff0000, v47
    v_cvt_pk_bf16_f32 v47, v27, v27
    v_lshlrev_b32 v27, 16, v47
    v_mul_f32 v19, v19, v28
    v_mul_f32 v20, v20, v29
    v_mul_f32 v21, v21, v30
    v_mul_f32 v22, v22, v31
    v_mul_f32 v23, v23, v32
    v_mul_f32 v24, v24, v33
    v_mul_f32 v25, v25, v34
    v_mul_f32 v26, v26, v35
    v_mul_f32 v27, v27, v36
    v_cvt_pk_bf16_f32 v47, v19, v20
    v_lshlrev_b32 v19, 16, v47
    v_and_b32 v20, 0xffff0000, v47
    v_cvt_pk_bf16_f32 v47, v21, v22
    v_lshlrev_b32 v21, 16, v47
    v_and_b32 v22, 0xffff0000, v47
    v_cvt_pk_bf16_f32 v47, v23, v24
    v_lshlrev_b32 v23, 16, v47
    v_and_b32 v24, 0xffff0000, v47
    v_cvt_pk_bf16_f32 v47, v25, v26
    v_lshlrev_b32 v25, 16, v47
    v_and_b32 v26, 0xffff0000, v47
    v_cvt_pk_bf16_f32 v47, v27, v27
    v_lshlrev_b32 v27, 16, v47
    v_add_f32 v19, v19, v37
    v_add_f32 v20, v20, v38
    v_add_f32 v21, v21, v39
    v_add_f32 v22, v22, v40
    v_add_f32 v23, v23, v41
    v_add_f32 v24, v24, v42
    v_add_f32 v25, v25, v43
    v_add_f32 v26, v26, v44
    v_add_f32 v27, v27, v45
    v_cvt_pk_bf16_f32 v47, v19, v20
    v_lshlrev_b32 v19, 16, v47
    v_and_b32 v20, 0xffff0000, v47
    v_cvt_pk_bf16_f32 v47, v21, v22
    v_lshlrev_b32 v21, 16, v47
    v_and_b32 v22, 0xffff0000, v47
    v_cvt_pk_bf16_f32 v47, v23, v24
    v_lshlrev_b32 v23, 16, v47
    v_and_b32 v24, 0xffff0000, v47
    v_cvt_pk_bf16_f32 v47, v25, v26
    v_lshlrev_b32 v25, 16, v47
    v_and_b32 v26, 0xffff0000, v47
    v_cvt_pk_bf16_f32 v47, v27, v27
    v_lshlrev_b32 v27, 16, v47
    v_mul_u32_u24 v6, 9216, v2
    v_add_u32 v49, 4608, v6
    v_add_f32 v50, v13, v16
    v_sub_f32 v16, v13, v16
    v_add_f32 v13, v22, v25
    v_sub_f32 v25, v22, v25
    v_add_f32 v22, v10, v50
    v_fma_f32 v51, -0.5, v50, v10
    v_add_f32 v50, v19, v13
    v_fma_f32 v10, -0.5, v13, v19
    v_mov_b32 v13, v51
    v_fmac_f32 v13, 0x3f5db3d7, v25
    v_mov_b32 v19, v10
    v_fmac_f32 v19, 0xbf5db3d7, v16
    v_fmac_f32 v51, 0xbf5db3d7, v25
    v_fmac_f32 v10, 0x3f5db3d7, v16
    v_add_f32 v25, v14, v17
    v_sub_f32 v17, v14, v17
    v_add_f32 v14, v23, v26
    v_sub_f32 v26, v23, v26
    v_add_f32 v23, v11, v25
    v_fma_f32 v16, -0.5, v25, v11
    v_add_f32 v25, v20, v14
    v_fma_f32 v11, -0.5, v14, v20
    v_mov_b32 v14, v16
    v_fmac_f32 v14, 0x3f5db3d7, v26
    v_mov_b32 v20, v11
    v_fmac_f32 v20, 0xbf5db3d7, v17
    v_fmac_f32 v16, 0xbf5db3d7, v26
    v_fmac_f32 v11, 0x3f5db3d7, v17
    v_add_f32 v26, v15, v18
    v_sub_f32 v18, v15, v18
    v_add_f32 v15, v24, v27
    v_sub_f32 v27, v24, v27
    v_add_f32 v24, v12, v26
    v_fma_f32 v17, -0.5, v26, v12
    v_add_f32 v26, v21, v15
    v_fma_f32 v12, -0.5, v15, v21
    v_mov_b32 v15, v17
    v_fmac_f32 v15, 0x3f5db3d7, v27
    v_mov_b32 v21, v12
    v_fmac_f32 v21, 0xbf5db3d7, v18
    v_fmac_f32 v17, 0xbf5db3d7, v27
    v_fmac_f32 v12, 0x3f5db3d7, v18
    v_add_f32 v27, v23, v24
    v_sub_f32 v24, v23, v24
    v_add_f32 v23, v25, v26
    v_sub_f32 v26, v25, v26
    v_add_f32 v25, v22, v27
    v_fma_f32 v18, -0.5, v27, v22
    v_add_f32 v27, v50, v23
    v_fma_f32 v22, -0.5, v23, v50
    v_mov_b32 v23, v18
    v_fmac_f32 v23, 0x3f5db3d7, v26
    v_mov_b32 v50, v22
    v_fmac_f32 v50, 0xbf5db3d7, v24
    v_fmac_f32 v18, 0xbf5db3d7, v26
    v_fmac_f32 v22, 0x3f5db3d7, v24
    v_mul_f32 v26, 0x3f441b7d, v14
    v_fmac_f32 v26, 0x3f248dbb, v20
    v_mul_f32 v24, 0xbf248dbb, v14
    v_fmac_f32 v24, 0x3f441b7d, v20
    v_mul_f32 v20, 0x3e31d0d4, v15
    v_fmac_f32 v20, 0x3f7c1c5c, v21
    v_mul_f32 v14, 0xbf7c1c5c, v15
    v_fmac_f32 v14, 0x3e31d0d4, v21
    v_add_f32 v21, v26, v20
    v_sub_f32 v20, v26, v20
    v_add_f32 v26, v24, v14
    v_sub_f32 v14, v24, v14
    v_add_f32 v24, v13, v21
    v_fma_f32 v15, -0.5, v21, v13
    v_add_f32 v21, v19, v26
    v_fma_f32 v13, -0.5, v26, v19
    v_mov_b32 v26, v15
    v_fmac_f32 v26, 0x3f5db3d7, v14
    v_mov_b32 v19, v13
    v_fmac_f32 v19, 0xbf5db3d7, v20
    v_fmac_f32 v15, 0xbf5db3d7, v14
    v_fmac_f32 v13, 0x3f5db3d7, v20
    v_mul_f32 v14, 0x3e31d0d4, v16
    v_fmac_f32 v14, 0x3f7c1c5c, v11
    v_mul_f32 v20, 0xbf7c1c5c, v16
    v_fmac_f32 v20, 0x3e31d0d4, v11
    v_mul_f32 v11, 0xbf708fb2, v17
    v_fmac_f32 v11, 0x3eaf1d44, v12
    v_mul_f32 v16, 0xbeaf1d44, v17
    v_fmac_f32 v16, 0xbf708fb2, v12
    v_add_f32 v12, v14, v11
    v_sub_f32 v11, v14, v11
    v_add_f32 v14, v20, v16
    v_sub_f32 v16, v20, v16
    v_add_f32 v20, v51, v12
    v_fma_f32 v17, -0.5, v12, v51
    v_add_f32 v12, v10, v14
    v_fma_f32 v51, -0.5, v14, v10
    v_mov_b32 v14, v17
    v_fmac_f32 v14, 0x3f5db3d7, v16
    v_mov_b32 v10, v51
    v_fmac_f32 v10, 0xbf5db3d7, v11
    v_fmac_f32 v17, 0xbf5db3d7, v16
    v_fmac_f32 v51, 0x3f5db3d7, v11
    v_mul_u32_u24 v7, 72, v1
    v_add_u32 v7, v7, v6
    ds_write2_b32 v7, v25, v27 offset0:0 offset1:1
    ds_write2_b32 v7, v24, v21 offset0:2 offset1:3
    ds_write2_b32 v7, v20, v12 offset0:4 offset1:5
    ds_write2_b32 v7, v23, v50 offset0:6 offset1:7
    ds_write2_b32 v7, v26, v19 offset0:8 offset1:9
    ds_write2_b32 v7, v14, v10 offset0:10 offset1:11
    ds_write2_b32 v7, v18, v22 offset0:12 offset1:13
    ds_write2_b32 v7, v15, v13 offset0:14 offset1:15
    ds_write2_b32 v7, v17, v51 offset0:16 offset1:17
    s_waitcnt lgkmcnt(0)
    v_mov_b32 v8, v1
    v_mul_u32_u24 v40, 57, v8
    v_lshrrev_b32 v40, 9, v40
    v_mul_u32_u24 v41, 9, v40
    v_sub_u32 v41, v8, v41
    v_cvt_f32_u32 v42, v41
    v_mul_u32_u24 v43, 72, v40
    v_add_u32 v43, v43, v41
    v_lshl_add_u32 v44, v8, 3, v6
    ds_read_b64 v[10:11], v44 offset:0
    ds_read_b64 v[12:13], v44 offset:576
    ds_read_b64 v[14:15], v44 offset:1152
    ds_read_b64 v[16:17], v44 offset:1728
    ds_read_b64 v[18:19], v44 offset:2304
    ds_read_b64 v[20:21], v44 offset:2880
    ds_read_b64 v[22:23], v44 offset:3456
    ds_read_b64 v[24:25], v44 offset:4032
    v_mul_f32 v45, 0xbc638e39, v42
    v_cos_f32 v26, v45
    v_sin_f32 v27, v45
    v_mul_f32 v45, 0xbce38e39, v42
    v_cos_f32 v28, v45
    v_sin_f32 v29, v45
    v_mul_f32 v45, 0xbd2aaaab, v42
    v_cos_f32 v30, v45
    v_sin_f32 v31, v45
    v_mul_f32 v45, 0xbd638e39, v42
    v_cos_f32 v32, v45
    v_sin_f32 v33, v45
    v_mul_f32 v45, 0xbd8e38e4, v42
    v_cos_f32 v34, v45
    v_sin_f32 v35, v45
    v_mul_f32 v45, 0xbdaaaaab, v42
    v_cos_f32 v36, v45
    v_sin_f32 v37, v45
    v_mul_f32 v45, 0xbdc71c72, v42
    v_cos_f32 v38, v45
    v_sin_f32 v39, v45
    s_waitcnt lgkmcnt(0)
    v_mul_f32_e64 v50, v12, v26
    v_mul_f32_e64 v51, v12, v27
    v_fma_f32 v50, -v13, v27, v50
    v_fma_f32 v51, v13, v26, v51
    v_mul_f32_e64 v13, v14, v28
    v_mul_f32_e64 v12, v14, v29
    v_fma_f32 v13, -v15, v29, v13
    v_fma_f32 v12, v15, v28, v12
    v_mul_f32_e64 v15, v16, v30
    v_mul_f32_e64 v14, v16, v31
    v_fma_f32 v15, -v17, v31, v15
    v_fma_f32 v14, v17, v30, v14
    v_mul_f32_e64 v17, v18, v32
    v_mul_f32_e64 v16, v18, v33
    v_fma_f32 v17, -v19, v33, v17
    v_fma_f32 v16, v19, v32, v16
    v_mul_f32_e64 v19, v20, v34
    v_mul_f32_e64 v18, v20, v35
    v_fma_f32 v19, -v21, v35, v19
    v_fma_f32 v18, v21, v34, v18
    v_mul_f32_e64 v21, v22, v36
    v_mul_f32_e64 v20, v22, v37
    v_fma_f32 v21, -v23, v37, v21
    v_fma_f32 v20, v23, v36, v20
    v_mul_f32_e64 v23, v24, v38
    v_mul_f32_e64 v22, v24, v39
    v_fma_f32 v23, -v25, v39, v23
    v_fma_f32 v22, v25, v38, v22
    v_add_f32 v25, v10, v17
    v_sub_f32 v17, v10, v17
    v_add_f32 v10, v11, v16
    v_sub_f32 v16, v11, v16
    v_add_f32 v11, v50, v19
    v_sub_f32 v19, v50, v19
    v_add_f32 v50, v51, v18
    v_sub_f32 v18, v51, v18
    v_add_f32 v51, v13, v21
    v_sub_f32 v21, v13, v21
    v_add_f32 v13, v12, v20
    v_sub_f32 v20, v12, v20
    v_add_f32 v12, v15, v23
    v_sub_f32 v23, v15, v23
    v_add_f32 v15, v14, v22
    v_sub_f32 v22, v14, v22
    v_add_f32 v14, v25, v51
    v_sub_f32 v51, v25, v51
    v_add_f32 v25, v10, v13
    v_sub_f32 v13, v10, v13
    v_add_f32 v10, v11, v12
    v_sub_f32 v12, v11, v12
    v_add_f32 v11, v50, v15
    v_sub_f32 v15, v50, v15
    v_add_f32 v50, v14, v10
    v_sub_f32 v10, v14, v10
    v_add_f32 v14, v25, v11
    v_sub_f32 v11, v25, v11
    v_add_f32 v25, v51, v15
    v_sub_f32 v15, v51, v15
    v_sub_f32 v51, v13, v12
    v_add_f32 v12, v13, v12
    v_add_f32 v13, v19, v18
    v_sub_f32 v18, v18, v19
    v_mul_f32 v13, 0x3f3504f3, v13
    v_mul_f32 v18, 0x3f3504f3, v18
    v_sub_f32 v19, v22, v23
    v_add_f32 v22, v23, v22
    v_mul_f32 v19, 0x3f3504f3, v19
    v_mul_f32 v22, 0x3f3504f3, v22
    v_add_f32 v23, v17, v20
    v_sub_f32 v20, v17, v20
    v_sub_f32 v17, v16, v21
    v_add_f32 v21, v16, v21
    v_add_f32 v16, v13, v19
    v_sub_f32 v19, v13, v19
    v_sub_f32 v13, v18, v22
    v_add_f32 v22, v18, v22
    v_add_f32 v18, v23, v16
    v_sub_f32 v16, v23, v16
    v_add_f32 v23, v17, v13
    v_sub_f32 v13, v17, v13
    v_add_f32 v17, v20, v22
    v_sub_f32 v22, v20, v22
    v_sub_f32 v20, v21, v19
    v_add_f32 v19, v21, v19
    v_lshl_add_u32 v44, v43, 3, v49
    ds_write_b32 v44, v50 offset:0
    ds_write_b32 v44, v14 offset:4
    ds_write_b32 v44, v18 offset:72
    ds_write_b32 v44, v23 offset:76
    ds_write_b32 v44, v25 offset:144
    ds_write_b32 v44, v51 offset:148
    ds_write_b32 v44, v17 offset:216
    ds_write_b32 v44, v20 offset:220
    ds_write_b32 v44, v10 offset:288
    ds_write_b32 v44, v11 offset:292
    ds_write_b32 v44, v16 offset:360
    ds_write_b32 v44, v13 offset:364
    ds_write_b32 v44, v15 offset:432
    ds_write_b32 v44, v12 offset:436
    ds_write_b32 v44, v22 offset:504
    ds_write_b32 v44, v19 offset:508
    s_waitcnt lgkmcnt(0)
    s_mov_b64 exec, 0xff
    v_add_u32 v8, 64, v1
    v_mul_u32_u24 v40, 57, v8
    v_lshrrev_b32 v40, 9, v40
    v_mul_u32_u24 v41, 9, v40
    v_sub_u32 v41, v8, v41
    v_cvt_f32_u32 v42, v41
    v_mul_u32_u24 v43, 72, v40
    v_add_u32 v43, v43, v41
    v_lshl_add_u32 v44, v8, 3, v6
    ds_read_b64 v[10:11], v44 offset:0
    ds_read_b64 v[12:13], v44 offset:576
    ds_read_b64 v[14:15], v44 offset:1152
    ds_read_b64 v[16:17], v44 offset:1728
    ds_read_b64 v[18:19], v44 offset:2304
    ds_read_b64 v[20:21], v44 offset:2880
    ds_read_b64 v[22:23], v44 offset:3456
    ds_read_b64 v[24:25], v44 offset:4032
    v_mul_f32 v45, 0xbc638e39, v42
    v_cos_f32 v26, v45
    v_sin_f32 v27, v45
    v_mul_f32 v45, 0xbce38e39, v42
    v_cos_f32 v28, v45
    v_sin_f32 v29, v45
    v_mul_f32 v45, 0xbd2aaaab, v42
    v_cos_f32 v30, v45
    v_sin_f32 v31, v45
    v_mul_f32 v45, 0xbd638e39, v42
    v_cos_f32 v32, v45
    v_sin_f32 v33, v45
    v_mul_f32 v45, 0xbd8e38e4, v42
    v_cos_f32 v34, v45
    v_sin_f32 v35, v45
    v_mul_f32 v45, 0xbdaaaaab, v42
    v_cos_f32 v36, v45
    v_sin_f32 v37, v45
    v_mul_f32 v45, 0xbdc71c72, v42
    v_cos_f32 v38, v45
    v_sin_f32 v39, v45
    s_waitcnt lgkmcnt(0)
    v_mul_f32_e64 v50, v12, v26
    v_mul_f32_e64 v51, v12, v27
    v_fma_f32 v50, -v13, v27, v50
    v_fma_f32 v51, v13, v26, v51
    v_mul_f32_e64 v13, v14, v28
    v_mul_f32_e64 v12, v14, v29
    v_fma_f32 v13, -v15, v29, v13
    v_fma_f32 v12, v15, v28, v12
    v_mul_f32_e64 v15, v16, v30
    v_mul_f32_e64 v14, v16, v31
    v_fma_f32 v15, -v17, v31, v15
    v_fma_f32 v14, v17, v30, v14
    v_mul_f32_e64 v17, v18, v32
    v_mul_f32_e64 v16, v18, v33
    v_fma_f32 v17, -v19, v33, v17
    v_fma_f32 v16, v19, v32, v16
    v_mul_f32_e64 v19, v20, v34
    v_mul_f32_e64 v18, v20, v35
    v_fma_f32 v19, -v21, v35, v19
    v_fma_f32 v18, v21, v34, v18
    v_mul_f32_e64 v21, v22, v36
    v_mul_f32_e64 v20, v22, v37
    v_fma_f32 v21, -v23, v37, v21
    v_fma_f32 v20, v23, v36, v20
    v_mul_f32_e64 v23, v24, v38
    v_mul_f32_e64 v22, v24, v39
    v_fma_f32 v23, -v25, v39, v23
    v_fma_f32 v22, v25, v38, v22
    v_add_f32 v25, v10, v17
    v_sub_f32 v17, v10, v17
    v_add_f32 v10, v11, v16
    v_sub_f32 v16, v11, v16
    v_add_f32 v11, v50, v19
    v_sub_f32 v19, v50, v19
    v_add_f32 v50, v51, v18
    v_sub_f32 v18, v51, v18
    v_add_f32 v51, v13, v21
    v_sub_f32 v21, v13, v21
    v_add_f32 v13, v12, v20
    v_sub_f32 v20, v12, v20
    v_add_f32 v12, v15, v23
    v_sub_f32 v23, v15, v23
    v_add_f32 v15, v14, v22
    v_sub_f32 v22, v14, v22
    v_add_f32 v14, v25, v51
    v_sub_f32 v51, v25, v51
    v_add_f32 v25, v10, v13
    v_sub_f32 v13, v10, v13
    v_add_f32 v10, v11, v12
    v_sub_f32 v12, v11, v12
    v_add_f32 v11, v50, v15
    v_sub_f32 v15, v50, v15
    v_add_f32 v50, v14, v10
    v_sub_f32 v10, v14, v10
    v_add_f32 v14, v25, v11
    v_sub_f32 v11, v25, v11
    v_add_f32 v25, v51, v15
    v_sub_f32 v15, v51, v15
    v_sub_f32 v51, v13, v12
    v_add_f32 v12, v13, v12
    v_add_f32 v13, v19, v18
    v_sub_f32 v18, v18, v19
    v_mul_f32 v13, 0x3f3504f3, v13
    v_mul_f32 v18, 0x3f3504f3, v18
    v_sub_f32 v19, v22, v23
    v_add_f32 v22, v23, v22
    v_mul_f32 v19, 0x3f3504f3, v19
    v_mul_f32 v22, 0x3f3504f3, v22
    v_add_f32 v23, v17, v20
    v_sub_f32 v20, v17, v20
    v_sub_f32 v17, v16, v21
    v_add_f32 v21, v16, v21
    v_add_f32 v16, v13, v19
    v_sub_f32 v19, v13, v19
    v_sub_f32 v13, v18, v22
    v_add_f32 v22, v18, v22
    v_add_f32 v18, v23, v16
    v_sub_f32 v16, v23, v16
    v_add_f32 v23, v17, v13
    v_sub_f32 v13, v17, v13
    v_add_f32 v17, v20, v22
    v_sub_f32 v22, v20, v22
    v_sub_f32 v20, v21, v19
    v_add_f32 v19, v21, v19
    v_lshl_add_u32 v44, v43, 3, v49
    ds_write_b32 v44, v50 offset:0
    ds_write_b32 v44, v14 offset:4
    ds_write_b32 v44, v18 offset:72
    ds_write_b32 v44, v23 offset:76
    ds_write_b32 v44, v25 offset:144
    ds_write_b32 v44, v51 offset:148
    ds_write_b32 v44, v17 offset:216
    ds_write_b32 v44, v20 offset:220
    ds_write_b32 v44, v10 offset:288
    ds_write_b32 v44, v11 offset:292
    ds_write_b32 v44, v16 offset:360
    ds_write_b32 v44, v13 offset:364
    ds_write_b32 v44, v15 offset:432
    ds_write_b32 v44, v12 offset:436
    ds_write_b32 v44, v22 offset:504
    ds_write_b32 v44, v19 offset:508
    s_waitcnt lgkmcnt(0)
    s_mov_b64 exec, -1
    v_mov_b32 v8, v1
    v_cvt_f32_u32 v42, v8
    v_mov_b32 v43, v8
    v_lshl_add_u32 v44, v8, 3, v49
    ds_read_b64 v[10:11], v44 offset:0
    ds_read_b64 v[12:13], v44 offset:576
    ds_read_b64 v[14:15], v44 offset:1152
    ds_read_b64 v[16:17], v44 offset:1728
    ds_read_b64 v[18:19], v44 offset:2304
    ds_read_b64 v[20:21], v44 offset:2880
    ds_read_b64 v[22:23], v44 offset:3456
    ds_read_b64 v[24:25], v44 offset:4032
    v_mul_f32 v45, 0xbae38e39, v42
    v_cos_f32 v26, v45
    v_sin_f32 v27, v45
    v_mul_f32 v45, 0xbb638e39, v42
    v_cos_f32 v28, v45
    v_sin_f32 v29, v45
    v_mul_f32 v45, 0xbbaaaaab, v42
    v_cos_f32 v30, v45
    v_sin_f32 v31, v45
    v_mul_f32 v45, 0xbbe38e39, v42
    v_cos_f32 v32, v45
    v_sin_f32 v33, v45
    v_mul_f32 v45, 0xbc0e38e4, v42
    v_cos_f32 v34, v45
    v_sin_f32 v35, v45
    v_mul_f32 v45, 0xbc2aaaab, v42
    v_cos_f32 v36, v45
    v_sin_f32 v37, v45
    v_mul_f32 v45, 0xbc471c72, v42
    v_cos_f32 v38, v45
    v_sin_f32 v39, v45
    s_waitcnt lgkmcnt(0)
    v_mul_f32_e64 v50, v12, v26
    v_mul_f32_e64 v51, v12, v27
    v_fma_f32 v50, -v13, v27, v50
    v_fma_f32 v51, v13, v26, v51
    v_mul_f32_e64 v13, v14, v28
    v_mul_f32_e64 v12, v14, v29
    v_fma_f32 v13, -v15, v29, v13
    v_fma_f32 v12, v15, v28, v12
    v_mul_f32_e64 v15, v16, v30
    v_mul_f32_e64 v14, v16, v31
    v_fma_f32 v15, -v17, v31, v15
    v_fma_f32 v14, v17, v30, v14
    v_mul_f32_e64 v17, v18, v32
    v_mul_f32_e64 v16, v18, v33
    v_fma_f32 v17, -v19, v33, v17
    v_fma_f32 v16, v19, v32, v16
    v_mul_f32_e64 v19, v20, v34
    v_mul_f32_e64 v18, v20, v35
    v_fma_f32 v19, -v21, v35, v19
    v_fma_f32 v18, v21, v34, v18
    v_mul_f32_e64 v21, v22, v36
    v_mul_f32_e64 v20, v22, v37
    v_fma_f32 v21, -v23, v37, v21
    v_fma_f32 v20, v23, v36, v20
    v_mul_f32_e64 v23, v24, v38
    v_mul_f32_e64 v22, v24, v39
    v_fma_f32 v23, -v25, v39, v23
    v_fma_f32 v22, v25, v38, v22
    v_add_f32 v25, v10, v17
    v_sub_f32 v17, v10, v17
    v_add_f32 v10, v11, v16
    v_sub_f32 v16, v11, v16
    v_add_f32 v11, v50, v19
    v_sub_f32 v19, v50, v19
    v_add_f32 v50, v51, v18
    v_sub_f32 v18, v51, v18
    v_add_f32 v51, v13, v21
    v_sub_f32 v21, v13, v21
    v_add_f32 v13, v12, v20
    v_sub_f32 v20, v12, v20
    v_add_f32 v12, v15, v23
    v_sub_f32 v23, v15, v23
    v_add_f32 v15, v14, v22
    v_sub_f32 v22, v14, v22
    v_add_f32 v14, v25, v51
    v_sub_f32 v51, v25, v51
    v_add_f32 v25, v10, v13
    v_sub_f32 v13, v10, v13
    v_add_f32 v10, v11, v12
    v_sub_f32 v12, v11, v12
    v_add_f32 v11, v50, v15
    v_sub_f32 v15, v50, v15
    v_add_f32 v50, v14, v10
    v_sub_f32 v10, v14, v10
    v_add_f32 v14, v25, v11
    v_sub_f32 v11, v25, v11
    v_add_f32 v25, v51, v15
    v_sub_f32 v15, v51, v15
    v_sub_f32 v51, v13, v12
    v_add_f32 v12, v13, v12
    v_add_f32 v13, v19, v18
    v_sub_f32 v18, v18, v19
    v_mul_f32 v13, 0x3f3504f3, v13
    v_mul_f32 v18, 0x3f3504f3, v18
    v_sub_f32 v19, v22, v23
    v_add_f32 v22, v23, v22
    v_mul_f32 v19, 0x3f3504f3, v19
    v_mul_f32 v22, 0x3f3504f3, v22
    v_add_f32 v23, v17, v20
    v_sub_f32 v20, v17, v20
    v_sub_f32 v17, v16, v21
    v_add_f32 v21, v16, v21
    v_add_f32 v16, v13, v19
    v_sub_f32 v19, v13, v19
    v_sub_f32 v13, v18, v22
    v_add_f32 v22, v18, v22
    v_add_f32 v18, v23, v16
    v_sub_f32 v16, v23, v16
    v_add_f32 v23, v17, v13
    v_sub_f32 v13, v17, v13
    v_add_f32 v17, v20, v22
    v_sub_f32 v22, v20, v22
    v_sub_f32 v20, v21, v19
    v_add_f32 v19, v21, v19
    v_lshl_add_u32 v44, v43, 3, v6
    ds_write_b32 v44, v50 offset:0
    ds_write_b32 v44, v14 offset:4
    ds_write_b32 v44, v18 offset:576
    ds_write_b32 v44, v23 offset:580
    ds_write_b32 v44, v25 offset:1152
    ds_write_b32 v44, v51 offset:1156
    ds_write_b32 v44, v17 offset:1728
    ds_write_b32 v44, v20 offset:1732
    ds_write_b32 v44, v10 offset:2304
    ds_write_b32 v44, v11 offset:2308
    ds_write_b32 v44, v16 offset:2880
    ds_write_b32 v44, v13 offset:2884
    ds_write_b32 v44, v15 offset:3456
    ds_write_b32 v44, v12 offset:3460
    ds_write_b32 v44, v22 offset:4032
    ds_write_b32 v44, v19 offset:4036
    s_waitcnt lgkmcnt(0)
    s_mov_b64 exec, 0xff
    v_add_u32 v8, 64, v1
    v_cvt_f32_u32 v42, v8
    v_mov_b32 v43, v8
    v_lshl_add_u32 v44, v8, 3, v49
    ds_read_b64 v[10:11], v44 offset:0
    ds_read_b64 v[12:13], v44 offset:576
    ds_read_b64 v[14:15], v44 offset:1152
    ds_read_b64 v[16:17], v44 offset:1728
    ds_read_b64 v[18:19], v44 offset:2304
    ds_read_b64 v[20:21], v44 offset:2880
    ds_read_b64 v[22:23], v44 offset:3456
    ds_read_b64 v[24:25], v44 offset:4032
    v_mul_f32 v45, 0xbae38e39, v42
    v_cos_f32 v26, v45
    v_sin_f32 v27, v45
    v_mul_f32 v45, 0xbb638e39, v42
    v_cos_f32 v28, v45
    v_sin_f32 v29, v45
    v_mul_f32 v45, 0xbbaaaaab, v42
    v_cos_f32 v30, v45
    v_sin_f32 v31, v45
    v_mul_f32 v45, 0xbbe38e39, v42
    v_cos_f32 v32, v45
    v_sin_f32 v33, v45
    v_mul_f32 v45, 0xbc0e38e4, v42
    v_cos_f32 v34, v45
    v_sin_f32 v35, v45
    v_mul_f32 v45, 0xbc2aaaab, v42
    v_cos_f32 v36, v45
    v_sin_f32 v37, v45
    v_mul_f32 v45, 0xbc471c72, v42
    v_cos_f32 v38, v45
    v_sin_f32 v39, v45
    s_waitcnt lgkmcnt(0)
    v_mul_f32_e64 v50, v12, v26
    v_mul_f32_e64 v51, v12, v27
    v_fma_f32 v50, -v13, v27, v50
    v_fma_f32 v51, v13, v26, v51
    v_mul_f32_e64 v13, v14, v28
    v_mul_f32_e64 v12, v14, v29
    v_fma_f32 v13, -v15, v29, v13
    v_fma_f32 v12, v15, v28, v12
    v_mul_f32_e64 v15, v16, v30
    v_mul_f32_e64 v14, v16, v31
    v_fma_f32 v15, -v17, v31, v15
    v_fma_f32 v14, v17, v30, v14
    v_mul_f32_e64 v17, v18, v32
    v_mul_f32_e64 v16, v18, v33
    v_fma_f32 v17, -v19, v33, v17
    v_fma_f32 v16, v19, v32, v16
    v_mul_f32_e64 v19, v20, v34
    v_mul_f32_e64 v18, v20, v35
    v_fma_f32 v19, -v21, v35, v19
    v_fma_f32 v18, v21, v34, v18
    v_mul_f32_e64 v21, v22, v36
    v_mul_f32_e64 v20, v22, v37
    v_fma_f32 v21, -v23, v37, v21
    v_fma_f32 v20, v23, v36, v20
    v_mul_f32_e64 v23, v24, v38
    v_mul_f32_e64 v22, v24, v39
    v_fma_f32 v23, -v25, v39, v23
    v_fma_f32 v22, v25, v38, v22
    v_add_f32 v25, v10, v17
    v_sub_f32 v17, v10, v17
    v_add_f32 v10, v11, v16
    v_sub_f32 v16, v11, v16
    v_add_f32 v11, v50, v19
    v_sub_f32 v19, v50, v19
    v_add_f32 v50, v51, v18
    v_sub_f32 v18, v51, v18
    v_add_f32 v51, v13, v21
    v_sub_f32 v21, v13, v21
    v_add_f32 v13, v12, v20
    v_sub_f32 v20, v12, v20
    v_add_f32 v12, v15, v23
    v_sub_f32 v23, v15, v23
    v_add_f32 v15, v14, v22
    v_sub_f32 v22, v14, v22
    v_add_f32 v14, v25, v51
    v_sub_f32 v51, v25, v51
    v_add_f32 v25, v10, v13
    v_sub_f32 v13, v10, v13
    v_add_f32 v10, v11, v12
    v_sub_f32 v12, v11, v12
    v_add_f32 v11, v50, v15
    v_sub_f32 v15, v50, v15
    v_add_f32 v50, v14, v10
    v_sub_f32 v10, v14, v10
    v_add_f32 v14, v25, v11
    v_sub_f32 v11, v25, v11
    v_add_f32 v25, v51, v15
    v_sub_f32 v15, v51, v15
    v_sub_f32 v51, v13, v12
    v_add_f32 v12, v13, v12
    v_add_f32 v13, v19, v18
    v_sub_f32 v18, v18, v19
    v_mul_f32 v13, 0x3f3504f3, v13
    v_mul_f32 v18, 0x3f3504f3, v18
    v_sub_f32 v19, v22, v23
    v_add_f32 v22, v23, v22
    v_mul_f32 v19, 0x3f3504f3, v19
    v_mul_f32 v22, 0x3f3504f3, v22
    v_add_f32 v23, v17, v20
    v_sub_f32 v20, v17, v20
    v_sub_f32 v17, v16, v21
    v_add_f32 v21, v16, v21
    v_add_f32 v16, v13, v19
    v_sub_f32 v19, v13, v19
    v_sub_f32 v13, v18, v22
    v_add_f32 v22, v18, v22
    v_add_f32 v18, v23, v16
    v_sub_f32 v16, v23, v16
    v_add_f32 v23, v17, v13
    v_sub_f32 v13, v17, v13
    v_add_f32 v17, v20, v22
    v_sub_f32 v22, v20, v22
    v_sub_f32 v20, v21, v19
    v_add_f32 v19, v21, v19
    v_lshl_add_u32 v44, v43, 3, v6
    ds_write_b32 v44, v50 offset:0
    ds_write_b32 v44, v14 offset:4
    ds_write_b32 v44, v18 offset:576
    ds_write_b32 v44, v23 offset:580
    ds_write_b32 v44, v25 offset:1152
    ds_write_b32 v44, v51 offset:1156
    ds_write_b32 v44, v17 offset:1728
    ds_write_b32 v44, v20 offset:1732
    ds_write_b32 v44, v10 offset:2304
    ds_write_b32 v44, v11 offset:2308
    ds_write_b32 v44, v16 offset:2880
    ds_write_b32 v44, v13 offset:2884
    ds_write_b32 v44, v15 offset:3456
    ds_write_b32 v44, v12 offset:3460
    ds_write_b32 v44, v22 offset:4032
    ds_write_b32 v44, v19 offset:4036
    s_waitcnt lgkmcnt(0)
    s_mov_b64 exec, -1
    s_lshl_b32 s12, s2, 3
    v_lshl_add_u32 v9, v2, 1, s12
    v_lshlrev_b32 v9, 3, v9
    s_add_u32 s14, s6, 4194304
    s_addc_u32 s15, s7, 0
    v_add_u32 v10, 0, v1
    v_sub_u32 v11, 576, v10
    v_cmp_eq_u32 vcc, 0, v10
    s_nop 1
    v_cndmask_b32_e64 v11, v11, 0, vcc
    v_lshl_add_u32 v12, v10, 3, v6
    v_lshl_add_u32 v13, v11, 3, v6
    ds_read_b64 v[14:15], v12
    ds_read_b64 v[16:17], v13
    s_waitcnt lgkmcnt(0)
    v_add_f32 v18, v14, v16
    v_sub_f32 v19, v15, v17
    v_add_f32 v20, v15, v17
    v_sub_f32 v21, v16, v14
    v_mul_f32 v18, 0.5, v18
    v_mul_f32 v19, 0.5, v19
    v_mul_f32 v20, 0.5, v20
    v_mul_f32 v21, 0.5, v21
    v_lshlrev_b32 v22, 14, v10
    v_add_u32 v22, v22, v9
    global_store_dwordx4 v22, v[18:21], s[14:15]
    v_add_u32 v10, 64, v1
    v_sub_u32 v11, 576, v10
    v_cmp_eq_u32 vcc, 0, v10
    s_nop 1
    v_cndmask_b32_e64 v11, v11, 0, vcc
    v_lshl_add_u32 v12, v10, 3, v6
    v_lshl_add_u32 v13, v11, 3, v6
    ds_read_b64 v[14:15], v12
    ds_read_b64 v[16:17], v13
    s_waitcnt lgkmcnt(0)
    v_add_f32 v18, v14, v16
    v_sub_f32 v19, v15, v17
    v_add_f32 v20, v15, v17
    v_sub_f32 v21, v16, v14
    v_mul_f32 v18, 0.5, v18
    v_mul_f32 v19, 0.5, v19
    v_mul_f32 v20, 0.5, v20
    v_mul_f32 v21, 0.5, v21
    v_lshlrev_b32 v22, 14, v10
    v_add_u32 v22, v22, v9
    global_store_dwordx4 v22, v[18:21], s[14:15]
    v_add_u32 v10, 128, v1
    v_sub_u32 v11, 576, v10
    v_cmp_eq_u32 vcc, 0, v10
    s_nop 1
    v_cndmask_b32_e64 v11, v11, 0, vcc
    v_lshl_add_u32 v12, v10, 3, v6
    v_lshl_add_u32 v13, v11, 3, v6
    ds_read_b64 v[14:15], v12
    ds_read_b64 v[16:17], v13
    s_waitcnt lgkmcnt(0)
    v_add_f32 v18, v14, v16
    v_sub_f32 v19, v15, v17
    v_add_f32 v20, v15, v17
    v_sub_f32 v21, v16, v14
    v_mul_f32 v18, 0.5, v18
    v_mul_f32 v19, 0.5, v19
    v_mul_f32 v20, 0.5, v20
    v_mul_f32 v21, 0.5, v21
    v_lshlrev_b32 v22, 14, v10
    v_add_u32 v22, v22, v9
    global_store_dwordx4 v22, v[18:21], s[14:15]
    v_add_u32 v10, 192, v1
    v_sub_u32 v11, 576, v10
    v_cmp_eq_u32 vcc, 0, v10
    s_nop 1
    v_cndmask_b32_e64 v11, v11, 0, vcc
    v_lshl_add_u32 v12, v10, 3, v6
    v_lshl_add_u32 v13, v11, 3, v6
    ds_read_b64 v[14:15], v12
    ds_read_b64 v[16:17], v13
    s_waitcnt lgkmcnt(0)
    v_add_f32 v18, v14, v16
    v_sub_f32 v19, v15, v17
    v_add_f32 v20, v15, v17
    v_sub_f32 v21, v16, v14
    v_mul_f32 v18, 0.5, v18
    v_mul_f32 v19, 0.5, v19
    v_mul_f32 v20, 0.5, v20
    v_mul_f32 v21, 0.5, v21
    v_lshlrev_b32 v22, 14, v10
    v_add_u32 v22, v22, v9
    global_store_dwordx4 v22, v[18:21], s[14:15]
    v_add_u32 v10, 256, v1
    v_sub_u32 v11, 576, v10
    v_cmp_eq_u32 vcc, 0, v10
    s_nop 1
    v_cndmask_b32_e64 v11, v11, 0, vcc
    v_lshl_add_u32 v12, v10, 3, v6
    v_lshl_add_u32 v13, v11, 3, v6
    ds_read_b64 v[14:15], v12
    ds_read_b64 v[16:17], v13
    s_waitcnt lgkmcnt(0)
    v_add_f32 v18, v14, v16
    v_sub_f32 v19, v15, v17
    v_add_f32 v20, v15, v17
    v_sub_f32 v21, v16, v14
    v_mul_f32 v18, 0.5, v18
    v_mul_f32 v19, 0.5, v19
    v_mul_f32 v20, 0.5, v20
    v_mul_f32 v21, 0.5, v21
    v_lshlrev_b32 v22, 14, v10
    v_add_u32 v22, v22, v9
    v_cmp_gt_u32 vcc, 289, v10
    s_and_saveexec_b64 s[22:23], vcc
    global_store_dwordx4 v22, v[18:21], s[14:15]
    s_mov_b64 exec, s[22:23]
    s_waitcnt vmcnt(0)
Lk2_end:
    s_endpgm
.globl k3_colfft_kernel
.p2align 8
.type k3_colfft_kernel,@function
k3_colfft_kernel:
    s_cmp_ge_u32 s2, 289
    s_cbranch_scc1 Lk3_end
    s_load_dwordx2 s[6:7], s[0:1], 80
    v_lshlrev_b32 v1, 3, v0
    s_lshl_b32 s8, s2, 14
    s_waitcnt lgkmcnt(0)
    s_add_u32 s10, s6, 4194304
    s_addc_u32 s11, s7, 0
    s_add_u32 s10, s10, s8
    s_addc_u32 s11, s11, 0
    s_add_u32 s12, s6, 9437184
    s_addc_u32 s13, s7, 0
    s_add_u32 s12, s12, s8
    s_addc_u32 s13, s13, 0
    s_lshl_b32 s9, s2, 13
    s_add_u32 s14, s6, 1048576
    s_addc_u32 s15, s7, 0
    s_add_u32 s14, s14, s9
    s_addc_u32 s15, s15, 0
    v_add_u32 v120, 0, v1
    v_add_u32 v121, 4096, v1
    v_add_u32 v122, 8192, v1
    v_add_u32 v123, 12288, v1
    global_load_dwordx2 v[10:11], v120, s[10:11] offset:0
    global_load_dwordx2 v[12:13], v120, s[10:11] offset:2048
    global_load_dwordx2 v[14:15], v121, s[10:11] offset:0
    global_load_dwordx2 v[16:17], v121, s[10:11] offset:2048
    global_load_dwordx2 v[18:19], v122, s[10:11] offset:0
    global_load_dwordx2 v[20:21], v122, s[10:11] offset:2048
    global_load_dwordx2 v[22:23], v123, s[10:11] offset:0
    global_load_dwordx2 v[24:25], v123, s[10:11] offset:2048
    v_lshlrev_b32 v2, 2, v0
    v_add_u32 v3, 4096, v2
    global_load_dword v26, v2, s[14:15] offset:0
    global_load_dword v27, v2, s[14:15] offset:2048
    global_load_dword v28, v3, s[14:15] offset:0
    global_load_dword v29, v3, s[14:15] offset:2048
    global_load_dword v30, v2, s[14:15] offset:1024
    global_load_dword v31, v2, s[14:15] offset:3072
    global_load_dword v32, v3, s[14:15] offset:1024
    global_load_dword v33, v3, s[14:15] offset:3072
    v_cvt_f32_u32 v4, v0
    v_and_b32 v5, 7, v0
    v_cvt_f32_u32 v5, v5
    v_and_b32 v6, 63, v0
    v_cvt_f32_u32 v6, v6
    v_lshlrev_b32 v7, 6, v0
    v_lshrrev_b32 v8, 3, v0
    v_lshlrev_b32 v8, 6, v8
    v_and_b32 v9, 7, v0
    v_add_u32 v8, v8, v9
    v_lshlrev_b32 v8, 3, v8
    v_lshrrev_b32 v9, 6, v0
    v_lshlrev_b32 v9, 9, v9
    v_and_b32 v48, 63, v0
    v_add_u32 v9, v9, v48
    v_lshlrev_b32 v9, 3, v9
    s_waitcnt vmcnt(8)
    v_add_f32 v50, v10, v18
    v_sub_f32 v18, v10, v18
    v_add_f32 v10, v11, v19
    v_sub_f32 v19, v11, v19
    v_add_f32 v11, v12, v20
    v_sub_f32 v20, v12, v20
    v_add_f32 v12, v13, v21
    v_sub_f32 v21, v13, v21
    v_add_f32 v13, v14, v22
    v_sub_f32 v22, v14, v22
    v_add_f32 v14, v15, v23
    v_sub_f32 v23, v15, v23
    v_add_f32 v15, v16, v24
    v_sub_f32 v24, v16, v24
    v_add_f32 v16, v17, v25
    v_sub_f32 v25, v17, v25
    v_add_f32 v17, v50, v13
    v_sub_f32 v13, v50, v13
    v_add_f32 v50, v10, v14
    v_sub_f32 v14, v10, v14
    v_add_f32 v10, v11, v15
    v_sub_f32 v15, v11, v15
    v_add_f32 v11, v12, v16
    v_sub_f32 v16, v12, v16
    v_add_f32 v12, v17, v10
    v_sub_f32 v10, v17, v10
    v_add_f32 v17, v50, v11
    v_sub_f32 v11, v50, v11
    v_add_f32 v50, v13, v16
    v_sub_f32 v16, v13, v16
    v_sub_f32 v13, v14, v15
    v_add_f32 v15, v14, v15
    v_add_f32 v14, v20, v21
    v_sub_f32 v21, v21, v20
    v_mul_f32 v14, 0x3f3504f3, v14
    v_mul_f32 v21, 0x3f3504f3, v21
    v_sub_f32 v20, v25, v24
    v_add_f32 v25, v24, v25
    v_mul_f32 v20, 0x3f3504f3, v20
    v_mul_f32 v25, 0x3f3504f3, v25
    v_add_f32 v24, v18, v23
    v_sub_f32 v23, v18, v23
    v_sub_f32 v18, v19, v22
    v_add_f32 v22, v19, v22
    v_add_f32 v19, v14, v20
    v_sub_f32 v20, v14, v20
    v_sub_f32 v14, v21, v25
    v_add_f32 v25, v21, v25
    v_add_f32 v21, v24, v19
    v_sub_f32 v19, v24, v19
    v_add_f32 v24, v18, v14
    v_sub_f32 v14, v18, v14
    v_add_f32 v18, v23, v25
    v_sub_f32 v25, v23, v25
    v_sub_f32 v23, v22, v20
    v_add_f32 v20, v22, v20
    ds_write_b32 v7, v12 offset:0
    ds_write_b32 v7, v17 offset:4
    ds_write_b32 v7, v21 offset:8
    ds_write_b32 v7, v24 offset:12
    ds_write_b32 v7, v50 offset:16
    ds_write_b32 v7, v13 offset:20
    ds_write_b32 v7, v18 offset:24
    ds_write_b32 v7, v23 offset:28
    ds_write_b32 v7, v10 offset:32
    ds_write_b32 v7, v11 offset:36
    ds_write_b32 v7, v19 offset:40
    ds_write_b32 v7, v14 offset:44
    ds_write_b32 v7, v16 offset:48
    ds_write_b32 v7, v15 offset:52
    ds_write_b32 v7, v25 offset:56
    ds_write_b32 v7, v20 offset:60
    s_waitcnt lgkmcnt(0)
    s_barrier
    ds_read_b64 v[10:11], v1 offset:0
    ds_read_b64 v[12:13], v1 offset:2048
    ds_read_b64 v[14:15], v1 offset:4096
    ds_read_b64 v[16:17], v1 offset:6144
    ds_read_b64 v[18:19], v1 offset:8192
    ds_read_b64 v[20:21], v1 offset:10240
    ds_read_b64 v[22:23], v1 offset:12288
    ds_read_b64 v[24:25], v1 offset:14336
    v_mul_f32 v49, 0xbc800000, v5
    v_cos_f32 v34, v49
    v_sin_f32 v35, v49
    v_mul_f32 v49, 0xbd000000, v5
    v_cos_f32 v36, v49
    v_sin_f32 v37, v49
    v_mul_f32 v49, 0xbd400000, v5
    v_cos_f32 v38, v49
    v_sin_f32 v39, v49
    v_mul_f32 v49, 0xbd800000, v5
    v_cos_f32 v40, v49
    v_sin_f32 v41, v49
    v_mul_f32 v49, 0xbda00000, v5
    v_cos_f32 v42, v49
    v_sin_f32 v43, v49
    v_mul_f32 v49, 0xbdc00000, v5
    v_cos_f32 v44, v49
    v_sin_f32 v45, v49
    v_mul_f32 v49, 0xbde00000, v5
    v_cos_f32 v46, v49
    v_sin_f32 v47, v49
    s_waitcnt lgkmcnt(0)
    v_mul_f32_e64 v50, v12, v34
    v_mul_f32_e64 v51, v12, v35
    v_fma_f32 v50, -v13, v35, v50
    v_fma_f32 v51, v13, v34, v51
    v_mul_f32_e64 v13, v14, v36
    v_mul_f32_e64 v12, v14, v37
    v_fma_f32 v13, -v15, v37, v13
    v_fma_f32 v12, v15, v36, v12
    v_mul_f32_e64 v15, v16, v38
    v_mul_f32_e64 v14, v16, v39
    v_fma_f32 v15, -v17, v39, v15
    v_fma_f32 v14, v17, v38, v14
    v_mul_f32_e64 v17, v18, v40
    v_mul_f32_e64 v16, v18, v41
    v_fma_f32 v17, -v19, v41, v17
    v_fma_f32 v16, v19, v40, v16
    v_mul_f32_e64 v19, v20, v42
    v_mul_f32_e64 v18, v20, v43
    v_fma_f32 v19, -v21, v43, v19
    v_fma_f32 v18, v21, v42, v18
    v_mul_f32_e64 v21, v22, v44
    v_mul_f32_e64 v20, v22, v45
    v_fma_f32 v21, -v23, v45, v21
    v_fma_f32 v20, v23, v44, v20
    v_mul_f32_e64 v23, v24, v46
    v_mul_f32_e64 v22, v24, v47
    v_fma_f32 v23, -v25, v47, v23
    v_fma_f32 v22, v25, v46, v22
    v_add_f32 v25, v10, v17
    v_sub_f32 v17, v10, v17
    v_add_f32 v10, v11, v16
    v_sub_f32 v16, v11, v16
    v_add_f32 v11, v50, v19
    v_sub_f32 v19, v50, v19
    v_add_f32 v50, v51, v18
    v_sub_f32 v18, v51, v18
    v_add_f32 v51, v13, v21
    v_sub_f32 v21, v13, v21
    v_add_f32 v13, v12, v20
    v_sub_f32 v20, v12, v20
    v_add_f32 v12, v15, v23
    v_sub_f32 v23, v15, v23
    v_add_f32 v15, v14, v22
    v_sub_f32 v22, v14, v22
    v_add_f32 v14, v25, v51
    v_sub_f32 v51, v25, v51
    v_add_f32 v25, v10, v13
    v_sub_f32 v13, v10, v13
    v_add_f32 v10, v11, v12
    v_sub_f32 v12, v11, v12
    v_add_f32 v11, v50, v15
    v_sub_f32 v15, v50, v15
    v_add_f32 v50, v14, v10
    v_sub_f32 v10, v14, v10
    v_add_f32 v14, v25, v11
    v_sub_f32 v11, v25, v11
    v_add_f32 v25, v51, v15
    v_sub_f32 v15, v51, v15
    v_sub_f32 v51, v13, v12
    v_add_f32 v12, v13, v12
    v_add_f32 v13, v19, v18
    v_sub_f32 v18, v18, v19
    v_mul_f32 v13, 0x3f3504f3, v13
    v_mul_f32 v18, 0x3f3504f3, v18
    v_sub_f32 v19, v22, v23
    v_add_f32 v22, v23, v22
    v_mul_f32 v19, 0x3f3504f3, v19
    v_mul_f32 v22, 0x3f3504f3, v22
    v_add_f32 v23, v17, v20
    v_sub_f32 v20, v17, v20
    v_sub_f32 v17, v16, v21
    v_add_f32 v21, v16, v21
    v_add_f32 v16, v13, v19
    v_sub_f32 v19, v13, v19
    v_sub_f32 v13, v18, v22
    v_add_f32 v22, v18, v22
    v_add_f32 v18, v23, v16
    v_sub_f32 v16, v23, v16
    v_add_f32 v23, v17, v13
    v_sub_f32 v13, v17, v13
    v_add_f32 v17, v20, v22
    v_sub_f32 v22, v20, v22
    v_sub_f32 v20, v21, v19
    v_add_f32 v19, v21, v19
    ds_write_b32 v8, v50 offset:16384
    ds_write_b32 v8, v14 offset:16388
    ds_write_b32 v8, v18 offset:16448
    ds_write_b32 v8, v23 offset:16452
    ds_write_b32 v8, v25 offset:16512
    ds_write_b32 v8, v51 offset:16516
    ds_write_b32 v8, v17 offset:16576
    ds_write_b32 v8, v20 offset:16580
    ds_write_b32 v8, v10 offset:16640
    ds_write_b32 v8, v11 offset:16644
    ds_write_b32 v8, v16 offset:16704
    ds_write_b32 v8, v13 offset:16708
    ds_write_b32 v8, v15 offset:16768
    ds_write_b32 v8, v12 offset:16772
    ds_write_b32 v8, v22 offset:16832
    ds_write_b32 v8, v19 offset:16836
    s_waitcnt lgkmcnt(0)
    s_barrier
    ds_read_b64 v[10:11], v1 offset:16384
    ds_read_b64 v[12:13], v1 offset:18432
    ds_read_b64 v[14:15], v1 offset:20480
    ds_read_b64 v[16:17], v1 offset:22528
    ds_read_b64 v[18:19], v1 offset:24576
    ds_read_b64 v[20:21], v1 offset:26624
    ds_read_b64 v[22:23], v1 offset:28672
    ds_read_b64 v[24:25], v1 offset:30720
    v_mul_f32 v49, 0xbb000000, v6
    v_cos_f32 v34, v49
    v_sin_f32 v35, v49
    v_mul_f32 v49, 0xbb800000, v6
    v_cos_f32 v36, v49
    v_sin_f32 v37, v49
    v_mul_f32 v49, 0xbbc00000, v6
    v_cos_f32 v38, v49
    v_sin_f32 v39, v49
    v_mul_f32 v49, 0xbc000000, v6
    v_cos_f32 v40, v49
    v_sin_f32 v41, v49
    v_mul_f32 v49, 0xbc200000, v6
    v_cos_f32 v42, v49
    v_sin_f32 v43, v49
    v_mul_f32 v49, 0xbc400000, v6
    v_cos_f32 v44, v49
    v_sin_f32 v45, v49
    v_mul_f32 v49, 0xbc600000, v6
    v_cos_f32 v46, v49
    v_sin_f32 v47, v49
    s_waitcnt lgkmcnt(0)
    v_mul_f32_e64 v50, v12, v34
    v_mul_f32_e64 v51, v12, v35
    v_fma_f32 v50, -v13, v35, v50
    v_fma_f32 v51, v13, v34, v51
    v_mul_f32_e64 v13, v14, v36
    v_mul_f32_e64 v12, v14, v37
    v_fma_f32 v13, -v15, v37, v13
    v_fma_f32 v12, v15, v36, v12
    v_mul_f32_e64 v15, v16, v38
    v_mul_f32_e64 v14, v16, v39
    v_fma_f32 v15, -v17, v39, v15
    v_fma_f32 v14, v17, v38, v14
    v_mul_f32_e64 v17, v18, v40
    v_mul_f32_e64 v16, v18, v41
    v_fma_f32 v17, -v19, v41, v17
    v_fma_f32 v16, v19, v40, v16
    v_mul_f32_e64 v19, v20, v42
    v_mul_f32_e64 v18, v20, v43
    v_fma_f32 v19, -v21, v43, v19
    v_fma_f32 v18, v21, v42, v18
    v_mul_f32_e64 v21, v22, v44
    v_mul_f32_e64 v20, v22, v45
    v_fma_f32 v21, -v23, v45, v21
    v_fma_f32 v20, v23, v44, v20
    v_mul_f32_e64 v23, v24, v46
    v_mul_f32_e64 v22, v24, v47
    v_fma_f32 v23, -v25, v47, v23
    v_fma_f32 v22, v25, v46, v22
    v_add_f32 v25, v10, v17
    v_sub_f32 v17, v10, v17
    v_add_f32 v10, v11, v16
    v_sub_f32 v16, v11, v16
    v_add_f32 v11, v50, v19
    v_sub_f32 v19, v50, v19
    v_add_f32 v50, v51, v18
    v_sub_f32 v18, v51, v18
    v_add_f32 v51, v13, v21
    v_sub_f32 v21, v13, v21
    v_add_f32 v13, v12, v20
    v_sub_f32 v20, v12, v20
    v_add_f32 v12, v15, v23
    v_sub_f32 v23, v15, v23
    v_add_f32 v15, v14, v22
    v_sub_f32 v22, v14, v22
    v_add_f32 v14, v25, v51
    v_sub_f32 v51, v25, v51
    v_add_f32 v25, v10, v13
    v_sub_f32 v13, v10, v13
    v_add_f32 v10, v11, v12
    v_sub_f32 v12, v11, v12
    v_add_f32 v11, v50, v15
    v_sub_f32 v15, v50, v15
    v_add_f32 v50, v14, v10
    v_sub_f32 v10, v14, v10
    v_add_f32 v14, v25, v11
    v_sub_f32 v11, v25, v11
    v_add_f32 v25, v51, v15
    v_sub_f32 v15, v51, v15
    v_sub_f32 v51, v13, v12
    v_add_f32 v12, v13, v12
    v_add_f32 v13, v19, v18
    v_sub_f32 v18, v18, v19
    v_mul_f32 v13, 0x3f3504f3, v13
    v_mul_f32 v18, 0x3f3504f3, v18
    v_sub_f32 v19, v22, v23
    v_add_f32 v22, v23, v22
    v_mul_f32 v19, 0x3f3504f3, v19
    v_mul_f32 v22, 0x3f3504f3, v22
    v_add_f32 v23, v17, v20
    v_sub_f32 v20, v17, v20
    v_sub_f32 v17, v16, v21
    v_add_f32 v21, v16, v21
    v_add_f32 v16, v13, v19
    v_sub_f32 v19, v13, v19
    v_sub_f32 v13, v18, v22
    v_add_f32 v22, v18, v22
    v_add_f32 v18, v23, v16
    v_sub_f32 v16, v23, v16
    v_add_f32 v23, v17, v13
    v_sub_f32 v13, v17, v13
    v_add_f32 v17, v20, v22
    v_sub_f32 v22, v20, v22
    v_sub_f32 v20, v21, v19
    v_add_f32 v19, v21, v19
    ds_write_b32 v9, v50 offset:0
    ds_write_b32 v9, v14 offset:4
    ds_write_b32 v9, v18 offset:512
    ds_write_b32 v9, v23 offset:516
    ds_write_b32 v9, v25 offset:1024
    ds_write_b32 v9, v51 offset:1028
    ds_write_b32 v9, v17 offset:1536
    ds_write_b32 v9, v20 offset:1540
    ds_write_b32 v9, v10 offset:2048
    ds_write_b32 v9, v11 offset:2052
    ds_write_b32 v9, v16 offset:2560
    ds_write_b32 v9, v13 offset:2564
    ds_write_b32 v9, v15 offset:3072
    ds_write_b32 v9, v12 offset:3076
    ds_write_b32 v9, v22 offset:3584
    ds_write_b32 v9, v19 offset:3588
    s_waitcnt lgkmcnt(0)
    s_barrier
    ds_read_b64 v[10:11], v1 offset:0
    ds_read_b64 v[12:13], v1 offset:2048
    ds_read_b64 v[14:15], v1 offset:4096
    ds_read_b64 v[16:17], v1 offset:6144
    ds_read_b64 v[18:19], v1 offset:8192
    ds_read_b64 v[20:21], v1 offset:10240
    ds_read_b64 v[22:23], v1 offset:12288
    ds_read_b64 v[24:25], v1 offset:14336
    s_waitcnt lgkmcnt(0)
    v_mov_b32 v48, v4
    v_mul_f32 v49, 0xba000000, v48
    v_cos_f32 v34, v49
    v_sin_f32 v35, v49
    v_mul_f32 v49, 0xba800000, v48
    v_cos_f32 v36, v49
    v_sin_f32 v37, v49
    v_mul_f32 v49, 0xbac00000, v48
    v_cos_f32 v38, v49
    v_sin_f32 v39, v49
    v_mul_f32_e64 v50, v14, v34
    v_mul_f32_e64 v51, v14, v35
    v_fma_f32 v50, -v15, v35, v50
    v_fma_f32 v51, v15, v34, v51
    v_mul_f32_e64 v15, v18, v36
    v_mul_f32_e64 v14, v18, v37
    v_fma_f32 v15, -v19, v37, v15
    v_fma_f32 v14, v19, v36, v14
    v_mul_f32_e64 v19, v22, v38
    v_mul_f32_e64 v18, v22, v39
    v_fma_f32 v19, -v23, v39, v19
    v_fma_f32 v18, v23, v38, v18
    v_add_f32 v23, v10, v15
    v_sub_f32 v15, v10, v15
    v_add_f32 v10, v11, v14
    v_sub_f32 v14, v11, v14
    v_add_f32 v11, v50, v19
    v_sub_f32 v19, v50, v19
    v_add_f32 v50, v51, v18
    v_sub_f32 v18, v51, v18
    v_add_f32 v51, v23, v11
    v_sub_f32 v11, v23, v11
    v_add_f32 v23, v10, v50
    v_sub_f32 v50, v10, v50
    v_add_f32 v10, v15, v18
    v_sub_f32 v18, v15, v18
    v_sub_f32 v15, v14, v19
    v_add_f32 v19, v14, v19
    v_add_f32 v48, 0x43800000, v4
    v_mul_f32 v49, 0xba000000, v48
    v_cos_f32 v34, v49
    v_sin_f32 v35, v49
    v_mul_f32 v49, 0xba800000, v48
    v_cos_f32 v36, v49
    v_sin_f32 v37, v49
    v_mul_f32 v49, 0xbac00000, v48
    v_cos_f32 v38, v49
    v_sin_f32 v39, v49
    v_mul_f32_e64 v14, v16, v34
    v_mul_f32_e64 v22, v16, v35
    v_fma_f32 v14, -v17, v35, v14
    v_fma_f32 v22, v17, v34, v22
    v_mul_f32_e64 v17, v20, v36
    v_mul_f32_e64 v16, v20, v37
    v_fma_f32 v17, -v21, v37, v17
    v_fma_f32 v16, v21, v36, v16
    v_mul_f32_e64 v21, v24, v38
    v_mul_f32_e64 v20, v24, v39
    v_fma_f32 v21, -v25, v39, v21
    v_fma_f32 v20, v25, v38, v20
    v_add_f32 v25, v12, v17
    v_sub_f32 v17, v12, v17
    v_add_f32 v12, v13, v16
    v_sub_f32 v16, v13, v16
    v_add_f32 v13, v14, v21
    v_sub_f32 v21, v14, v21
    v_add_f32 v14, v22, v20
    v_sub_f32 v20, v22, v20
    v_add_f32 v22, v25, v13
    v_sub_f32 v13, v25, v13
    v_add_f32 v25, v12, v14
    v_sub_f32 v14, v12, v14
    v_add_f32 v12, v17, v20
    v_sub_f32 v20, v17, v20
    v_sub_f32 v17, v16, v21
    v_add_f32 v21, v16, v21
    s_waitcnt vmcnt(0)
    v_lshlrev_b32 v46, 16, v26
    v_and_b32 v47, 0xffff0000, v26
    v_mul_f32 v46, 0x35638e39, v46
    v_mul_f32 v47, 0x35638e39, v47
    v_mul_f32_e64 v16, v51, v46
    v_mul_f32_e64 v24, v51, v47
    v_fma_f32 v16, -v23, v47, v16
    v_fma_f32 v24, v23, v46, v24
    v_lshlrev_b32 v46, 16, v30
    v_and_b32 v47, 0xffff0000, v30
    v_mul_f32 v46, 0x35638e39, v46
    v_mul_f32 v47, 0x35638e39, v47
    v_mul_f32_e64 v23, v22, v46
    v_mul_f32_e64 v51, v22, v47
    v_fma_f32 v23, -v25, v47, v23
    v_fma_f32 v51, v25, v46, v51
    v_lshlrev_b32 v46, 16, v27
    v_and_b32 v47, 0xffff0000, v27
    v_mul_f32 v46, 0x35638e39, v46
    v_mul_f32 v47, 0x35638e39, v47
    v_mul_f32_e64 v25, v10, v46
    v_mul_f32_e64 v22, v10, v47
    v_fma_f32 v25, -v15, v47, v25
    v_fma_f32 v22, v15, v46, v22
    v_lshlrev_b32 v46, 16, v31
    v_and_b32 v47, 0xffff0000, v31
    v_mul_f32 v46, 0x35638e39, v46
    v_mul_f32 v47, 0x35638e39, v47
    v_mul_f32_e64 v15, v12, v46
    v_mul_f32_e64 v10, v12, v47
    v_fma_f32 v15, -v17, v47, v15
    v_fma_f32 v10, v17, v46, v10
    v_lshlrev_b32 v46, 16, v28
    v_and_b32 v47, 0xffff0000, v28
    v_mul_f32 v46, 0x35638e39, v46
    v_mul_f32 v47, 0x35638e39, v47
    v_mul_f32_e64 v17, v11, v46
    v_mul_f32_e64 v12, v11, v47
    v_fma_f32 v17, -v50, v47, v17
    v_fma_f32 v12, v50, v46, v12
    v_lshlrev_b32 v46, 16, v32
    v_and_b32 v47, 0xffff0000, v32
    v_mul_f32 v46, 0x35638e39, v46
    v_mul_f32 v47, 0x35638e39, v47
    v_mul_f32_e64 v50, v13, v46
    v_mul_f32_e64 v11, v13, v47
    v_fma_f32 v50, -v14, v47, v50
    v_fma_f32 v11, v14, v46, v11
    v_lshlrev_b32 v46, 16, v29
    v_and_b32 v47, 0xffff0000, v29
    v_mul_f32 v46, 0x35638e39, v46
    v_mul_f32 v47, 0x35638e39, v47
    v_mul_f32_e64 v14, v18, v46
    v_mul_f32_e64 v13, v18, v47
    v_fma_f32 v14, -v19, v47, v14
    v_fma_f32 v13, v19, v46, v13
    v_lshlrev_b32 v46, 16, v33
    v_and_b32 v47, 0xffff0000, v33
    v_mul_f32 v46, 0x35638e39, v46
    v_mul_f32 v47, 0x35638e39, v47
    v_mul_f32_e64 v19, v20, v46
    v_mul_f32_e64 v18, v20, v47
    v_fma_f32 v19, -v21, v47, v19
    v_fma_f32 v18, v21, v46, v18
    v_mov_b32 v21, v16
    v_mov_b32 v20, v24
    v_mov_b32 v52, v23
    v_mov_b32 v53, v25
    v_mov_b32 v54, v22
    v_mov_b32 v55, v15
    v_mov_b32 v56, v10
    v_mov_b32 v57, v17
    v_mov_b32 v58, v12
    v_mov_b32 v59, v11
    v_mov_b32 v60, v14
    v_mov_b32 v61, v13
    v_mov_b32 v62, v19
    v_mov_b32 v63, v18
    v_mov_b32 v10, v21
    v_mov_b32 v11, v20
    v_mov_b32 v12, v52
    v_mov_b32 v13, v51
    v_mov_b32 v14, v53
    v_mov_b32 v15, v54
    v_mov_b32 v16, v55
    v_mov_b32 v17, v56
    v_mov_b32 v18, v57
    v_mov_b32 v19, v58
    v_mov_b32 v20, v50
    v_mov_b32 v21, v59
    v_mov_b32 v22, v60
    v_mov_b32 v23, v61
    v_mov_b32 v24, v62
    v_mov_b32 v25, v63
    v_add_f32 v50, v10, v18
    v_sub_f32 v18, v10, v18
    v_add_f32 v10, v11, v19
    v_sub_f32 v19, v11, v19
    v_add_f32 v11, v12, v20
    v_sub_f32 v20, v12, v20
    v_add_f32 v12, v13, v21
    v_sub_f32 v21, v13, v21
    v_add_f32 v13, v14, v22
    v_sub_f32 v22, v14, v22
    v_add_f32 v14, v15, v23
    v_sub_f32 v23, v15, v23
    v_add_f32 v15, v16, v24
    v_sub_f32 v24, v16, v24
    v_add_f32 v16, v17, v25
    v_sub_f32 v25, v17, v25
    v_add_f32 v17, v50, v13
    v_sub_f32 v13, v50, v13
    v_add_f32 v50, v10, v14
    v_sub_f32 v14, v10, v14
    v_add_f32 v10, v11, v15
    v_sub_f32 v15, v11, v15
    v_add_f32 v11, v12, v16
    v_sub_f32 v16, v12, v16
    v_add_f32 v12, v17, v10
    v_sub_f32 v10, v17, v10
    v_add_f32 v17, v50, v11
    v_sub_f32 v11, v50, v11
    v_sub_f32 v50, v13, v16
    v_add_f32 v16, v13, v16
    v_add_f32 v13, v14, v15
    v_sub_f32 v15, v14, v15
    v_sub_f32 v14, v20, v21
    v_add_f32 v21, v20, v21
    v_mul_f32 v14, 0x3f3504f3, v14
    v_mul_f32 v21, 0x3f3504f3, v21
    v_add_f32 v20, v24, v25
    v_sub_f32 v25, v24, v25
    v_mul_f32 v20, 0x3f3504f3, v20
    v_mul_f32 v25, 0x3f3504f3, v25
    v_sub_f32 v24, v18, v23
    v_add_f32 v23, v18, v23
    v_add_f32 v18, v19, v22
    v_sub_f32 v22, v19, v22
    v_sub_f32 v19, v14, v20
    v_add_f32 v20, v14, v20
    v_add_f32 v14, v21, v25
    v_sub_f32 v25, v21, v25
    v_add_f32 v21, v24, v19
    v_sub_f32 v19, v24, v19
    v_add_f32 v24, v18, v14
    v_sub_f32 v14, v18, v14
    v_sub_f32 v18, v23, v25
    v_add_f32 v25, v23, v25
    v_add_f32 v23, v22, v20
    v_sub_f32 v20, v22, v20
    ds_write_b32 v7, v12 offset:16384
    ds_write_b32 v7, v17 offset:16388
    ds_write_b32 v7, v21 offset:16392
    ds_write_b32 v7, v24 offset:16396
    ds_write_b32 v7, v50 offset:16400
    ds_write_b32 v7, v13 offset:16404
    ds_write_b32 v7, v18 offset:16408
    ds_write_b32 v7, v23 offset:16412
    ds_write_b32 v7, v10 offset:16416
    ds_write_b32 v7, v11 offset:16420
    ds_write_b32 v7, v19 offset:16424
    ds_write_b32 v7, v14 offset:16428
    ds_write_b32 v7, v16 offset:16432
    ds_write_b32 v7, v15 offset:16436
    ds_write_b32 v7, v25 offset:16440
    ds_write_b32 v7, v20 offset:16444
    s_waitcnt lgkmcnt(0)
    s_barrier
    ds_read_b64 v[10:11], v1 offset:16384
    ds_read_b64 v[12:13], v1 offset:18432
    ds_read_b64 v[14:15], v1 offset:20480
    ds_read_b64 v[16:17], v1 offset:22528
    ds_read_b64 v[18:19], v1 offset:24576
    ds_read_b64 v[20:21], v1 offset:26624
    ds_read_b64 v[22:23], v1 offset:28672
    ds_read_b64 v[24:25], v1 offset:30720
    v_mul_f32 v49, 0x3c800000, v5
    v_cos_f32 v34, v49
    v_sin_f32 v35, v49
    v_mul_f32 v49, 0x3d000000, v5
    v_cos_f32 v36, v49
    v_sin_f32 v37, v49
    v_mul_f32 v49, 0x3d400000, v5
    v_cos_f32 v38, v49
    v_sin_f32 v39, v49
    v_mul_f32 v49, 0x3d800000, v5
    v_cos_f32 v40, v49
    v_sin_f32 v41, v49
    v_mul_f32 v49, 0x3da00000, v5
    v_cos_f32 v42, v49
    v_sin_f32 v43, v49
    v_mul_f32 v49, 0x3dc00000, v5
    v_cos_f32 v44, v49
    v_sin_f32 v45, v49
    v_mul_f32 v49, 0x3de00000, v5
    v_cos_f32 v46, v49
    v_sin_f32 v47, v49
    s_waitcnt lgkmcnt(0)
    v_mul_f32_e64 v50, v12, v34
    v_mul_f32_e64 v51, v12, v35
    v_fma_f32 v50, -v13, v35, v50
    v_fma_f32 v51, v13, v34, v51
    v_mul_f32_e64 v13, v14, v36
    v_mul_f32_e64 v12, v14, v37
    v_fma_f32 v13, -v15, v37, v13
    v_fma_f32 v12, v15, v36, v12
    v_mul_f32_e64 v15, v16, v38
    v_mul_f32_e64 v14, v16, v39
    v_fma_f32 v15, -v17, v39, v15
    v_fma_f32 v14, v17, v38, v14
    v_mul_f32_e64 v17, v18, v40
    v_mul_f32_e64 v16, v18, v41
    v_fma_f32 v17, -v19, v41, v17
    v_fma_f32 v16, v19, v40, v16
    v_mul_f32_e64 v19, v20, v42
    v_mul_f32_e64 v18, v20, v43
    v_fma_f32 v19, -v21, v43, v19
    v_fma_f32 v18, v21, v42, v18
    v_mul_f32_e64 v21, v22, v44
    v_mul_f32_e64 v20, v22, v45
    v_fma_f32 v21, -v23, v45, v21
    v_fma_f32 v20, v23, v44, v20
    v_mul_f32_e64 v23, v24, v46
    v_mul_f32_e64 v22, v24, v47
    v_fma_f32 v23, -v25, v47, v23
    v_fma_f32 v22, v25, v46, v22
    v_add_f32 v25, v10, v17
    v_sub_f32 v17, v10, v17
    v_add_f32 v10, v11, v16
    v_sub_f32 v16, v11, v16
    v_add_f32 v11, v50, v19
    v_sub_f32 v19, v50, v19
    v_add_f32 v50, v51, v18
    v_sub_f32 v18, v51, v18
    v_add_f32 v51, v13, v21
    v_sub_f32 v21, v13, v21
    v_add_f32 v13, v12, v20
    v_sub_f32 v20, v12, v20
    v_add_f32 v12, v15, v23
    v_sub_f32 v23, v15, v23
    v_add_f32 v15, v14, v22
    v_sub_f32 v22, v14, v22
    v_add_f32 v14, v25, v51
    v_sub_f32 v51, v25, v51
    v_add_f32 v25, v10, v13
    v_sub_f32 v13, v10, v13
    v_add_f32 v10, v11, v12
    v_sub_f32 v12, v11, v12
    v_add_f32 v11, v50, v15
    v_sub_f32 v15, v50, v15
    v_add_f32 v50, v14, v10
    v_sub_f32 v10, v14, v10
    v_add_f32 v14, v25, v11
    v_sub_f32 v11, v25, v11
    v_sub_f32 v25, v51, v15
    v_add_f32 v15, v51, v15
    v_add_f32 v51, v13, v12
    v_sub_f32 v12, v13, v12
    v_sub_f32 v13, v19, v18
    v_add_f32 v18, v19, v18
    v_mul_f32 v13, 0x3f3504f3, v13
    v_mul_f32 v18, 0x3f3504f3, v18
    v_add_f32 v19, v23, v22
    v_sub_f32 v22, v23, v22
    v_mul_f32 v19, 0x3f3504f3, v19
    v_mul_f32 v22, 0x3f3504f3, v22
    v_sub_f32 v23, v17, v20
    v_add_f32 v20, v17, v20
    v_add_f32 v17, v16, v21
    v_sub_f32 v21, v16, v21
    v_sub_f32 v16, v13, v19
    v_add_f32 v19, v13, v19
    v_add_f32 v13, v18, v22
    v_sub_f32 v22, v18, v22
    v_add_f32 v18, v23, v16
    v_sub_f32 v16, v23, v16
    v_add_f32 v23, v17, v13
    v_sub_f32 v13, v17, v13
    v_sub_f32 v17, v20, v22
    v_add_f32 v22, v20, v22
    v_add_f32 v20, v21, v19
    v_sub_f32 v19, v21, v19
    ds_write_b32 v8, v50 offset:0
    ds_write_b32 v8, v14 offset:4
    ds_write_b32 v8, v18 offset:64
    ds_write_b32 v8, v23 offset:68
    ds_write_b32 v8, v25 offset:128
    ds_write_b32 v8, v51 offset:132
    ds_write_b32 v8, v17 offset:192
    ds_write_b32 v8, v20 offset:196
    ds_write_b32 v8, v10 offset:256
    ds_write_b32 v8, v11 offset:260
    ds_write_b32 v8, v16 offset:320
    ds_write_b32 v8, v13 offset:324
    ds_write_b32 v8, v15 offset:384
    ds_write_b32 v8, v12 offset:388
    ds_write_b32 v8, v22 offset:448
    ds_write_b32 v8, v19 offset:452
    s_waitcnt lgkmcnt(0)
    s_barrier
    ds_read_b64 v[10:11], v1 offset:0
    ds_read_b64 v[12:13], v1 offset:2048
    ds_read_b64 v[14:15], v1 offset:4096
    ds_read_b64 v[16:17], v1 offset:6144
    ds_read_b64 v[18:19], v1 offset:8192
    ds_read_b64 v[20:21], v1 offset:10240
    ds_read_b64 v[22:23], v1 offset:12288
    ds_read_b64 v[24:25], v1 offset:14336
    v_mul_f32 v49, 0x3b000000, v6
    v_cos_f32 v34, v49
    v_sin_f32 v35, v49
    v_mul_f32 v49, 0x3b800000, v6
    v_cos_f32 v36, v49
    v_sin_f32 v37, v49
    v_mul_f32 v49, 0x3bc00000, v6
    v_cos_f32 v38, v49
    v_sin_f32 v39, v49
    v_mul_f32 v49, 0x3c000000, v6
    v_cos_f32 v40, v49
    v_sin_f32 v41, v49
    v_mul_f32 v49, 0x3c200000, v6
    v_cos_f32 v42, v49
    v_sin_f32 v43, v49
    v_mul_f32 v49, 0x3c400000, v6
    v_cos_f32 v44, v49
    v_sin_f32 v45, v49
    v_mul_f32 v49, 0x3c600000, v6
    v_cos_f32 v46, v49
    v_sin_f32 v47, v49
    s_waitcnt lgkmcnt(0)
    v_mul_f32_e64 v50, v12, v34
    v_mul_f32_e64 v51, v12, v35
    v_fma_f32 v50, -v13, v35, v50
    v_fma_f32 v51, v13, v34, v51
    v_mul_f32_e64 v13, v14, v36
    v_mul_f32_e64 v12, v14, v37
    v_fma_f32 v13, -v15, v37, v13
    v_fma_f32 v12, v15, v36, v12
    v_mul_f32_e64 v15, v16, v38
    v_mul_f32_e64 v14, v16, v39
    v_fma_f32 v15, -v17, v39, v15
    v_fma_f32 v14, v17, v38, v14
    v_mul_f32_e64 v17, v18, v40
    v_mul_f32_e64 v16, v18, v41
    v_fma_f32 v17, -v19, v41, v17
    v_fma_f32 v16, v19, v40, v16
    v_mul_f32_e64 v19, v20, v42
    v_mul_f32_e64 v18, v20, v43
    v_fma_f32 v19, -v21, v43, v19
    v_fma_f32 v18, v21, v42, v18
    v_mul_f32_e64 v21, v22, v44
    v_mul_f32_e64 v20, v22, v45
    v_fma_f32 v21, -v23, v45, v21
    v_fma_f32 v20, v23, v44, v20
    v_mul_f32_e64 v23, v24, v46
    v_mul_f32_e64 v22, v24, v47
    v_fma_f32 v23, -v25, v47, v23
    v_fma_f32 v22, v25, v46, v22
    v_add_f32 v25, v10, v17
    v_sub_f32 v17, v10, v17
    v_add_f32 v10, v11, v16
    v_sub_f32 v16, v11, v16
    v_add_f32 v11, v50, v19
    v_sub_f32 v19, v50, v19
    v_add_f32 v50, v51, v18
    v_sub_f32 v18, v51, v18
    v_add_f32 v51, v13, v21
    v_sub_f32 v21, v13, v21
    v_add_f32 v13, v12, v20
    v_sub_f32 v20, v12, v20
    v_add_f32 v12, v15, v23
    v_sub_f32 v23, v15, v23
    v_add_f32 v15, v14, v22
    v_sub_f32 v22, v14, v22
    v_add_f32 v14, v25, v51
    v_sub_f32 v51, v25, v51
    v_add_f32 v25, v10, v13
    v_sub_f32 v13, v10, v13
    v_add_f32 v10, v11, v12
    v_sub_f32 v12, v11, v12
    v_add_f32 v11, v50, v15
    v_sub_f32 v15, v50, v15
    v_add_f32 v50, v14, v10
    v_sub_f32 v10, v14, v10
    v_add_f32 v14, v25, v11
    v_sub_f32 v11, v25, v11
    v_sub_f32 v25, v51, v15
    v_add_f32 v15, v51, v15
    v_add_f32 v51, v13, v12
    v_sub_f32 v12, v13, v12
    v_sub_f32 v13, v19, v18
    v_add_f32 v18, v19, v18
    v_mul_f32 v13, 0x3f3504f3, v13
    v_mul_f32 v18, 0x3f3504f3, v18
    v_add_f32 v19, v23, v22
    v_sub_f32 v22, v23, v22
    v_mul_f32 v19, 0x3f3504f3, v19
    v_mul_f32 v22, 0x3f3504f3, v22
    v_sub_f32 v23, v17, v20
    v_add_f32 v20, v17, v20
    v_add_f32 v17, v16, v21
    v_sub_f32 v21, v16, v21
    v_sub_f32 v16, v13, v19
    v_add_f32 v19, v13, v19
    v_add_f32 v13, v18, v22
    v_sub_f32 v22, v18, v22
    v_add_f32 v18, v23, v16
    v_sub_f32 v16, v23, v16
    v_add_f32 v23, v17, v13
    v_sub_f32 v13, v17, v13
    v_sub_f32 v17, v20, v22
    v_add_f32 v22, v20, v22
    v_add_f32 v20, v21, v19
    v_sub_f32 v19, v21, v19
    ds_write_b32 v9, v50 offset:16384
    ds_write_b32 v9, v14 offset:16388
    ds_write_b32 v9, v18 offset:16896
    ds_write_b32 v9, v23 offset:16900
    ds_write_b32 v9, v25 offset:17408
    ds_write_b32 v9, v51 offset:17412
    ds_write_b32 v9, v17 offset:17920
    ds_write_b32 v9, v20 offset:17924
    ds_write_b32 v9, v10 offset:18432
    ds_write_b32 v9, v11 offset:18436
    ds_write_b32 v9, v16 offset:18944
    ds_write_b32 v9, v13 offset:18948
    ds_write_b32 v9, v15 offset:19456
    ds_write_b32 v9, v12 offset:19460
    ds_write_b32 v9, v22 offset:19968
    ds_write_b32 v9, v19 offset:19972
    s_waitcnt lgkmcnt(0)
    s_barrier
    ds_read_b64 v[10:11], v1 offset:16384
    ds_read_b64 v[12:13], v1 offset:18432
    ds_read_b64 v[14:15], v1 offset:20480
    ds_read_b64 v[16:17], v1 offset:22528
    ds_read_b64 v[18:19], v1 offset:24576
    ds_read_b64 v[20:21], v1 offset:26624
    ds_read_b64 v[22:23], v1 offset:28672
    ds_read_b64 v[24:25], v1 offset:30720
    s_waitcnt lgkmcnt(0)
    v_mov_b32 v48, v4
    v_mul_f32 v49, 0x3a000000, v48
    v_cos_f32 v34, v49
    v_sin_f32 v35, v49
    v_mul_f32 v49, 0x3a800000, v48
    v_cos_f32 v36, v49
    v_sin_f32 v37, v49
    v_mul_f32 v49, 0x3ac00000, v48
    v_cos_f32 v38, v49
    v_sin_f32 v39, v49
    v_mul_f32_e64 v50, v14, v34
    v_mul_f32_e64 v51, v14, v35
    v_fma_f32 v50, -v15, v35, v50
    v_fma_f32 v51, v15, v34, v51
    v_mul_f32_e64 v15, v18, v36
    v_mul_f32_e64 v14, v18, v37
    v_fma_f32 v15, -v19, v37, v15
    v_fma_f32 v14, v19, v36, v14
    v_mul_f32_e64 v19, v22, v38
    v_mul_f32_e64 v18, v22, v39
    v_fma_f32 v19, -v23, v39, v19
    v_fma_f32 v18, v23, v38, v18
    v_add_f32 v23, v10, v15
    v_sub_f32 v15, v10, v15
    v_add_f32 v10, v11, v14
    v_sub_f32 v14, v11, v14
    v_add_f32 v11, v50, v19
    v_sub_f32 v19, v50, v19
    v_add_f32 v50, v51, v18
    v_sub_f32 v18, v51, v18
    v_add_f32 v51, v23, v11
    v_sub_f32 v11, v23, v11
    v_add_f32 v23, v10, v50
    v_sub_f32 v50, v10, v50
    v_sub_f32 v10, v15, v18
    v_add_f32 v18, v15, v18
    v_add_f32 v15, v14, v19
    v_sub_f32 v19, v14, v19
    v_add_f32 v48, 0x43800000, v4
    v_mul_f32 v49, 0x3a000000, v48
    v_cos_f32 v34, v49
    v_sin_f32 v35, v49
    v_mul_f32 v49, 0x3a800000, v48
    v_cos_f32 v36, v49
    v_sin_f32 v37, v49
    v_mul_f32 v49, 0x3ac00000, v48
    v_cos_f32 v38, v49
    v_sin_f32 v39, v49
    v_mul_f32_e64 v14, v16, v34
    v_mul_f32_e64 v22, v16, v35
    v_fma_f32 v14, -v17, v35, v14
    v_fma_f32 v22, v17, v34, v22
    v_mul_f32_e64 v17, v20, v36
    v_mul_f32_e64 v16, v20, v37
    v_fma_f32 v17, -v21, v37, v17
    v_fma_f32 v16, v21, v36, v16
    v_mul_f32_e64 v21, v24, v38
    v_mul_f32_e64 v20, v24, v39
    v_fma_f32 v21, -v25, v39, v21
    v_fma_f32 v20, v25, v38, v20
    v_add_f32 v25, v12, v17
    v_sub_f32 v17, v12, v17
    v_add_f32 v12, v13, v16
    v_sub_f32 v16, v13, v16
    v_add_f32 v13, v14, v21
    v_sub_f32 v21, v14, v21
    v_add_f32 v14, v22, v20
    v_sub_f32 v20, v22, v20
    v_add_f32 v22, v25, v13
    v_sub_f32 v13, v25, v13
    v_add_f32 v25, v12, v14
    v_sub_f32 v14, v12, v14
    v_sub_f32 v12, v17, v20
    v_add_f32 v20, v17, v20
    v_add_f32 v17, v16, v21
    v_sub_f32 v21, v16, v21
    v_mov_b32 v16, v23
    v_mov_b32 v24, v22
    v_mov_b32 v52, v25
    v_mov_b32 v53, v10
    v_mov_b32 v54, v15
    v_mov_b32 v55, v12
    v_mov_b32 v56, v17
    v_mov_b32 v57, v11
    v_mov_b32 v58, v13
    v_mov_b32 v59, v14
    v_mov_b32 v60, v18
    v_mov_b32 v61, v19
    v_mov_b32 v62, v20
    v_mov_b32 v63, v21
    v_mov_b32 v10, v51
    v_mov_b32 v11, v16
    v_mov_b32 v12, v24
    v_mov_b32 v13, v52
    v_mov_b32 v14, v53
    v_mov_b32 v15, v54
    v_mov_b32 v16, v55
    v_mov_b32 v17, v56
    v_mov_b32 v18, v57
    v_mov_b32 v19, v50
    v_mov_b32 v20, v58
    v_mov_b32 v21, v59
    v_mov_b32 v22, v60
    v_mov_b32 v23, v61
    v_mov_b32 v24, v62
    v_mov_b32 v25, v63
    global_store_dwordx2 v120, v[10:11], s[12:13] offset:0
    global_store_dwordx2 v120, v[12:13], s[12:13] offset:2048
    global_store_dwordx2 v121, v[14:15], s[12:13] offset:0
    global_store_dwordx2 v121, v[16:17], s[12:13] offset:2048
    global_store_dwordx2 v122, v[18:19], s[12:13] offset:0
    global_store_dwordx2 v122, v[20:21], s[12:13] offset:2048
    global_store_dwordx2 v123, v[22:23], s[12:13] offset:0
    global_store_dwordx2 v123, v[24:25], s[12:13] offset:2048
    s_waitcnt vmcnt(0)
Lk3_end:
    s_endpgm
.globl k4_rowifft_kernel
.p2align 8
.type k4_rowifft_kernel,@function
k4_rowifft_kernel:
    s_cmp_ge_u32 s2, 256
    s_cbranch_scc1 Lk4_end
    s_load_dwordx2 s[4:5], s[0:1], 0
    s_load_dwordx2 s[6:7], s[0:1], 80
    v_and_b32 v1, 63, v0
    v_lshrrev_b32 v2, 6, v0
    s_lshl_b32 s8, s2, 3
    v_lshl_add_u32 v3, v2, 1, s8
    v_mul_u32_u24 v6, 9216, v2
    v_add_u32 v49, 4608, v6
    s_waitcnt lgkmcnt(0)
    s_add_u32 s14, s6, 9437184
    s_addc_u32 s15, s7, 0
    v_lshlrev_b32 v9, 3, v3
    v_add_u32 v10, 0, v1
    v_lshlrev_b32 v22, 14, v10
    v_add_u32 v22, v22, v9
    global_load_dwordx4 v[60:63], v22, s[14:15]
    v_add_u32 v10, 64, v1
    v_lshlrev_b32 v22, 14, v10
    v_add_u32 v22, v22, v9
    global_load_dwordx4 v[64:67], v22, s[14:15]
    v_add_u32 v10, 128, v1
    v_lshlrev_b32 v22, 14, v10
    v_add_u32 v22, v22, v9
    global_load_dwordx4 v[68:71], v22, s[14:15]
    v_add_u32 v10, 192, v1
    v_lshlrev_b32 v22, 14, v10
    v_add_u32 v22, v22, v9
    global_load_dwordx4 v[72:75], v22, s[14:15]
    v_add_u32 v10, 256, v1
    v_lshlrev_b32 v22, 14, v10
    v_add_u32 v22, v22, v9
    v_cmp_gt_u32 vcc, 289, v10
    s_and_saveexec_b64 s[22:23], vcc
    global_load_dwordx4 v[76:79], v22, s[14:15]
    s_mov_b64 exec, s[22:23]
    s_waitcnt vmcnt(0)
    v_add_u32 v10, 0, v1
    v_cmp_eq_u32 vcc, 0, v10
    s_nop 1
    v_cndmask_b32_e64 v61, v61, 0, vcc
    v_cndmask_b32_e64 v63, v63, 0, vcc
    v_cmp_eq_u32 vcc, 288, v10
    s_nop 1
    v_cndmask_b32_e64 v61, v61, 0, vcc
    v_cndmask_b32_e64 v63, v63, 0, vcc
    v_sub_f32 v14, v60, v63
    v_add_f32 v15, v61, v62
    v_add_f32 v16, v60, v63
    v_sub_f32 v17, v62, v61
    v_lshl_add_u32 v12, v10, 3, v6
    v_sub_u32 v11, 576, v10
    v_lshl_add_u32 v13, v11, 3, v6
    ds_write_b64 v12, v[14:15]
    v_cmp_lt_u32 vcc, 0, v10
    s_and_b64 exec, exec, vcc
    v_cmp_gt_u32 vcc, 288, v10
    s_and_b64 exec, exec, vcc
    ds_write_b64 v13, v[16:17]
    s_mov_b64 exec, -1
    v_add_u32 v10, 64, v1
    v_cmp_eq_u32 vcc, 0, v10
    s_nop 1
    v_cndmask_b32_e64 v65, v65, 0, vcc
    v_cndmask_b32_e64 v67, v67, 0, vcc
    v_cmp_eq_u32 vcc, 288, v10
    s_nop 1
    v_cndmask_b32_e64 v65, v65, 0, vcc
    v_cndmask_b32_e64 v67, v67, 0, vcc
    v_sub_f32 v14, v64, v67
    v_add_f32 v15, v65, v66
    v_add_f32 v16, v64, v67
    v_sub_f32 v17, v66, v65
    v_lshl_add_u32 v12, v10, 3, v6
    v_sub_u32 v11, 576, v10
    v_lshl_add_u32 v13, v11, 3, v6
    ds_write_b64 v12, v[14:15]
    v_cmp_lt_u32 vcc, 0, v10
    s_and_b64 exec, exec, vcc
    v_cmp_gt_u32 vcc, 288, v10
    s_and_b64 exec, exec, vcc
    ds_write_b64 v13, v[16:17]
    s_mov_b64 exec, -1
    v_add_u32 v10, 128, v1
    v_cmp_eq_u32 vcc, 0, v10
    s_nop 1
    v_cndmask_b32_e64 v69, v69, 0, vcc
    v_cndmask_b32_e64 v71, v71, 0, vcc
    v_cmp_eq_u32 vcc, 288, v10
    s_nop 1
    v_cndmask_b32_e64 v69, v69, 0, vcc
    v_cndmask_b32_e64 v71, v71, 0, vcc
    v_sub_f32 v14, v68, v71
    v_add_f32 v15, v69, v70
    v_add_f32 v16, v68, v71
    v_sub_f32 v17, v70, v69
    v_lshl_add_u32 v12, v10, 3, v6
    v_sub_u32 v11, 576, v10
    v_lshl_add_u32 v13, v11, 3, v6
    ds_write_b64 v12, v[14:15]
    v_cmp_lt_u32 vcc, 0, v10
    s_and_b64 exec, exec, vcc
    v_cmp_gt_u32 vcc, 288, v10
    s_and_b64 exec, exec, vcc
    ds_write_b64 v13, v[16:17]
    s_mov_b64 exec, -1
    v_add_u32 v10, 192, v1
    v_cmp_eq_u32 vcc, 0, v10
    s_nop 1
    v_cndmask_b32_e64 v73, v73, 0, vcc
    v_cndmask_b32_e64 v75, v75, 0, vcc
    v_cmp_eq_u32 vcc, 288, v10
    s_nop 1
    v_cndmask_b32_e64 v73, v73, 0, vcc
    v_cndmask_b32_e64 v75, v75, 0, vcc
    v_sub_f32 v14, v72, v75
    v_add_f32 v15, v73, v74
    v_add_f32 v16, v72, v75
    v_sub_f32 v17, v74, v73
    v_lshl_add_u32 v12, v10, 3, v6
    v_sub_u32 v11, 576, v10
    v_lshl_add_u32 v13, v11, 3, v6
    ds_write_b64 v12, v[14:15]
    v_cmp_lt_u32 vcc, 0, v10
    s_and_b64 exec, exec, vcc
    v_cmp_gt_u32 vcc, 288, v10
    s_and_b64 exec, exec, vcc
    ds_write_b64 v13, v[16:17]
    s_mov_b64 exec, -1
    v_add_u32 v10, 256, v1
    v_cmp_eq_u32 vcc, 0, v10
    s_nop 1
    v_cndmask_b32_e64 v77, v77, 0, vcc
    v_cndmask_b32_e64 v79, v79, 0, vcc
    v_cmp_eq_u32 vcc, 288, v10
    s_nop 1
    v_cndmask_b32_e64 v77, v77, 0, vcc
    v_cndmask_b32_e64 v79, v79, 0, vcc
    v_sub_f32 v14, v76, v79
    v_add_f32 v15, v77, v78
    v_add_f32 v16, v76, v79
    v_sub_f32 v17, v78, v77
    v_lshl_add_u32 v12, v10, 3, v6
    v_sub_u32 v11, 576, v10
    v_lshl_add_u32 v13, v11, 3, v6
    v_cmp_gt_u32 vcc, 289, v10
    s_and_saveexec_b64 s[22:23], vcc
    ds_write_b64 v12, v[14:15]
    v_cmp_lt_u32 vcc, 0, v10
    s_and_b64 exec, exec, vcc
    v_cmp_gt_u32 vcc, 288, v10
    s_and_b64 exec, exec, vcc
    ds_write_b64 v13, v[16:17]
    s_mov_b64 exec, -1
    s_waitcnt lgkmcnt(0)
    v_mov_b32 v8, v1
    v_lshlrev_b32 v44, 3, v8
    v_lshl_add_u32 v46, v8, 3, v6
    ds_read_b64 v[10:11], v46 offset:0
    ds_read_b64 v[12:13], v46 offset:576
    ds_read_b64 v[14:15], v46 offset:1152
    ds_read_b64 v[16:17], v46 offset:1728
    ds_read_b64 v[18:19], v46 offset:2304
    ds_read_b64 v[20:21], v46 offset:2880
    ds_read_b64 v[22:23], v46 offset:3456
    ds_read_b64 v[24:25], v46 offset:4032
    s_waitcnt lgkmcnt(0)
    v_add_f32 v50, v10, v18
    v_sub_f32 v18, v10, v18
    v_add_f32 v10, v11, v19
    v_sub_f32 v19, v11, v19
    v_add_f32 v11, v12, v20
    v_sub_f32 v20, v12, v20
    v_add_f32 v12, v13, v21
    v_sub_f32 v21, v13, v21
    v_add_f32 v13, v14, v22
    v_sub_f32 v22, v14, v22
    v_add_f32 v14, v15, v23
    v_sub_f32 v23, v15, v23
    v_add_f32 v15, v16, v24
    v_sub_f32 v24, v16, v24
    v_add_f32 v16, v17, v25
    v_sub_f32 v25, v17, v25
    v_add_f32 v17, v50, v13
    v_sub_f32 v13, v50, v13
    v_add_f32 v50, v10, v14
    v_sub_f32 v14, v10, v14
    v_add_f32 v10, v11, v15
    v_sub_f32 v15, v11, v15
    v_add_f32 v11, v12, v16
    v_sub_f32 v16, v12, v16
    v_add_f32 v12, v17, v10
    v_sub_f32 v10, v17, v10
    v_add_f32 v17, v50, v11
    v_sub_f32 v11, v50, v11
    v_sub_f32 v50, v13, v16
    v_add_f32 v16, v13, v16
    v_add_f32 v13, v14, v15
    v_sub_f32 v15, v14, v15
    v_sub_f32 v14, v20, v21
    v_add_f32 v21, v20, v21
    v_mul_f32 v14, 0x3f3504f3, v14
    v_mul_f32 v21, 0x3f3504f3, v21
    v_add_f32 v20, v24, v25
    v_sub_f32 v25, v24, v25
    v_mul_f32 v20, 0x3f3504f3, v20
    v_mul_f32 v25, 0x3f3504f3, v25
    v_sub_f32 v24, v18, v23
    v_add_f32 v23, v18, v23
    v_add_f32 v18, v19, v22
    v_sub_f32 v22, v19, v22
    v_sub_f32 v19, v14, v20
    v_add_f32 v20, v14, v20
    v_add_f32 v14, v21, v25
    v_sub_f32 v25, v21, v25
    v_add_f32 v21, v24, v19
    v_sub_f32 v19, v24, v19
    v_add_f32 v24, v18, v14
    v_sub_f32 v14, v18, v14
    v_sub_f32 v18, v23, v25
    v_add_f32 v25, v23, v25
    v_add_f32 v23, v22, v20
    v_sub_f32 v20, v22, v20
    v_lshl_add_u32 v46, v44, 3, v49
    ds_write_b32 v46, v12 offset:0
    ds_write_b32 v46, v17 offset:4
    ds_write_b32 v46, v21 offset:8
    ds_write_b32 v46, v24 offset:12
    ds_write_b32 v46, v50 offset:16
    ds_write_b32 v46, v13 offset:20
    ds_write_b32 v46, v18 offset:24
    ds_write_b32 v46, v23 offset:28
    ds_write_b32 v46, v10 offset:32
    ds_write_b32 v46, v11 offset:36
    ds_write_b32 v46, v19 offset:40
    ds_write_b32 v46, v14 offset:44
    ds_write_b32 v46, v16 offset:48
    ds_write_b32 v46, v15 offset:52
    ds_write_b32 v46, v25 offset:56
    ds_write_b32 v46, v20 offset:60
    s_waitcnt lgkmcnt(0)
    s_mov_b64 exec, 0xff
    v_add_u32 v8, 64, v1
    v_lshlrev_b32 v44, 3, v8
    v_lshl_add_u32 v46, v8, 3, v6
    ds_read_b64 v[10:11], v46 offset:0
    ds_read_b64 v[12:13], v46 offset:576
    ds_read_b64 v[14:15], v46 offset:1152
    ds_read_b64 v[16:17], v46 offset:1728
    ds_read_b64 v[18:19], v46 offset:2304
    ds_read_b64 v[20:21], v46 offset:2880
    ds_read_b64 v[22:23], v46 offset:3456
    ds_read_b64 v[24:25], v46 offset:4032
    s_waitcnt lgkmcnt(0)
    v_add_f32 v50, v10, v18
    v_sub_f32 v18, v10, v18
    v_add_f32 v10, v11, v19
    v_sub_f32 v19, v11, v19
    v_add_f32 v11, v12, v20
    v_sub_f32 v20, v12, v20
    v_add_f32 v12, v13, v21
    v_sub_f32 v21, v13, v21
    v_add_f32 v13, v14, v22
    v_sub_f32 v22, v14, v22
    v_add_f32 v14, v15, v23
    v_sub_f32 v23, v15, v23
    v_add_f32 v15, v16, v24
    v_sub_f32 v24, v16, v24
    v_add_f32 v16, v17, v25
    v_sub_f32 v25, v17, v25
    v_add_f32 v17, v50, v13
    v_sub_f32 v13, v50, v13
    v_add_f32 v50, v10, v14
    v_sub_f32 v14, v10, v14
    v_add_f32 v10, v11, v15
    v_sub_f32 v15, v11, v15
    v_add_f32 v11, v12, v16
    v_sub_f32 v16, v12, v16
    v_add_f32 v12, v17, v10
    v_sub_f32 v10, v17, v10
    v_add_f32 v17, v50, v11
    v_sub_f32 v11, v50, v11
    v_sub_f32 v50, v13, v16
    v_add_f32 v16, v13, v16
    v_add_f32 v13, v14, v15
    v_sub_f32 v15, v14, v15
    v_sub_f32 v14, v20, v21
    v_add_f32 v21, v20, v21
    v_mul_f32 v14, 0x3f3504f3, v14
    v_mul_f32 v21, 0x3f3504f3, v21
    v_add_f32 v20, v24, v25
    v_sub_f32 v25, v24, v25
    v_mul_f32 v20, 0x3f3504f3, v20
    v_mul_f32 v25, 0x3f3504f3, v25
    v_sub_f32 v24, v18, v23
    v_add_f32 v23, v18, v23
    v_add_f32 v18, v19, v22
    v_sub_f32 v22, v19, v22
    v_sub_f32 v19, v14, v20
    v_add_f32 v20, v14, v20
    v_add_f32 v14, v21, v25
    v_sub_f32 v25, v21, v25
    v_add_f32 v21, v24, v19
    v_sub_f32 v19, v24, v19
    v_add_f32 v24, v18, v14
    v_sub_f32 v14, v18, v14
    v_sub_f32 v18, v23, v25
    v_add_f32 v25, v23, v25
    v_add_f32 v23, v22, v20
    v_sub_f32 v20, v22, v20
    v_lshl_add_u32 v46, v44, 3, v49
    ds_write_b32 v46, v12 offset:0
    ds_write_b32 v46, v17 offset:4
    ds_write_b32 v46, v21 offset:8
    ds_write_b32 v46, v24 offset:12
    ds_write_b32 v46, v50 offset:16
    ds_write_b32 v46, v13 offset:20
    ds_write_b32 v46, v18 offset:24
    ds_write_b32 v46, v23 offset:28
    ds_write_b32 v46, v10 offset:32
    ds_write_b32 v46, v11 offset:36
    ds_write_b32 v46, v19 offset:40
    ds_write_b32 v46, v14 offset:44
    ds_write_b32 v46, v16 offset:48
    ds_write_b32 v46, v15 offset:52
    ds_write_b32 v46, v25 offset:56
    ds_write_b32 v46, v20 offset:60
    s_waitcnt lgkmcnt(0)
    s_mov_b64 exec, -1
    v_mov_b32 v8, v1
    v_and_b32 v42, 7, v8
    v_cvt_f32_u32 v43, v42
    v_lshrrev_b32 v44, 3, v8
    v_lshl_add_u32 v44, v44, 6, v42
    v_lshl_add_u32 v46, v8, 3, v49
    ds_read_b64 v[10:11], v46 offset:0
    ds_read_b64 v[12:13], v46 offset:576
    ds_read_b64 v[14:15], v46 offset:1152
    ds_read_b64 v[16:17], v46 offset:1728
    ds_read_b64 v[18:19], v46 offset:2304
    ds_read_b64 v[20:21], v46 offset:2880
    ds_read_b64 v[22:23], v46 offset:3456
    ds_read_b64 v[24:25], v46 offset:4032
    v_mul_f32 v45, 0x3c800000, v43
    v_cos_f32 v28, v45
    v_sin_f32 v29, v45
    v_mul_f32 v45, 0x3d000000, v43
    v_cos_f32 v30, v45
    v_sin_f32 v31, v45
    v_mul_f32 v45, 0x3d400000, v43
    v_cos_f32 v32, v45
    v_sin_f32 v33, v45
    v_mul_f32 v45, 0x3d800000, v43
    v_cos_f32 v34, v45
    v_sin_f32 v35, v45
    v_mul_f32 v45, 0x3da00000, v43
    v_cos_f32 v36, v45
    v_sin_f32 v37, v45
    v_mul_f32 v45, 0x3dc00000, v43
    v_cos_f32 v38, v45
    v_sin_f32 v39, v45
    v_mul_f32 v45, 0x3de00000, v43
    v_cos_f32 v40, v45
    v_sin_f32 v41, v45
    s_waitcnt lgkmcnt(0)
    v_mul_f32_e64 v50, v12, v28
    v_mul_f32_e64 v51, v12, v29
    v_fma_f32 v50, -v13, v29, v50
    v_fma_f32 v51, v13, v28, v51
    v_mul_f32_e64 v13, v14, v30
    v_mul_f32_e64 v12, v14, v31
    v_fma_f32 v13, -v15, v31, v13
    v_fma_f32 v12, v15, v30, v12
    v_mul_f32_e64 v15, v16, v32
    v_mul_f32_e64 v14, v16, v33
    v_fma_f32 v15, -v17, v33, v15
    v_fma_f32 v14, v17, v32, v14
    v_mul_f32_e64 v17, v18, v34
    v_mul_f32_e64 v16, v18, v35
    v_fma_f32 v17, -v19, v35, v17
    v_fma_f32 v16, v19, v34, v16
    v_mul_f32_e64 v19, v20, v36
    v_mul_f32_e64 v18, v20, v37
    v_fma_f32 v19, -v21, v37, v19
    v_fma_f32 v18, v21, v36, v18
    v_mul_f32_e64 v21, v22, v38
    v_mul_f32_e64 v20, v22, v39
    v_fma_f32 v21, -v23, v39, v21
    v_fma_f32 v20, v23, v38, v20
    v_mul_f32_e64 v23, v24, v40
    v_mul_f32_e64 v22, v24, v41
    v_fma_f32 v23, -v25, v41, v23
    v_fma_f32 v22, v25, v40, v22
    v_add_f32 v25, v10, v17
    v_sub_f32 v17, v10, v17
    v_add_f32 v10, v11, v16
    v_sub_f32 v16, v11, v16
    v_add_f32 v11, v50, v19
    v_sub_f32 v19, v50, v19
    v_add_f32 v50, v51, v18
    v_sub_f32 v18, v51, v18
    v_add_f32 v51, v13, v21
    v_sub_f32 v21, v13, v21
    v_add_f32 v13, v12, v20
    v_sub_f32 v20, v12, v20
    v_add_f32 v12, v15, v23
    v_sub_f32 v23, v15, v23
    v_add_f32 v15, v14, v22
    v_sub_f32 v22, v14, v22
    v_add_f32 v14, v25, v51
    v_sub_f32 v51, v25, v51
    v_add_f32 v25, v10, v13
    v_sub_f32 v13, v10, v13
    v_add_f32 v10, v11, v12
    v_sub_f32 v12, v11, v12
    v_add_f32 v11, v50, v15
    v_sub_f32 v15, v50, v15
    v_add_f32 v50, v14, v10
    v_sub_f32 v10, v14, v10
    v_add_f32 v14, v25, v11
    v_sub_f32 v11, v25, v11
    v_sub_f32 v25, v51, v15
    v_add_f32 v15, v51, v15
    v_add_f32 v51, v13, v12
    v_sub_f32 v12, v13, v12
    v_sub_f32 v13, v19, v18
    v_add_f32 v18, v19, v18
    v_mul_f32 v13, 0x3f3504f3, v13
    v_mul_f32 v18, 0x3f3504f3, v18
    v_add_f32 v19, v23, v22
    v_sub_f32 v22, v23, v22
    v_mul_f32 v19, 0x3f3504f3, v19
    v_mul_f32 v22, 0x3f3504f3, v22
    v_sub_f32 v23, v17, v20
    v_add_f32 v20, v17, v20
    v_add_f32 v17, v16, v21
    v_sub_f32 v21, v16, v21
    v_sub_f32 v16, v13, v19
    v_add_f32 v19, v13, v19
    v_add_f32 v13, v18, v22
    v_sub_f32 v22, v18, v22
    v_add_f32 v18, v23, v16
    v_sub_f32 v16, v23, v16
    v_add_f32 v23, v17, v13
    v_sub_f32 v13, v17, v13
    v_sub_f32 v17, v20, v22
    v_add_f32 v22, v20, v22
    v_add_f32 v20, v21, v19
    v_sub_f32 v19, v21, v19
    v_lshl_add_u32 v46, v44, 3, v6
    ds_write_b32 v46, v50 offset:0
    ds_write_b32 v46, v14 offset:4
    ds_write_b32 v46, v18 offset:64
    ds_write_b32 v46, v23 offset:68
    ds_write_b32 v46, v25 offset:128
    ds_write_b32 v46, v51 offset:132
    ds_write_b32 v46, v17 offset:192
    ds_write_b32 v46, v20 offset:196
    ds_write_b32 v46, v10 offset:256
    ds_write_b32 v46, v11 offset:260
    ds_write_b32 v46, v16 offset:320
    ds_write_b32 v46, v13 offset:324
    ds_write_b32 v46, v15 offset:384
    ds_write_b32 v46, v12 offset:388
    ds_write_b32 v46, v22 offset:448
    ds_write_b32 v46, v19 offset:452
    s_waitcnt lgkmcnt(0)
    s_mov_b64 exec, 0xff
    v_add_u32 v8, 64, v1
    v_and_b32 v42, 7, v8
    v_cvt_f32_u32 v43, v42
    v_lshrrev_b32 v44, 3, v8
    v_lshl_add_u32 v44, v44, 6, v42
    v_lshl_add_u32 v46, v8, 3, v49
    ds_read_b64 v[10:11], v46 offset:0
    ds_read_b64 v[12:13], v46 offset:576
    ds_read_b64 v[14:15], v46 offset:1152
    ds_read_b64 v[16:17], v46 offset:1728
    ds_read_b64 v[18:19], v46 offset:2304
    ds_read_b64 v[20:21], v46 offset:2880
    ds_read_b64 v[22:23], v46 offset:3456
    ds_read_b64 v[24:25], v46 offset:4032
    v_mul_f32 v45, 0x3c800000, v43
    v_cos_f32 v28, v45
    v_sin_f32 v29, v45
    v_mul_f32 v45, 0x3d000000, v43
    v_cos_f32 v30, v45
    v_sin_f32 v31, v45
    v_mul_f32 v45, 0x3d400000, v43
    v_cos_f32 v32, v45
    v_sin_f32 v33, v45
    v_mul_f32 v45, 0x3d800000, v43
    v_cos_f32 v34, v45
    v_sin_f32 v35, v45
    v_mul_f32 v45, 0x3da00000, v43
    v_cos_f32 v36, v45
    v_sin_f32 v37, v45
    v_mul_f32 v45, 0x3dc00000, v43
    v_cos_f32 v38, v45
    v_sin_f32 v39, v45
    v_mul_f32 v45, 0x3de00000, v43
    v_cos_f32 v40, v45
    v_sin_f32 v41, v45
    s_waitcnt lgkmcnt(0)
    v_mul_f32_e64 v50, v12, v28
    v_mul_f32_e64 v51, v12, v29
    v_fma_f32 v50, -v13, v29, v50
    v_fma_f32 v51, v13, v28, v51
    v_mul_f32_e64 v13, v14, v30
    v_mul_f32_e64 v12, v14, v31
    v_fma_f32 v13, -v15, v31, v13
    v_fma_f32 v12, v15, v30, v12
    v_mul_f32_e64 v15, v16, v32
    v_mul_f32_e64 v14, v16, v33
    v_fma_f32 v15, -v17, v33, v15
    v_fma_f32 v14, v17, v32, v14
    v_mul_f32_e64 v17, v18, v34
    v_mul_f32_e64 v16, v18, v35
    v_fma_f32 v17, -v19, v35, v17
    v_fma_f32 v16, v19, v34, v16
    v_mul_f32_e64 v19, v20, v36
    v_mul_f32_e64 v18, v20, v37
    v_fma_f32 v19, -v21, v37, v19
    v_fma_f32 v18, v21, v36, v18
    v_mul_f32_e64 v21, v22, v38
    v_mul_f32_e64 v20, v22, v39
    v_fma_f32 v21, -v23, v39, v21
    v_fma_f32 v20, v23, v38, v20
    v_mul_f32_e64 v23, v24, v40
    v_mul_f32_e64 v22, v24, v41
    v_fma_f32 v23, -v25, v41, v23
    v_fma_f32 v22, v25, v40, v22
    v_add_f32 v25, v10, v17
    v_sub_f32 v17, v10, v17
    v_add_f32 v10, v11, v16
    v_sub_f32 v16, v11, v16
    v_add_f32 v11, v50, v19
    v_sub_f32 v19, v50, v19
    v_add_f32 v50, v51, v18
    v_sub_f32 v18, v51, v18
    v_add_f32 v51, v13, v21
    v_sub_f32 v21, v13, v21
    v_add_f32 v13, v12, v20
    v_sub_f32 v20, v12, v20
    v_add_f32 v12, v15, v23
    v_sub_f32 v23, v15, v23
    v_add_f32 v15, v14, v22
    v_sub_f32 v22, v14, v22
    v_add_f32 v14, v25, v51
    v_sub_f32 v51, v25, v51
    v_add_f32 v25, v10, v13
    v_sub_f32 v13, v10, v13
    v_add_f32 v10, v11, v12
    v_sub_f32 v12, v11, v12
    v_add_f32 v11, v50, v15
    v_sub_f32 v15, v50, v15
    v_add_f32 v50, v14, v10
    v_sub_f32 v10, v14, v10
    v_add_f32 v14, v25, v11
    v_sub_f32 v11, v25, v11
    v_sub_f32 v25, v51, v15
    v_add_f32 v15, v51, v15
    v_add_f32 v51, v13, v12
    v_sub_f32 v12, v13, v12
    v_sub_f32 v13, v19, v18
    v_add_f32 v18, v19, v18
    v_mul_f32 v13, 0x3f3504f3, v13
    v_mul_f32 v18, 0x3f3504f3, v18
    v_add_f32 v19, v23, v22
    v_sub_f32 v22, v23, v22
    v_mul_f32 v19, 0x3f3504f3, v19
    v_mul_f32 v22, 0x3f3504f3, v22
    v_sub_f32 v23, v17, v20
    v_add_f32 v20, v17, v20
    v_add_f32 v17, v16, v21
    v_sub_f32 v21, v16, v21
    v_sub_f32 v16, v13, v19
    v_add_f32 v19, v13, v19
    v_add_f32 v13, v18, v22
    v_sub_f32 v22, v18, v22
    v_add_f32 v18, v23, v16
    v_sub_f32 v16, v23, v16
    v_add_f32 v23, v17, v13
    v_sub_f32 v13, v17, v13
    v_sub_f32 v17, v20, v22
    v_add_f32 v22, v20, v22
    v_add_f32 v20, v21, v19
    v_sub_f32 v19, v21, v19
    v_lshl_add_u32 v46, v44, 3, v6
    ds_write_b32 v46, v50 offset:0
    ds_write_b32 v46, v14 offset:4
    ds_write_b32 v46, v18 offset:64
    ds_write_b32 v46, v23 offset:68
    ds_write_b32 v46, v25 offset:128
    ds_write_b32 v46, v51 offset:132
    ds_write_b32 v46, v17 offset:192
    ds_write_b32 v46, v20 offset:196
    ds_write_b32 v46, v10 offset:256
    ds_write_b32 v46, v11 offset:260
    ds_write_b32 v46, v16 offset:320
    ds_write_b32 v46, v13 offset:324
    ds_write_b32 v46, v15 offset:384
    ds_write_b32 v46, v12 offset:388
    ds_write_b32 v46, v22 offset:448
    ds_write_b32 v46, v19 offset:452
    s_waitcnt lgkmcnt(0)
    s_mov_b64 exec, -1
    v_lshl_add_u32 v44, v1, 3, v6
    ds_read_b64 v[10:11], v44 offset:0
    ds_read_b64 v[12:13], v44 offset:512
    ds_read_b64 v[14:15], v44 offset:1024
    ds_read_b64 v[16:17], v44 offset:1536
    ds_read_b64 v[18:19], v44 offset:2048
    ds_read_b64 v[20:21], v44 offset:2560
    ds_read_b64 v[22:23], v44 offset:3072
    ds_read_b64 v[24:25], v44 offset:3584
    ds_read_b64 v[26:27], v44 offset:4096
    v_cvt_f32_u32 v42, v1
    s_waitcnt lgkmcnt(0)
    v_mul_f32 v45, 0x3ae38e39, v42
    v_cos_f32 v40, v45
    v_sin_f32 v41, v45
    v_mul_f32_e64 v50, v12, v40
    v_mul_f32_e64 v51, v12, v41
    v_fma_f32 v50, -v13, v41, v50
    v_fma_f32 v51, v13, v40, v51
    v_mul_f32 v45, 0x3b638e39, v42
    v_cos_f32 v40, v45
    v_sin_f32 v41, v45
    v_mul_f32_e64 v13, v14, v40
    v_mul_f32_e64 v12, v14, v41
    v_fma_f32 v13, -v15, v41, v13
    v_fma_f32 v12, v15, v40, v12
    v_mul_f32 v45, 0x3baaaaab, v42
    v_cos_f32 v40, v45
    v_sin_f32 v41, v45
    v_mul_f32_e64 v15, v16, v40
    v_mul_f32_e64 v14, v16, v41
    v_fma_f32 v15, -v17, v41, v15
    v_fma_f32 v14, v17, v40, v14
    v_mul_f32 v45, 0x3be38e39, v42
    v_cos_f32 v40, v45
    v_sin_f32 v41, v45
    v_mul_f32_e64 v17, v18, v40
    v_mul_f32_e64 v16, v18, v41
    v_fma_f32 v17, -v19, v41, v17
    v_fma_f32 v16, v19, v40, v16
    v_mul_f32 v45, 0x3c0e38e4, v42
    v_cos_f32 v40, v45
    v_sin_f32 v41, v45
    v_mul_f32_e64 v19, v20, v40
    v_mul_f32_e64 v18, v20, v41
    v_fma_f32 v19, -v21, v41, v19
    v_fma_f32 v18, v21, v40, v18
    v_mul_f32 v45, 0x3c2aaaab, v42
    v_cos_f32 v40, v45
    v_sin_f32 v41, v45
    v_mul_f32_e64 v21, v22, v40
    v_mul_f32_e64 v20, v22, v41
    v_fma_f32 v21, -v23, v41, v21
    v_fma_f32 v20, v23, v40, v20
    v_mul_f32 v45, 0x3c471c72, v42
    v_cos_f32 v40, v45
    v_sin_f32 v41, v45
    v_mul_f32_e64 v23, v24, v40
    v_mul_f32_e64 v22, v24, v41
    v_fma_f32 v23, -v25, v41, v23
    v_fma_f32 v22, v25, v40, v22
    v_mul_f32 v45, 0x3c638e39, v42
    v_cos_f32 v40, v45
    v_sin_f32 v41, v45
    v_mul_f32_e64 v25, v26, v40
    v_mul_f32_e64 v24, v26, v41
    v_fma_f32 v25, -v27, v41, v25
    v_fma_f32 v24, v27, v40, v24
    v_add_f32 v27, v15, v21
    v_sub_f32 v21, v15, v21
    v_add_f32 v15, v14, v20
    v_sub_f32 v20, v14, v20
    v_add_f32 v14, v10, v27
    v_fma_f32 v26, -0.5, v27, v10
    v_add_f32 v27, v11, v15
    v_fma_f32 v10, -0.5, v15, v11
    v_mov_b32 v15, v26
    v_fmac_f32 v15, 0xbf5db3d7, v20
    v_mov_b32 v11, v10
    v_fmac_f32 v11, 0x3f5db3d7, v21
    v_fmac_f32 v26, 0x3f5db3d7, v20
    v_fmac_f32 v10, 0xbf5db3d7, v21
    v_add_f32 v20, v17, v23
    v_sub_f32 v23, v17, v23
    v_add_f32 v17, v16, v22
    v_sub_f32 v22, v16, v22
    v_add_f32 v16, v50, v20
    v_fma_f32 v21, -0.5, v20, v50
    v_add_f32 v20, v51, v17
    v_fma_f32 v50, -0.5, v17, v51
    v_mov_b32 v17, v21
    v_fmac_f32 v17, 0xbf5db3d7, v22
    v_mov_b32 v51, v50
    v_fmac_f32 v51, 0x3f5db3d7, v23
    v_fmac_f32 v21, 0x3f5db3d7, v22
    v_fmac_f32 v50, 0xbf5db3d7, v23
    v_add_f32 v22, v19, v25
    v_sub_f32 v25, v19, v25
    v_add_f32 v19, v18, v24
    v_sub_f32 v24, v18, v24
    v_add_f32 v18, v13, v22
    v_fma_f32 v23, -0.5, v22, v13
    v_add_f32 v22, v12, v19
    v_fma_f32 v13, -0.5, v19, v12
    v_mov_b32 v19, v23
    v_fmac_f32 v19, 0xbf5db3d7, v24
    v_mov_b32 v12, v13
    v_fmac_f32 v12, 0x3f5db3d7, v25
    v_fmac_f32 v23, 0x3f5db3d7, v24
    v_fmac_f32 v13, 0xbf5db3d7, v25
    v_add_f32 v24, v16, v18
    v_sub_f32 v18, v16, v18
    v_add_f32 v16, v20, v22
    v_sub_f32 v22, v20, v22
    v_add_f32 v20, v14, v24
    v_fma_f32 v25, -0.5, v24, v14
    v_add_f32 v24, v27, v16
    v_fma_f32 v14, -0.5, v16, v27
    v_mov_b32 v16, v25
    v_fmac_f32 v16, 0xbf5db3d7, v22
    v_mov_b32 v27, v14
    v_fmac_f32 v27, 0x3f5db3d7, v18
    v_fmac_f32 v25, 0x3f5db3d7, v22
    v_fmac_f32 v14, 0xbf5db3d7, v18
    v_mul_f32 v22, 0x3f441b7d, v17
    v_fmac_f32 v22, 0xbf248dbb, v51
    v_mul_f32 v18, 0x3f248dbb, v17
    v_fmac_f32 v18, 0x3f441b7d, v51
    v_mul_f32 v51, 0x3e31d0d4, v19
    v_fmac_f32 v51, 0xbf7c1c5c, v12
    v_mul_f32 v17, 0x3f7c1c5c, v19
    v_fmac_f32 v17, 0x3e31d0d4, v12
    v_add_f32 v12, v22, v51
    v_sub_f32 v51, v22, v51
    v_add_f32 v22, v18, v17
    v_sub_f32 v17, v18, v17
    v_add_f32 v18, v15, v12
    v_fma_f32 v19, -0.5, v12, v15
    v_add_f32 v12, v11, v22
    v_fma_f32 v15, -0.5, v22, v11
    v_mov_b32 v22, v19
    v_fmac_f32 v22, 0xbf5db3d7, v17
    v_mov_b32 v11, v15
    v_fmac_f32 v11, 0x3f5db3d7, v51
    v_fmac_f32 v19, 0x3f5db3d7, v17
    v_fmac_f32 v15, 0xbf5db3d7, v51
    v_mul_f32 v17, 0x3e31d0d4, v21
    v_fmac_f32 v17, 0xbf7c1c5c, v50
    v_mul_f32 v51, 0x3f7c1c5c, v21
    v_fmac_f32 v51, 0x3e31d0d4, v50
    v_mul_f32 v50, 0xbf708fb2, v23
    v_fmac_f32 v50, 0xbeaf1d44, v13
    v_mul_f32 v21, 0x3eaf1d44, v23
    v_fmac_f32 v21, 0xbf708fb2, v13
    v_add_f32 v13, v17, v50
    v_sub_f32 v50, v17, v50
    v_add_f32 v17, v51, v21
    v_sub_f32 v21, v51, v21
    v_add_f32 v51, v26, v13
    v_fma_f32 v23, -0.5, v13, v26
    v_add_f32 v13, v10, v17
    v_fma_f32 v26, -0.5, v17, v10
    v_mov_b32 v17, v23
    v_fmac_f32 v17, 0xbf5db3d7, v21
    v_mov_b32 v10, v26
    v_fmac_f32 v10, 0x3f5db3d7, v50
    v_fmac_f32 v23, 0x3f5db3d7, v21
    v_fmac_f32 v26, 0xbf5db3d7, v50
    v_mov_b32 v50, v20
    v_mov_b32 v52, v24
    v_mov_b32 v53, v18
    v_mov_b32 v54, v12
    v_mov_b32 v55, v13
    v_mov_b32 v56, v16
    v_mov_b32 v57, v27
    v_mov_b32 v58, v22
    v_mov_b32 v59, v11
    v_mov_b32 v60, v17
    v_mov_b32 v61, v10
    v_mov_b32 v62, v25
    v_mov_b32 v63, v14
    v_mov_b32 v64, v19
    v_mov_b32 v65, v15
    v_mov_b32 v66, v23
    v_mov_b32 v67, v26
    s_movk_i32 s9, 1152
    v_mul_lo_u32 v4, v3, s9
    v_lshl_add_u32 v4, v1, 1, v4
    v_lshlrev_b32 v5, 2, v1
    s_add_u32 s10, s6, 4608
    s_addc_u32 s11, s7, 0
    s_add_u32 s12, s6, 6912
    s_addc_u32 s13, s7, 0
    s_add_u32 s16, s6, 9216
    s_addc_u32 s17, s7, 0
    global_load_ushort v10, v4, s[4:5] offset:0
    global_load_ushort v19, v4, s[4:5] offset:1152
    global_load_ushort v11, v4, s[4:5] offset:128
    global_load_ushort v20, v4, s[4:5] offset:1280
    global_load_ushort v12, v4, s[4:5] offset:256
    global_load_ushort v21, v4, s[4:5] offset:1408
    global_load_ushort v13, v4, s[4:5] offset:384
    global_load_ushort v22, v4, s[4:5] offset:1536
    global_load_ushort v14, v4, s[4:5] offset:512
    global_load_ushort v23, v4, s[4:5] offset:1664
    global_load_ushort v15, v4, s[4:5] offset:640
    global_load_ushort v24, v4, s[4:5] offset:1792
    global_load_ushort v16, v4, s[4:5] offset:768
    global_load_ushort v25, v4, s[4:5] offset:1920
    global_load_ushort v17, v4, s[4:5] offset:896
    global_load_ushort v26, v4, s[4:5] offset:2048
    global_load_ushort v18, v4, s[4:5] offset:1024
    global_load_ushort v27, v4, s[4:5] offset:2176
    global_load_dword v28, v5, s[10:11] offset:0
    global_load_dword v120, v5, s[12:13] offset:0
    global_load_dword v129, v5, s[16:17] offset:0
    global_load_dword v29, v5, s[10:11] offset:256
    global_load_dword v121, v5, s[12:13] offset:256
    global_load_dword v130, v5, s[16:17] offset:256
    global_load_dword v30, v5, s[10:11] offset:512
    global_load_dword v122, v5, s[12:13] offset:512
    global_load_dword v131, v5, s[16:17] offset:512
    global_load_dword v31, v5, s[10:11] offset:768
    global_load_dword v123, v5, s[12:13] offset:768
    global_load_dword v132, v5, s[16:17] offset:768
    global_load_dword v32, v5, s[10:11] offset:1024
    global_load_dword v124, v5, s[12:13] offset:1024
    global_load_dword v133, v5, s[16:17] offset:1024
    global_load_dword v33, v5, s[10:11] offset:1280
    global_load_dword v125, v5, s[12:13] offset:1280
    global_load_dword v134, v5, s[16:17] offset:1280
    global_load_dword v34, v5, s[10:11] offset:1536
    global_load_dword v126, v5, s[12:13] offset:1536
    global_load_dword v135, v5, s[16:17] offset:1536
    global_load_dword v35, v5, s[10:11] offset:1792
    global_load_dword v127, v5, s[12:13] offset:1792
    global_load_dword v136, v5, s[16:17] offset:1792
    global_load_dword v36, v5, s[10:11] offset:2048
    global_load_dword v128, v5, s[12:13] offset:2048
    global_load_dword v137, v5, s[16:17] offset:2048
    v_cvt_pk_bf16_f32 v45, v50, v53
    v_lshlrev_b32 v50, 16, v45
    v_and_b32 v53, 0xffff0000, v45
    v_cvt_pk_bf16_f32 v45, v51, v56
    v_lshlrev_b32 v51, 16, v45
    v_and_b32 v56, 0xffff0000, v45
    v_cvt_pk_bf16_f32 v45, v58, v60
    v_lshlrev_b32 v58, 16, v45
    v_and_b32 v60, 0xffff0000, v45
    v_cvt_pk_bf16_f32 v45, v62, v64
    v_lshlrev_b32 v62, 16, v45
    v_and_b32 v64, 0xffff0000, v45
    v_cvt_pk_bf16_f32 v45, v66, v52
    v_lshlrev_b32 v66, 16, v45
    v_and_b32 v52, 0xffff0000, v45
    v_cvt_pk_bf16_f32 v45, v54, v55
    v_lshlrev_b32 v54, 16, v45
    v_and_b32 v55, 0xffff0000, v45
    v_cvt_pk_bf16_f32 v45, v57, v59
    v_lshlrev_b32 v57, 16, v45
    v_and_b32 v59, 0xffff0000, v45
    v_cvt_pk_bf16_f32 v45, v61, v63
    v_lshlrev_b32 v61, 16, v45
    v_and_b32 v63, 0xffff0000, v45
    v_cvt_pk_bf16_f32 v45, v65, v67
    v_lshlrev_b32 v65, 16, v45
    v_and_b32 v67, 0xffff0000, v45
    s_waitcnt vmcnt(0)
    v_mul_f32 v50, v50, v28
    v_mul_f32 v52, v52, v28
    v_mul_f32 v53, v53, v29
    v_mul_f32 v54, v54, v29
    v_mul_f32 v51, v51, v30
    v_mul_f32 v55, v55, v30
    v_mul_f32 v56, v56, v31
    v_mul_f32 v57, v57, v31
    v_mul_f32 v58, v58, v32
    v_mul_f32 v59, v59, v32
    v_mul_f32 v60, v60, v33
    v_mul_f32 v61, v61, v33
    v_mul_f32 v62, v62, v34
    v_mul_f32 v63, v63, v34
    v_mul_f32 v64, v64, v35
    v_mul_f32 v65, v65, v35
    v_mul_f32 v66, v66, v36
    v_mul_f32 v67, v67, v36
    v_cvt_pk_bf16_f32 v45, v50, v53
    v_lshlrev_b32 v50, 16, v45
    v_and_b32 v53, 0xffff0000, v45
    v_cvt_pk_bf16_f32 v45, v51, v56
    v_lshlrev_b32 v51, 16, v45
    v_and_b32 v56, 0xffff0000, v45
    v_cvt_pk_bf16_f32 v45, v58, v60
    v_lshlrev_b32 v58, 16, v45
    v_and_b32 v60, 0xffff0000, v45
    v_cvt_pk_bf16_f32 v45, v62, v64
    v_lshlrev_b32 v62, 16, v45
    v_and_b32 v64, 0xffff0000, v45
    v_cvt_pk_bf16_f32 v45, v66, v52
    v_lshlrev_b32 v66, 16, v45
    v_and_b32 v52, 0xffff0000, v45
    v_cvt_pk_bf16_f32 v45, v54, v55
    v_lshlrev_b32 v54, 16, v45
    v_and_b32 v55, 0xffff0000, v45
    v_cvt_pk_bf16_f32 v45, v57, v59
    v_lshlrev_b32 v57, 16, v45
    v_and_b32 v59, 0xffff0000, v45
    v_cvt_pk_bf16_f32 v45, v61, v63
    v_lshlrev_b32 v61, 16, v45
    v_and_b32 v63, 0xffff0000, v45
    v_cvt_pk_bf16_f32 v45, v65, v67
    v_lshlrev_b32 v65, 16, v45
    v_and_b32 v67, 0xffff0000, v45
    v_lshlrev_b32 v10, 16, v10
    v_lshlrev_b32 v19, 16, v19
    v_add_f32 v50, v50, v10
    v_add_f32 v52, v52, v19
    v_lshlrev_b32 v11, 16, v11
    v_lshlrev_b32 v20, 16, v20
    v_add_f32 v53, v53, v11
    v_add_f32 v54, v54, v20
    v_lshlrev_b32 v12, 16, v12
    v_lshlrev_b32 v21, 16, v21
    v_add_f32 v51, v51, v12
    v_add_f32 v55, v55, v21
    v_lshlrev_b32 v13, 16, v13
    v_lshlrev_b32 v22, 16, v22
    v_add_f32 v56, v56, v13
    v_add_f32 v57, v57, v22
    v_lshlrev_b32 v14, 16, v14
    v_lshlrev_b32 v23, 16, v23
    v_add_f32 v58, v58, v14
    v_add_f32 v59, v59, v23
    v_lshlrev_b32 v15, 16, v15
    v_lshlrev_b32 v24, 16, v24
    v_add_f32 v60, v60, v15
    v_add_f32 v61, v61, v24
    v_lshlrev_b32 v16, 16, v16
    v_lshlrev_b32 v25, 16, v25
    v_add_f32 v62, v62, v16
    v_add_f32 v63, v63, v25
    v_lshlrev_b32 v17, 16, v17
    v_lshlrev_b32 v26, 16, v26
    v_add_f32 v64, v64, v17
    v_add_f32 v65, v65, v26
    v_lshlrev_b32 v18, 16, v18
    v_lshlrev_b32 v27, 16, v27
    v_add_f32 v66, v66, v18
    v_add_f32 v67, v67, v27
    v_cvt_pk_bf16_f32 v45, v50, v53
    v_lshlrev_b32 v50, 16, v45
    v_and_b32 v53, 0xffff0000, v45
    v_cvt_pk_bf16_f32 v45, v51, v56
    v_lshlrev_b32 v51, 16, v45
    v_and_b32 v56, 0xffff0000, v45
    v_cvt_pk_bf16_f32 v45, v58, v60
    v_lshlrev_b32 v58, 16, v45
    v_and_b32 v60, 0xffff0000, v45
    v_cvt_pk_bf16_f32 v45, v62, v64
    v_lshlrev_b32 v62, 16, v45
    v_and_b32 v64, 0xffff0000, v45
    v_cvt_pk_bf16_f32 v45, v66, v52
    v_lshlrev_b32 v66, 16, v45
    v_and_b32 v52, 0xffff0000, v45
    v_cvt_pk_bf16_f32 v45, v54, v55
    v_lshlrev_b32 v54, 16, v45
    v_and_b32 v55, 0xffff0000, v45
    v_cvt_pk_bf16_f32 v45, v57, v59
    v_lshlrev_b32 v57, 16, v45
    v_and_b32 v59, 0xffff0000, v45
    v_cvt_pk_bf16_f32 v45, v61, v63
    v_lshlrev_b32 v61, 16, v45
    v_and_b32 v63, 0xffff0000, v45
    v_cvt_pk_bf16_f32 v45, v65, v67
    v_lshlrev_b32 v65, 16, v45
    v_and_b32 v67, 0xffff0000, v45
    s_add_u32 s18, s6, 14680064
    s_addc_u32 s19, s7, 0
    global_store_short_d16_hi v4, v50, s[18:19] offset:0
    global_store_short_d16_hi v4, v52, s[18:19] offset:1152
    global_store_short_d16_hi v4, v53, s[18:19] offset:128
    global_store_short_d16_hi v4, v54, s[18:19] offset:1280
    global_store_short_d16_hi v4, v51, s[18:19] offset:256
    global_store_short_d16_hi v4, v55, s[18:19] offset:1408
    global_store_short_d16_hi v4, v56, s[18:19] offset:384
    global_store_short_d16_hi v4, v57, s[18:19] offset:1536
    global_store_short_d16_hi v4, v58, s[18:19] offset:512
    global_store_short_d16_hi v4, v59, s[18:19] offset:1664
    global_store_short_d16_hi v4, v60, s[18:19] offset:640
    global_store_short_d16_hi v4, v61, s[18:19] offset:1792
    global_store_short_d16_hi v4, v62, s[18:19] offset:768
    global_store_short_d16_hi v4, v63, s[18:19] offset:1920
    global_store_short_d16_hi v4, v64, s[18:19] offset:896
    global_store_short_d16_hi v4, v65, s[18:19] offset:2048
    global_store_short_d16_hi v4, v66, s[18:19] offset:1024
    global_store_short_d16_hi v4, v67, s[18:19] offset:2176
    v_add_f32 v46, v50, v53
    v_add_f32 v46, v46, v51
    v_add_f32 v46, v46, v56
    v_add_f32 v46, v46, v58
    v_add_f32 v46, v46, v60
    v_add_f32 v46, v46, v62
    v_add_f32 v46, v46, v64
    v_add_f32 v46, v46, v66
    s_nop 1
    v_add_f32 v46, v46, v46 quad_perm:[1,0,3,2] row_mask:0xf bank_mask:0xf
    s_nop 1
    v_add_f32 v46, v46, v46 quad_perm:[2,3,0,1] row_mask:0xf bank_mask:0xf
    s_nop 1
    v_add_f32 v46, v46, v46 row_half_mirror row_mask:0xf bank_mask:0xf
    s_nop 1
    v_add_f32 v46, v46, v46 row_mirror row_mask:0xf bank_mask:0xf
    s_nop 0
    v_readlane_b32 s20, v46, 0
    v_readlane_b32 s21, v46, 16
    v_readlane_b32 s22, v46, 32
    v_readlane_b32 s23, v46, 48
    v_mov_b32 v46, s20
    v_add_f32 v46, s21, v46
    v_add_f32 v46, s22, v46
    v_add_f32 v46, s23, v46
    v_mul_f32 v46, 0x3ae38e39, v46
    v_sub_f32 v47, v50, v46
    v_mul_f32 v48, v47, v47
    v_sub_f32 v47, v53, v46
    v_fmac_f32 v48, v47, v47
    v_sub_f32 v47, v51, v46
    v_fmac_f32 v48, v47, v47
    v_sub_f32 v47, v56, v46
    v_fmac_f32 v48, v47, v47
    v_sub_f32 v47, v58, v46
    v_fmac_f32 v48, v47, v47
    v_sub_f32 v47, v60, v46
    v_fmac_f32 v48, v47, v47
    v_sub_f32 v47, v62, v46
    v_fmac_f32 v48, v47, v47
    v_sub_f32 v47, v64, v46
    v_fmac_f32 v48, v47, v47
    v_sub_f32 v47, v66, v46
    v_fmac_f32 v48, v47, v47
    s_nop 1
    v_add_f32 v48, v48, v48 quad_perm:[1,0,3,2] row_mask:0xf bank_mask:0xf
    s_nop 1
    v_add_f32 v48, v48, v48 quad_perm:[2,3,0,1] row_mask:0xf bank_mask:0xf
    s_nop 1
    v_add_f32 v48, v48, v48 row_half_mirror row_mask:0xf bank_mask:0xf
    s_nop 1
    v_add_f32 v48, v48, v48 row_mirror row_mask:0xf bank_mask:0xf
    s_nop 0
    v_readlane_b32 s20, v48, 0
    v_readlane_b32 s21, v48, 16
    v_readlane_b32 s22, v48, 32
    v_readlane_b32 s23, v48, 48
    v_mov_b32 v48, s20
    v_add_f32 v48, s21, v48
    v_add_f32 v48, s22, v48
    v_add_f32 v48, s23, v48
    v_mul_f32 v48, 0x3ae38e39, v48
    v_cvt_pk_bf16_f32 v47, v46, v48
    v_lshlrev_b32 v46, 16, v47
    v_and_b32 v48, 0xffff0000, v47
    v_add_f32 v48, 0x3727c5ac, v48
    v_cvt_pk_bf16_f32 v47, v48, v48
    v_lshlrev_b32 v48, 16, v47
    v_sqrt_f32 v48, v48
    s_nop 0
    v_cvt_pk_bf16_f32 v47, v48, v48
    v_lshlrev_b32 v48, 16, v47
    v_rcp_f32 v48, v48
    v_sub_f32 v50, v50, v46
    v_sub_f32 v53, v53, v46
    v_sub_f32 v51, v51, v46
    v_sub_f32 v56, v56, v46
    v_sub_f32 v58, v58, v46
    v_sub_f32 v60, v60, v46
    v_sub_f32 v62, v62, v46
    v_sub_f32 v64, v64, v46
    v_sub_f32 v66, v66, v46
    v_cvt_pk_bf16_f32 v47, v50, v53
    v_lshlrev_b32 v50, 16, v47
    v_and_b32 v53, 0xffff0000, v47
    v_cvt_pk_bf16_f32 v47, v51, v56
    v_lshlrev_b32 v51, 16, v47
    v_and_b32 v56, 0xffff0000, v47
    v_cvt_pk_bf16_f32 v47, v58, v60
    v_lshlrev_b32 v58, 16, v47
    v_and_b32 v60, 0xffff0000, v47
    v_cvt_pk_bf16_f32 v47, v62, v64
    v_lshlrev_b32 v62, 16, v47
    v_and_b32 v64, 0xffff0000, v47
    v_cvt_pk_bf16_f32 v47, v66, v66
    v_lshlrev_b32 v66, 16, v47
    v_mul_f32 v50, v50, v48
    v_mul_f32 v53, v53, v48
    v_mul_f32 v51, v51, v48
    v_mul_f32 v56, v56, v48
    v_mul_f32 v58, v58, v48
    v_mul_f32 v60, v60, v48
    v_mul_f32 v62, v62, v48
    v_mul_f32 v64, v64, v48
    v_mul_f32 v66, v66, v48
    v_cvt_pk_bf16_f32 v47, v50, v53
    v_lshlrev_b32 v50, 16, v47
    v_and_b32 v53, 0xffff0000, v47
    v_cvt_pk_bf16_f32 v47, v51, v56
    v_lshlrev_b32 v51, 16, v47
    v_and_b32 v56, 0xffff0000, v47
    v_cvt_pk_bf16_f32 v47, v58, v60
    v_lshlrev_b32 v58, 16, v47
    v_and_b32 v60, 0xffff0000, v47
    v_cvt_pk_bf16_f32 v47, v62, v64
    v_lshlrev_b32 v62, 16, v47
    v_and_b32 v64, 0xffff0000, v47
    v_cvt_pk_bf16_f32 v47, v66, v66
    v_lshlrev_b32 v66, 16, v47
    v_mul_f32 v50, v50, v129
    v_mul_f32 v53, v53, v130
    v_mul_f32 v51, v51, v131
    v_mul_f32 v56, v56, v132
    v_mul_f32 v58, v58, v133
    v_mul_f32 v60, v60, v134
    v_mul_f32 v62, v62, v135
    v_mul_f32 v64, v64, v136
    v_mul_f32 v66, v66, v137
    v_cvt_pk_bf16_f32 v47, v50, v53
    v_lshlrev_b32 v50, 16, v47
    v_and_b32 v53, 0xffff0000, v47
    v_cvt_pk_bf16_f32 v47, v51, v56
    v_lshlrev_b32 v51, 16, v47
    v_and_b32 v56, 0xffff0000, v47
    v_cvt_pk_bf16_f32 v47, v58, v60
    v_lshlrev_b32 v58, 16, v47
    v_and_b32 v60, 0xffff0000, v47
    v_cvt_pk_bf16_f32 v47, v62, v64
    v_lshlrev_b32 v62, 16, v47
    v_and_b32 v64, 0xffff0000, v47
    v_cvt_pk_bf16_f32 v47, v66, v66
    v_lshlrev_b32 v66, 16, v47
    v_add_f32 v50, v50, v120
    v_add_f32 v53, v53, v121
    v_add_f32 v51, v51, v122
    v_add_f32 v56, v56, v123
    v_add_f32 v58, v58, v124
    v_add_f32 v60, v60, v125
    v_add_f32 v62, v62, v126
    v_add_f32 v64, v64, v127
    v_add_f32 v66, v66, v128
    v_cvt_pk_bf16_f32 v47, v50, v53
    v_lshlrev_b32 v50, 16, v47
    v_and_b32 v53, 0xffff0000, v47
    v_cvt_pk_bf16_f32 v47, v51, v56
    v_lshlrev_b32 v51, 16, v47
    v_and_b32 v56, 0xffff0000, v47
    v_cvt_pk_bf16_f32 v47, v58, v60
    v_lshlrev_b32 v58, 16, v47
    v_and_b32 v60, 0xffff0000, v47
    v_cvt_pk_bf16_f32 v47, v62, v64
    v_lshlrev_b32 v62, 16, v47
    v_and_b32 v64, 0xffff0000, v47
    v_cvt_pk_bf16_f32 v47, v66, v66
    v_lshlrev_b32 v66, 16, v47
    v_add_f32 v46, v52, v54
    v_add_f32 v46, v46, v55
    v_add_f32 v46, v46, v57
    v_add_f32 v46, v46, v59
    v_add_f32 v46, v46, v61
    v_add_f32 v46, v46, v63
    v_add_f32 v46, v46, v65
    v_add_f32 v46, v46, v67
    s_nop 1
    v_add_f32 v46, v46, v46 quad_perm:[1,0,3,2] row_mask:0xf bank_mask:0xf
    s_nop 1
    v_add_f32 v46, v46, v46 quad_perm:[2,3,0,1] row_mask:0xf bank_mask:0xf
    s_nop 1
    v_add_f32 v46, v46, v46 row_half_mirror row_mask:0xf bank_mask:0xf
    s_nop 1
    v_add_f32 v46, v46, v46 row_mirror row_mask:0xf bank_mask:0xf
    s_nop 0
    v_readlane_b32 s20, v46, 0
    v_readlane_b32 s21, v46, 16
    v_readlane_b32 s22, v46, 32
    v_readlane_b32 s23, v46, 48
    v_mov_b32 v46, s20
    v_add_f32 v46, s21, v46
    v_add_f32 v46, s22, v46
    v_add_f32 v46, s23, v46
    v_mul_f32 v46, 0x3ae38e39, v46
    v_sub_f32 v47, v52, v46
    v_mul_f32 v48, v47, v47
    v_sub_f32 v47, v54, v46
    v_fmac_f32 v48, v47, v47
    v_sub_f32 v47, v55, v46
    v_fmac_f32 v48, v47, v47
    v_sub_f32 v47, v57, v46
    v_fmac_f32 v48, v47, v47
    v_sub_f32 v47, v59, v46
    v_fmac_f32 v48, v47, v47
    v_sub_f32 v47, v61, v46
    v_fmac_f32 v48, v47, v47
    v_sub_f32 v47, v63, v46
    v_fmac_f32 v48, v47, v47
    v_sub_f32 v47, v65, v46
    v_fmac_f32 v48, v47, v47
    v_sub_f32 v47, v67, v46
    v_fmac_f32 v48, v47, v47
    s_nop 1
    v_add_f32 v48, v48, v48 quad_perm:[1,0,3,2] row_mask:0xf bank_mask:0xf
    s_nop 1
    v_add_f32 v48, v48, v48 quad_perm:[2,3,0,1] row_mask:0xf bank_mask:0xf
    s_nop 1
    v_add_f32 v48, v48, v48 row_half_mirror row_mask:0xf bank_mask:0xf
    s_nop 1
    v_add_f32 v48, v48, v48 row_mirror row_mask:0xf bank_mask:0xf
    s_nop 0
    v_readlane_b32 s20, v48, 0
    v_readlane_b32 s21, v48, 16
    v_readlane_b32 s22, v48, 32
    v_readlane_b32 s23, v48, 48
    v_mov_b32 v48, s20
    v_add_f32 v48, s21, v48
    v_add_f32 v48, s22, v48
    v_add_f32 v48, s23, v48
    v_mul_f32 v48, 0x3ae38e39, v48
    v_cvt_pk_bf16_f32 v47, v46, v48
    v_lshlrev_b32 v46, 16, v47
    v_and_b32 v48, 0xffff0000, v47
    v_add_f32 v48, 0x3727c5ac, v48
    v_cvt_pk_bf16_f32 v47, v48, v48
    v_lshlrev_b32 v48, 16, v47
    v_sqrt_f32 v48, v48
    s_nop 0
    v_cvt_pk_bf16_f32 v47, v48, v48
    v_lshlrev_b32 v48, 16, v47
    v_rcp_f32 v48, v48
    v_sub_f32 v52, v52, v46
    v_sub_f32 v54, v54, v46
    v_sub_f32 v55, v55, v46
    v_sub_f32 v57, v57, v46
    v_sub_f32 v59, v59, v46
    v_sub_f32 v61, v61, v46
    v_sub_f32 v63, v63, v46
    v_sub_f32 v65, v65, v46
    v_sub_f32 v67, v67, v46
    v_cvt_pk_bf16_f32 v47, v52, v54
    v_lshlrev_b32 v52, 16, v47
    v_and_b32 v54, 0xffff0000, v47
    v_cvt_pk_bf16_f32 v47, v55, v57
    v_lshlrev_b32 v55, 16, v47
    v_and_b32 v57, 0xffff0000, v47
    v_cvt_pk_bf16_f32 v47, v59, v61
    v_lshlrev_b32 v59, 16, v47
    v_and_b32 v61, 0xffff0000, v47
    v_cvt_pk_bf16_f32 v47, v63, v65
    v_lshlrev_b32 v63, 16, v47
    v_and_b32 v65, 0xffff0000, v47
    v_cvt_pk_bf16_f32 v47, v67, v67
    v_lshlrev_b32 v67, 16, v47
    v_mul_f32 v52, v52, v48
    v_mul_f32 v54, v54, v48
    v_mul_f32 v55, v55, v48
    v_mul_f32 v57, v57, v48
    v_mul_f32 v59, v59, v48
    v_mul_f32 v61, v61, v48
    v_mul_f32 v63, v63, v48
    v_mul_f32 v65, v65, v48
    v_mul_f32 v67, v67, v48
    v_cvt_pk_bf16_f32 v47, v52, v54
    v_lshlrev_b32 v52, 16, v47
    v_and_b32 v54, 0xffff0000, v47
    v_cvt_pk_bf16_f32 v47, v55, v57
    v_lshlrev_b32 v55, 16, v47
    v_and_b32 v57, 0xffff0000, v47
    v_cvt_pk_bf16_f32 v47, v59, v61
    v_lshlrev_b32 v59, 16, v47
    v_and_b32 v61, 0xffff0000, v47
    v_cvt_pk_bf16_f32 v47, v63, v65
    v_lshlrev_b32 v63, 16, v47
    v_and_b32 v65, 0xffff0000, v47
    v_cvt_pk_bf16_f32 v47, v67, v67
    v_lshlrev_b32 v67, 16, v47
    v_mul_f32 v52, v52, v129
    v_mul_f32 v54, v54, v130
    v_mul_f32 v55, v55, v131
    v_mul_f32 v57, v57, v132
    v_mul_f32 v59, v59, v133
    v_mul_f32 v61, v61, v134
    v_mul_f32 v63, v63, v135
    v_mul_f32 v65, v65, v136
    v_mul_f32 v67, v67, v137
    v_cvt_pk_bf16_f32 v47, v52, v54
    v_lshlrev_b32 v52, 16, v47
    v_and_b32 v54, 0xffff0000, v47
    v_cvt_pk_bf16_f32 v47, v55, v57
    v_lshlrev_b32 v55, 16, v47
    v_and_b32 v57, 0xffff0000, v47
    v_cvt_pk_bf16_f32 v47, v59, v61
    v_lshlrev_b32 v59, 16, v47
    v_and_b32 v61, 0xffff0000, v47
    v_cvt_pk_bf16_f32 v47, v63, v65
    v_lshlrev_b32 v63, 16, v47
    v_and_b32 v65, 0xffff0000, v47
    v_cvt_pk_bf16_f32 v47, v67, v67
    v_lshlrev_b32 v67, 16, v47
    v_add_f32 v52, v52, v120
    v_add_f32 v54, v54, v121
    v_add_f32 v55, v55, v122
    v_add_f32 v57, v57, v123
    v_add_f32 v59, v59, v124
    v_add_f32 v61, v61, v125
    v_add_f32 v63, v63, v126
    v_add_f32 v65, v65, v127
    v_add_f32 v67, v67, v128
    v_cvt_pk_bf16_f32 v47, v52, v54
    v_lshlrev_b32 v52, 16, v47
    v_and_b32 v54, 0xffff0000, v47
    v_cvt_pk_bf16_f32 v47, v55, v57
    v_lshlrev_b32 v55, 16, v47
    v_and_b32 v57, 0xffff0000, v47
    v_cvt_pk_bf16_f32 v47, v59, v61
    v_lshlrev_b32 v59, 16, v47
    v_and_b32 v61, 0xffff0000, v47
    v_cvt_pk_bf16_f32 v47, v63, v65
    v_lshlrev_b32 v63, 16, v47
    v_and_b32 v65, 0xffff0000, v47
    v_cvt_pk_bf16_f32 v47, v67, v67
    v_lshlrev_b32 v67, 16, v47
    s_add_u32 s18, s6, 17825792
    s_addc_u32 s19, s7, 0
    global_store_short_d16_hi v4, v50, s[18:19] offset:0
    global_store_short_d16_hi v4, v52, s[18:19] offset:1152
    global_store_short_d16_hi v4, v53, s[18:19] offset:128
    global_store_short_d16_hi v4, v54, s[18:19] offset:1280
    global_store_short_d16_hi v4, v51, s[18:19] offset:256
    global_store_short_d16_hi v4, v55, s[18:19] offset:1408
    global_store_short_d16_hi v4, v56, s[18:19] offset:384
    global_store_short_d16_hi v4, v57, s[18:19] offset:1536
    global_store_short_d16_hi v4, v58, s[18:19] offset:512
    global_store_short_d16_hi v4, v59, s[18:19] offset:1664
    global_store_short_d16_hi v4, v60, s[18:19] offset:640
    global_store_short_d16_hi v4, v61, s[18:19] offset:1792
    global_store_short_d16_hi v4, v62, s[18:19] offset:768
    global_store_short_d16_hi v4, v63, s[18:19] offset:1920
    global_store_short_d16_hi v4, v64, s[18:19] offset:896
    global_store_short_d16_hi v4, v65, s[18:19] offset:2048
    global_store_short_d16_hi v4, v66, s[18:19] offset:1024
    global_store_short_d16_hi v4, v67, s[18:19] offset:2176
    s_waitcnt vmcnt(0)
Lk4_end:
    s_endpgm
.globl k5_gemm1_kernel
.p2align 8
.type k5_gemm1_kernel,@function
k5_gemm1_kernel:
    s_cmp_ge_u32 s2, 256
    s_cbranch_scc1 Lg1_end
    s_load_dwordx2 s[16:17], s[0:1], 32
    s_load_dwordx2 s[18:19], s[0:1], 80
    v_and_b32 v104, 63, v0
    v_lshrrev_b32 v105, 6, v0
    s_nop 0
    v_readfirstlane_b32 s20, v105
    s_waitcnt lgkmcnt(0)
    s_and_b32 s21, s2, 15
    s_lshr_b32 s22, s2, 4
    s_mov_b32 s23, 0
    s_mul_i32 s24, s22, 147456
    s_add_u32 s4, s18, 17825792
    s_addc_u32 s5, s19, 0
    s_add_u32 s4, s4, s24
    s_addc_u32 s5, s5, 0
    s_and_b32 s5, s5, 0xffff
    s_sub_u32 s6, 2359296, s24
    s_mov_b32 s7, 0x00020000
    s_mul_i32 s25, s21, 576
    s_add_u32 s8, s16, s25
    s_addc_u32 s9, s17, 0
    s_and_b32 s9, s9, 0xffff
    s_sub_u32 s10, 5308416, s25
    s_mov_b32 s11, 0x00020000
    s_mul_i32 s27, s20, 256
    v_add_u32 v0, s27, v104
    v_add_u32 v0, 0, v0
    v_lshrrev_b32 v1, 3, v0
    v_and_b32 v2, 7, v0
    v_and_b32 v3, 7, v1
    v_xor_b32 v2, v2, v3
    s_movk_i32 s28, 1152
    v_mul_lo_u32 v1, v1, s28
    v_lshl_add_u32 v106, v2, 4, v1
    s_mul_i32 s27, s20, 256
    v_add_u32 v0, s27, v104
    v_add_u32 v0, 64, v0
    v_lshrrev_b32 v1, 3, v0
    v_and_b32 v2, 7, v0
    v_and_b32 v3, 7, v1
    v_xor_b32 v2, v2, v3
    s_movk_i32 s28, 1152
    v_mul_lo_u32 v1, v1, s28
    v_lshl_add_u32 v107, v2, 4, v1
    s_mul_i32 s27, s20, 256
    v_add_u32 v0, s27, v104
    v_add_u32 v0, 128, v0
    v_lshrrev_b32 v1, 3, v0
    v_and_b32 v2, 7, v0
    v_and_b32 v3, 7, v1
    v_xor_b32 v2, v2, v3
    s_movk_i32 s28, 1152
    v_mul_lo_u32 v1, v1, s28
    v_lshl_add_u32 v108, v2, 4, v1
    s_mul_i32 s27, s20, 256
    v_add_u32 v0, s27, v104
    v_add_u32 v0, 192, v0
    v_lshrrev_b32 v1, 3, v0
    v_and_b32 v2, 7, v0
    v_and_b32 v3, 7, v1
    v_xor_b32 v2, v2, v3
    s_movk_i32 s28, 1152
    v_mul_lo_u32 v1, v1, s28
    v_lshl_add_u32 v109, v2, 4, v1
    s_mul_i32 s27, s20, 576
    v_add_u32 v0, s27, v104
    v_add_u32 v0, 0, v0
    v_mul_u32_u24 v1, 1821, v0
    v_lshrrev_b32 v1, 16, v1
    v_mul_u32_u24 v2, 36, v1
    v_sub_u32 v2, v0, v2
    s_mov_b32 s28, 9216
    v_mul_lo_u32 v1, v1, s28
    v_lshl_add_u32 v114, v2, 4, v1
    s_mul_i32 s27, s20, 576
    v_add_u32 v0, s27, v104
    v_add_u32 v0, 64, v0
    v_mul_u32_u24 v1, 1821, v0
    v_lshrrev_b32 v1, 16, v1
    v_mul_u32_u24 v2, 36, v1
    v_sub_u32 v2, v0, v2
    s_mov_b32 s28, 9216
    v_mul_lo_u32 v1, v1, s28
    v_lshl_add_u32 v115, v2, 4, v1
    s_mul_i32 s27, s20, 576
    v_add_u32 v0, s27, v104
    v_add_u32 v0, 128, v0
    v_mul_u32_u24 v1, 1821, v0
    v_lshrrev_b32 v1, 16, v1
    v_mul_u32_u24 v2, 36, v1
    v_sub_u32 v2, v0, v2
    s_mov_b32 s28, 9216
    v_mul_lo_u32 v1, v1, s28
    v_lshl_add_u32 v116, v2, 4, v1
    s_mul_i32 s27, s20, 576
    v_add_u32 v0, s27, v104
    v_add_u32 v0, 192, v0
    v_mul_u32_u24 v1, 1821, v0
    v_lshrrev_b32 v1, 16, v1
    v_mul_u32_u24 v2, 36, v1
    v_sub_u32 v2, v0, v2
    s_mov_b32 s28, 9216
    v_mul_lo_u32 v1, v1, s28
    v_lshl_add_u32 v117, v2, 4, v1
    s_mul_i32 s27, s20, 576
    v_add_u32 v0, s27, v104
    v_add_u32 v0, 256, v0
    v_mul_u32_u24 v1, 1821, v0
    v_lshrrev_b32 v1, 16, v1
    v_mul_u32_u24 v2, 36, v1
    v_sub_u32 v2, v0, v2
    s_mov_b32 s28, 9216
    v_mul_lo_u32 v1, v1, s28
    v_lshl_add_u32 v118, v2, 4, v1
    s_mul_i32 s27, s20, 576
    v_add_u32 v0, s27, v104
    v_add_u32 v0, 320, v0
    v_mul_u32_u24 v1, 1821, v0
    v_lshrrev_b32 v1, 16, v1
    v_mul_u32_u24 v2, 36, v1
    v_sub_u32 v2, v0, v2
    s_mov_b32 s28, 9216
    v_mul_lo_u32 v1, v1, s28
    v_lshl_add_u32 v119, v2, 4, v1
    s_mul_i32 s27, s20, 576
    v_add_u32 v0, s27, v104
    v_add_u32 v0, 384, v0
    v_mul_u32_u24 v1, 1821, v0
    v_lshrrev_b32 v1, 16, v1
    v_mul_u32_u24 v2, 36, v1
    v_sub_u32 v2, v0, v2
    s_mov_b32 s28, 9216
    v_mul_lo_u32 v1, v1, s28
    v_lshl_add_u32 v120, v2, 4, v1
    s_mul_i32 s27, s20, 576
    v_add_u32 v0, s27, v104
    v_add_u32 v0, 448, v0
    v_mul_u32_u24 v1, 1821, v0
    v_lshrrev_b32 v1, 16, v1
    v_mul_u32_u24 v2, 36, v1
    v_sub_u32 v2, v0, v2
    s_mov_b32 s28, 9216
    v_mul_lo_u32 v1, v1, s28
    v_lshl_add_u32 v121, v2, 4, v1
    s_mul_i32 s27, s20, 576
    v_add_u32 v0, s27, v104
    v_add_u32 v0, 512, v0
    v_mul_u32_u24 v1, 1821, v0
    v_lshrrev_b32 v1, 16, v1
    v_mul_u32_u24 v2, 36, v1
    v_sub_u32 v2, v0, v2
    s_mov_b32 s28, 9216
    v_mul_lo_u32 v1, v1, s28
    v_lshl_add_u32 v122, v2, 4, v1
    s_mul_i32 s29, s20, 4096
    s_mul_i32 s30, s20, 9216
    s_add_u32 s30, s30, 16384
    v_lshrrev_b32 v0, 4, v104
    v_and_b32 v1, 15, v104
    s_lshr_b32 s31, s20, 1
    s_and_b32 s32, s20, 1
    s_lshl_b32 s33, s31, 6
    v_add_u32 v2, s33, v1
    v_mul_u32_u24 v2, 128, v2
    v_and_b32 v3, 7, v1
    v_add_u32 v4, 0, v0
    v_xor_b32 v4, v4, v3
    v_lshl_add_u32 v123, v4, 4, v2
    v_lshl_add_u32 v124, v4, 4, v2
    v_add_u32 v124, 53248, v124
    v_lshl_add_u32 v125, v4, 4, v2
    v_add_u32 v125, 106496, v125
    v_add_u32 v4, 4, v0
    v_xor_b32 v4, v4, v3
    v_lshl_add_u32 v126, v4, 4, v2
    v_lshl_add_u32 v127, v4, 4, v2
    v_add_u32 v127, 53248, v127
    v_lshl_add_u32 v128, v4, 4, v2
    v_add_u32 v128, 106496, v128
    v_lshrrev_b32 v4, 2, v1
    v_lshl_add_u32 v4, v0, 3, v4
    v_mul_u32_u24 v4, 576, v4
    v_add_u32 v4, 16384, v4
    s_mul_i32 s34, s32, 288
    v_add_u32 v4, s34, v4
    v_and_b32 v5, 3, v1
    v_lshl_add_u32 v129, v5, 4, v4
    v_lshl_add_u32 v130, v5, 3, v4
    v_add_u32 v130, 256, v130
    v_lshl_add_u32 v131, v5, 4, v4
    v_lshl_add_u32 v132, v5, 3, v4
    v_add_u32 v132, 256, v132
    v_add_u32 v131, 53248, v131
    v_add_u32 v132, 53248, v132
    v_lshl_add_u32 v133, v5, 4, v4
    v_lshl_add_u32 v134, v5, 3, v4
    v_add_u32 v134, 256, v134
    v_add_u32 v133, 106496, v133
    v_add_u32 v134, 106496, v134
    s_mov_b32 s12, 0
    s_mov_b32 s13, 0
    s_add_u32 m0, s29, 0
    s_nop 0
    buffer_load_dwordx4 v106, s[4:7], s12 offen lds
    s_add_u32 m0, s29, 1024
    s_nop 0
    buffer_load_dwordx4 v107, s[4:7], s12 offen lds
    s_add_u32 m0, s29, 2048
    s_nop 0
    buffer_load_dwordx4 v108, s[4:7], s12 offen lds
    s_add_u32 m0, s29, 3072
    s_nop 0
    buffer_load_dwordx4 v109, s[4:7], s12 offen lds
    s_add_u32 m0, s30, 0
    s_nop 0
    buffer_load_dwordx4 v114, s[8:11], s13 offen lds
    s_add_u32 m0, s30, 1024
    s_nop 0
    buffer_load_dwordx4 v115, s[8:11], s13 offen lds
    s_add_u32 m0, s30, 2048
    s_nop 0
    buffer_load_dwordx4 v116, s[8:11], s13 offen lds
    s_add_u32 m0, s30, 3072
    s_nop 0
    buffer_load_dwordx4 v117, s[8:11], s13 offen lds
    s_add_u32 m0, s30, 4096
    s_nop 0
    buffer_load_dwordx4 v118, s[8:11], s13 offen lds
    s_add_u32 m0, s30, 5120
    s_nop 0
    buffer_load_dwordx4 v119, s[8:11], s13 offen lds
    s_add_u32 m0, s30, 6144
    s_nop 0
    buffer_load_dwordx4 v120, s[8:11], s13 offen lds
    s_add_u32 m0, s30, 7168
    s_nop 0
    buffer_load_dwordx4 v121, s[8:11], s13 offen lds
    s_add_u32 m0, s30, 8192
    s_nop 0
    buffer_load_dwordx4 v122, s[8:11], s13 offen lds
    s_add_u32 s12, s12, 128
    s_add_u32 s13, s13, 589824
    s_add_u32 m0, s29, 53248
    s_nop 0
    buffer_load_dwordx4 v106, s[4:7], s12 offen lds
    s_add_u32 m0, s29, 54272
    s_nop 0
    buffer_load_dwordx4 v107, s[4:7], s12 offen lds
    s_add_u32 m0, s29, 55296
    s_nop 0
    buffer_load_dwordx4 v108, s[4:7], s12 offen lds
    s_add_u32 m0, s29, 56320
    s_nop 0
    buffer_load_dwordx4 v109, s[4:7], s12 offen lds
    s_add_u32 m0, s30, 53248
    s_nop 0
    buffer_load_dwordx4 v114, s[8:11], s13 offen lds
    s_add_u32 m0, s30, 54272
    s_nop 0
    buffer_load_dwordx4 v115, s[8:11], s13 offen lds
    s_add_u32 m0, s30, 55296
    s_nop 0
    buffer_load_dwordx4 v116, s[8:11], s13 offen lds
    s_add_u32 m0, s30, 56320
    s_nop 0
    buffer_load_dwordx4 v117, s[8:11], s13 offen lds
    s_add_u32 m0, s30, 57344
    s_nop 0
    buffer_load_dwordx4 v118, s[8:11], s13 offen lds
    s_add_u32 m0, s30, 58368
    s_nop 0
    buffer_load_dwordx4 v119, s[8:11], s13 offen lds
    s_add_u32 m0, s30, 59392
    s_nop 0
    buffer_load_dwordx4 v120, s[8:11], s13 offen lds
    s_add_u32 m0, s30, 60416
    s_nop 0
    buffer_load_dwordx4 v121, s[8:11], s13 offen lds
    s_add_u32 m0, s30, 61440
    s_nop 0
    buffer_load_dwordx4 v122, s[8:11], s13 offen lds
    s_add_u32 s12, s12, 128
    s_add_u32 s13, s13, 589824
    s_add_u32 m0, s29, 106496
    s_nop 0
    buffer_load_dwordx4 v106, s[4:7], s12 offen lds
    s_add_u32 m0, s29, 107520
    s_nop 0
    buffer_load_dwordx4 v107, s[4:7], s12 offen lds
    s_add_u32 m0, s29, 108544
    s_nop 0
    buffer_load_dwordx4 v108, s[4:7], s12 offen lds
    s_add_u32 m0, s29, 109568
    s_nop 0
    buffer_load_dwordx4 v109, s[4:7], s12 offen lds
    s_add_u32 m0, s30, 106496
    s_nop 0
    buffer_load_dwordx4 v114, s[8:11], s13 offen lds
    s_add_u32 m0, s30, 107520
    s_nop 0
    buffer_load_dwordx4 v115, s[8:11], s13 offen lds
    s_add_u32 m0, s30, 108544
    s_nop 0
    buffer_load_dwordx4 v116, s[8:11], s13 offen lds
    s_add_u32 m0, s30, 109568
    s_nop 0
    buffer_load_dwordx4 v117, s[8:11], s13 offen lds
    s_add_u32 m0, s30, 110592
    s_nop 0
    buffer_load_dwordx4 v118, s[8:11], s13 offen lds
    s_add_u32 m0, s30, 111616
    s_nop 0
    buffer_load_dwordx4 v119, s[8:11], s13 offen lds
    s_add_u32 m0, s30, 112640
    s_nop 0
    buffer_load_dwordx4 v120, s[8:11], s13 offen lds
    s_add_u32 m0, s30, 113664
    s_nop 0
    buffer_load_dwordx4 v121, s[8:11], s13 offen lds
    s_add_u32 m0, s30, 114688
    s_nop 0
    buffer_load_dwordx4 v122, s[8:11], s13 offen lds
    s_add_u32 s12, s12, 128
    s_add_u32 s13, s13, 589824
    s_waitcnt vmcnt(26)
    s_barrier
    ds_read_b128 v[72:75], v123 offset:0
    ds_read_b128 v[76:79], v123 offset:2048
    ds_read_b128 v[80:83], v123 offset:4096
    ds_read_b128 v[84:87], v123 offset:6144
    ds_read_b64_tr_b16 v[0:1], v129 offset:0
    ds_read_b64_tr_b16 v[2:3], v129 offset:2304
    ds_read_b64_tr_b16 v[4:5], v129 offset:8
    ds_read_b64_tr_b16 v[6:7], v129 offset:2312
    ds_read_b64_tr_b16 v[8:9], v129 offset:64
    ds_read_b64_tr_b16 v[10:11], v129 offset:2368
    ds_read_b64_tr_b16 v[12:13], v129 offset:72
    ds_read_b64_tr_b16 v[14:15], v129 offset:2376
    ds_read_b64_tr_b16 v[16:17], v129 offset:128
    ds_read_b64_tr_b16 v[18:19], v129 offset:2432
    ds_read_b64_tr_b16 v[20:21], v129 offset:136
    ds_read_b64_tr_b16 v[22:23], v129 offset:2440
    ds_read_b64_tr_b16 v[24:25], v129 offset:192
    ds_read_b64_tr_b16 v[26:27], v129 offset:2496
    ds_read_b64_tr_b16 v[28:29], v129 offset:200
    ds_read_b64_tr_b16 v[30:31], v129 offset:2504
    ds_read_b64_tr_b16 v[32:33], v130 offset:0
    ds_read_b64_tr_b16 v[34:35], v130 offset:2304
    s_waitcnt lgkmcnt(0)
    v_mfma_f32_16x16x32_bf16 a[0:3], v[0:3], v[72:75], 0
    ds_read_b128 v[88:91], v126 offset:0
    v_mfma_f32_16x16x32_bf16 a[4:7], v[0:3], v[76:79], 0
    ds_read_b128 v[92:95], v126 offset:2048
    v_mfma_f32_16x16x32_bf16 a[8:11], v[0:3], v[80:83], 0
    ds_read_b128 v[96:99], v126 offset:4096
    v_mfma_f32_16x16x32_bf16 a[12:15], v[0:3], v[84:87], 0
    ds_read_b128 v[100:103], v126 offset:6144
    v_mfma_f32_16x16x32_bf16 a[16:19], v[4:7], v[72:75], 0
    ds_read_b64_tr_b16 v[36:37], v129 offset:18432
    ds_read_b64_tr_b16 v[38:39], v129 offset:20736
    v_mfma_f32_16x16x32_bf16 a[20:23], v[4:7], v[76:79], 0
    ds_read_b64_tr_b16 v[40:41], v129 offset:18440
    v_mfma_f32_16x16x32_bf16 a[24:27], v[4:7], v[80:83], 0
    ds_read_b64_tr_b16 v[42:43], v129 offset:20744
    v_mfma_f32_16x16x32_bf16 a[28:31], v[4:7], v[84:87], 0
    ds_read_b64_tr_b16 v[44:45], v129 offset:18496
    v_mfma_f32_16x16x32_bf16 a[32:35], v[8:11], v[72:75], 0
    ds_read_b64_tr_b16 v[46:47], v129 offset:20800
    ds_read_b64_tr_b16 v[48:49], v129 offset:18504
    v_mfma_f32_16x16x32_bf16 a[36:39], v[8:11], v[76:79], 0
    ds_read_b64_tr_b16 v[50:51], v129 offset:20808
    v_mfma_f32_16x16x32_bf16 a[40:43], v[8:11], v[80:83], 0
    ds_read_b64_tr_b16 v[52:53], v129 offset:18560
    v_mfma_f32_16x16x32_bf16 a[44:47], v[8:11], v[84:87], 0
    ds_read_b64_tr_b16 v[54:55], v129 offset:20864
    v_mfma_f32_16x16x32_bf16 a[48:51], v[12:15], v[72:75], 0
    ds_read_b64_tr_b16 v[56:57], v129 offset:18568
    v_mfma_f32_16x16x32_bf16 a[52:55], v[12:15], v[76:79], 0
    ds_read_b64_tr_b16 v[58:59], v129 offset:20872
    ds_read_b64_tr_b16 v[60:61], v129 offset:18624
    v_mfma_f32_16x16x32_bf16 a[56:59], v[12:15], v[80:83], 0
    ds_read_b64_tr_b16 v[62:63], v129 offset:20928
    v_mfma_f32_16x16x32_bf16 a[60:63], v[12:15], v[84:87], 0
    ds_read_b64_tr_b16 v[64:65], v129 offset:18632
    v_mfma_f32_16x16x32_bf16 a[64:67], v[16:19], v[72:75], 0
    ds_read_b64_tr_b16 v[66:67], v129 offset:20936
    v_mfma_f32_16x16x32_bf16 a[68:71], v[16:19], v[76:79], 0
    ds_read_b64_tr_b16 v[68:69], v130 offset:18432
    ds_read_b64_tr_b16 v[70:71], v130 offset:20736
    v_mfma_f32_16x16x32_bf16 a[72:75], v[16:19], v[80:83], 0
    v_mfma_f32_16x16x32_bf16 a[76:79], v[16:19], v[84:87], 0
    v_mfma_f32_16x16x32_bf16 a[80:83], v[20:23], v[72:75], 0
    v_mfma_f32_16x16x32_bf16 a[84:87], v[20:23], v[76:79], 0
    v_mfma_f32_16x16x32_bf16 a[88:91], v[20:23], v[80:83], 0
    v_mfma_f32_16x16x32_bf16 a[92:95], v[20:23], v[84:87], 0
    v_mfma_f32_16x16x32_bf16 a[96:99], v[24:27], v[72:75], 0
    v_mfma_f32_16x16x32_bf16 a[100:103], v[24:27], v[76:79], 0
    v_mfma_f32_16x16x32_bf16 a[104:107], v[24:27], v[80:83], 0
    v_mfma_f32_16x16x32_bf16 a[108:111], v[24:27], v[84:87], 0
    v_mfma_f32_16x16x32_bf16 a[112:115], v[28:31], v[72:75], 0
    v_mfma_f32_16x16x32_bf16 a[116:119], v[28:31], v[76:79], 0
    v_mfma_f32_16x16x32_bf16 a[120:123], v[28:31], v[80:83], 0
    v_mfma_f32_16x16x32_bf16 a[124:127], v[28:31], v[84:87], 0
    v_mfma_f32_16x16x32_bf16 a[128:131], v[32:35], v[72:75], 0
    v_mfma_f32_16x16x32_bf16 a[132:135], v[32:35], v[76:79], 0
    v_mfma_f32_16x16x32_bf16 a[136:139], v[32:35], v[80:83], 0
    v_mfma_f32_16x16x32_bf16 a[140:143], v[32:35], v[84:87], 0
    s_waitcnt lgkmcnt(0)
    s_waitcnt vmcnt(13)
    s_barrier
    s_add_u32 m0, s29, 0
    s_nop 0
    buffer_load_dwordx4 v106, s[4:7], s12 offen lds
    s_add_u32 m0, s29, 1024
    s_nop 0
    buffer_load_dwordx4 v107, s[4:7], s12 offen lds
    s_add_u32 m0, s29, 2048
    s_nop 0
    buffer_load_dwordx4 v108, s[4:7], s12 offen lds
    s_add_u32 m0, s29, 3072
    s_nop 0
    buffer_load_dwordx4 v109, s[4:7], s12 offen lds
    s_add_u32 m0, s30, 0
    s_nop 0
    buffer_load_dwordx4 v114, s[8:11], s13 offen lds
    s_add_u32 m0, s30, 1024
    s_nop 0
    buffer_load_dwordx4 v115, s[8:11], s13 offen lds
    s_add_u32 m0, s30, 2048
    s_nop 0
    buffer_load_dwordx4 v116, s[8:11], s13 offen lds
    s_add_u32 m0, s30, 3072
    s_nop 0
    buffer_load_dwordx4 v117, s[8:11], s13 offen lds
    s_add_u32 m0, s30, 4096
    s_nop 0
    buffer_load_dwordx4 v118, s[8:11], s13 offen lds
    s_add_u32 m0, s30, 5120
    s_nop 0
    buffer_load_dwordx4 v119, s[8:11], s13 offen lds
    s_add_u32 m0, s30, 6144
    s_nop 0
    buffer_load_dwordx4 v120, s[8:11], s13 offen lds
    s_add_u32 m0, s30, 7168
    s_nop 0
    buffer_load_dwordx4 v121, s[8:11], s13 offen lds
    s_add_u32 m0, s30, 8192
    s_nop 0
    buffer_load_dwordx4 v122, s[8:11], s13 offen lds
    s_add_u32 s12, s12, 128
    s_add_u32 s13, s13, 589824
    v_mfma_f32_16x16x32_bf16 a[0:3], v[36:39], v[88:91], a[0:3]
    ds_read_b128 v[72:75], v124 offset:0
    v_mfma_f32_16x16x32_bf16 a[4:7], v[36:39], v[92:95], a[4:7]
    ds_read_b128 v[76:79], v124 offset:2048
    v_mfma_f32_16x16x32_bf16 a[8:11], v[36:39], v[96:99], a[8:11]
    ds_read_b128 v[80:83], v124 offset:4096
    v_mfma_f32_16x16x32_bf16 a[12:15], v[36:39], v[100:103], a[12:15]
    ds_read_b128 v[84:87], v124 offset:6144
    v_mfma_f32_16x16x32_bf16 a[16:19], v[40:43], v[88:91], a[16:19]
    ds_read_b64_tr_b16 v[0:1], v131 offset:0
    ds_read_b64_tr_b16 v[2:3], v131 offset:2304
    v_mfma_f32_16x16x32_bf16 a[20:23], v[40:43], v[92:95], a[20:23]
    ds_read_b64_tr_b16 v[4:5], v131 offset:8
    v_mfma_f32_16x16x32_bf16 a[24:27], v[40:43], v[96:99], a[24:27]
    ds_read_b64_tr_b16 v[6:7], v131 offset:2312
    v_mfma_f32_16x16x32_bf16 a[28:31], v[40:43], v[100:103], a[28:31]
    ds_read_b64_tr_b16 v[8:9], v131 offset:64
    v_mfma_f32_16x16x32_bf16 a[32:35], v[44:47], v[88:91], a[32:35]
    ds_read_b64_tr_b16 v[10:11], v131 offset:2368
    ds_read_b64_tr_b16 v[12:13], v131 offset:72
    v_mfma_f32_16x16x32_bf16 a[36:39], v[44:47], v[92:95], a[36:39]
    ds_read_b64_tr_b16 v[14:15], v131 offset:2376
    v_mfma_f32_16x16x32_bf16 a[40:43], v[44:47], v[96:99], a[40:43]
    ds_read_b64_tr_b16 v[16:17], v131 offset:128
    v_mfma_f32_16x16x32_bf16 a[44:47], v[44:47], v[100:103], a[44:47]
    ds_read_b64_tr_b16 v[18:19], v131 offset:2432
    v_mfma_f32_16x16x32_bf16 a[48:51], v[48:51], v[88:91], a[48:51]
    ds_read_b64_tr_b16 v[20:21], v131 offset:136
    v_mfma_f32_16x16x32_bf16 a[52:55], v[48:51], v[92:95], a[52:55]
    ds_read_b64_tr_b16 v[22:23], v131 offset:2440
    ds_read_b64_tr_b16 v[24:25], v131 offset:192
    v_mfma_f32_16x16x32_bf16 a[56:59], v[48:51], v[96:99], a[56:59]
    ds_read_b64_tr_b16 v[26:27], v131 offset:2496
    v_mfma_f32_16x16x32_bf16 a[60:63], v[48:51], v[100:103], a[60:63]
    ds_read_b64_tr_b16 v[28:29], v131 offset:200
    v_mfma_f32_16x16x32_bf16 a[64:67], v[52:55], v[88:91], a[64:67]
    ds_read_b64_tr_b16 v[30:31], v131 offset:2504
    v_mfma_f32_16x16x32_bf16 a[68:71], v[52:55], v[92:95], a[68:71]
    ds_read_b64_tr_b16 v[32:33], v132 offset:0
    ds_read_b64_tr_b16 v[34:35], v132 offset:2304
    v_mfma_f32_16x16x32_bf16 a[72:75], v[52:55], v[96:99], a[72:75]
    v_mfma_f32_16x16x32_bf16 a[76:79], v[52:55], v[100:103], a[76:79]
    v_mfma_f32_16x16x32_bf16 a[80:83], v[56:59], v[88:91], a[80:83]
    v_mfma_f32_16x16x32_bf16 a[84:87], v[56:59], v[92:95], a[84:87]
    v_mfma_f32_16x16x32_bf16 a[88:91], v[56:59], v[96:99], a[88:91]
    v_mfma_f32_16x16x32_bf16 a[92:95], v[56:59], v[100:103], a[92:95]
    v_mfma_f32_16x16x32_bf16 a[96:99], v[60:63], v[88:91], a[96:99]
    v_mfma_f32_16x16x32_bf16 a[100:103], v[60:63], v[92:95], a[100:103]
    v_mfma_f32_16x16x32_bf16 a[104:107], v[60:63], v[96:99], a[104:107]
    v_mfma_f32_16x16x32_bf16 a[108:111], v[60:63], v[100:103], a[108:111]
    v_mfma_f32_16x16x32_bf16 a[112:115], v[64:67], v[88:91], a[112:115]
    v_mfma_f32_16x16x32_bf16 a[116:119], v[64:67], v[92:95], a[116:119]
    v_mfma_f32_16x16x32_bf16 a[120:123], v[64:67], v[96:99], a[120:123]
    v_mfma_f32_16x16x32_bf16 a[124:127], v[64:67], v[100:103], a[124:127]
    v_mfma_f32_16x16x32_bf16 a[128:131], v[68:71], v[88:91], a[128:131]
    v_mfma_f32_16x16x32_bf16 a[132:135], v[68:71], v[92:95], a[132:135]
    v_mfma_f32_16x16x32_bf16 a[136:139], v[68:71], v[96:99], a[136:139]
    v_mfma_f32_16x16x32_bf16 a[140:143], v[68:71], v[100:103], a[140:143]
    s_waitcnt lgkmcnt(0)
    v_mfma_f32_16x16x32_bf16 a[0:3], v[0:3], v[72:75], a[0:3]
    ds_read_b128 v[88:91], v127 offset:0
    v_mfma_f32_16x16x32_bf16 a[4:7], v[0:3], v[76:79], a[4:7]
    ds_read_b128 v[92:95], v127 offset:2048
    v_mfma_f32_16x16x32_bf16 a[8:11], v[0:3], v[80:83], a[8:11]
    ds_read_b128 v[96:99], v127 offset:4096
    v_mfma_f32_16x16x32_bf16 a[12:15], v[0:3], v[84:87], a[12:15]
    ds_read_b128 v[100:103], v127 offset:6144
    v_mfma_f32_16x16x32_bf16 a[16:19], v[4:7], v[72:75], a[16:19]
    ds_read_b64_tr_b16 v[36:37], v131 offset:18432
    ds_read_b64_tr_b16 v[38:39], v131 offset:20736
    v_mfma_f32_16x16x32_bf16 a[20:23], v[4:7], v[76:79], a[20:23]
    ds_read_b64_tr_b16 v[40:41], v131 offset:18440
    v_mfma_f32_16x16x32_bf16 a[24:27], v[4:7], v[80:83], a[24:27]
    ds_read_b64_tr_b16 v[42:43], v131 offset:20744
    v_mfma_f32_16x16x32_bf16 a[28:31], v[4:7], v[84:87], a[28:31]
    ds_read_b64_tr_b16 v[44:45], v131 offset:18496
    v_mfma_f32_16x16x32_bf16 a[32:35], v[8:11], v[72:75], a[32:35]
    ds_read_b64_tr_b16 v[46:47], v131 offset:20800
    ds_read_b64_tr_b16 v[48:49], v131 offset:18504
    v_mfma_f32_16x16x32_bf16 a[36:39], v[8:11], v[76:79], a[36:39]
    ds_read_b64_tr_b16 v[50:51], v131 offset:20808
    v_mfma_f32_16x16x32_bf16 a[40:43], v[8:11], v[80:83], a[40:43]
    ds_read_b64_tr_b16 v[52:53], v131 offset:18560
    v_mfma_f32_16x16x32_bf16 a[44:47], v[8:11], v[84:87], a[44:47]
    ds_read_b64_tr_b16 v[54:55], v131 offset:20864
    v_mfma_f32_16x16x32_bf16 a[48:51], v[12:15], v[72:75], a[48:51]
    ds_read_b64_tr_b16 v[56:57], v131 offset:18568
    v_mfma_f32_16x16x32_bf16 a[52:55], v[12:15], v[76:79], a[52:55]
    ds_read_b64_tr_b16 v[58:59], v131 offset:20872
    ds_read_b64_tr_b16 v[60:61], v131 offset:18624
    v_mfma_f32_16x16x32_bf16 a[56:59], v[12:15], v[80:83], a[56:59]
    ds_read_b64_tr_b16 v[62:63], v131 offset:20928
    v_mfma_f32_16x16x32_bf16 a[60:63], v[12:15], v[84:87], a[60:63]
    ds_read_b64_tr_b16 v[64:65], v131 offset:18632
    v_mfma_f32_16x16x32_bf16 a[64:67], v[16:19], v[72:75], a[64:67]
    ds_read_b64_tr_b16 v[66:67], v131 offset:20936
    v_mfma_f32_16x16x32_bf16 a[68:71], v[16:19], v[76:79], a[68:71]
    ds_read_b64_tr_b16 v[68:69], v132 offset:18432
    ds_read_b64_tr_b16 v[70:71], v132 offset:20736
    v_mfma_f32_16x16x32_bf16 a[72:75], v[16:19], v[80:83], a[72:75]
    v_mfma_f32_16x16x32_bf16 a[76:79], v[16:19], v[84:87], a[76:79]
    v_mfma_f32_16x16x32_bf16 a[80:83], v[20:23], v[72:75], a[80:83]
    v_mfma_f32_16x16x32_bf16 a[84:87], v[20:23], v[76:79], a[84:87]
    v_mfma_f32_16x16x32_bf16 a[88:91], v[20:23], v[80:83], a[88:91]
    v_mfma_f32_16x16x32_bf16 a[92:95], v[20:23], v[84:87], a[92:95]
    v_mfma_f32_16x16x32_bf16 a[96:99], v[24:27], v[72:75], a[96:99]
    v_mfma_f32_16x16x32_bf16 a[100:103], v[24:27], v[76:79], a[100:103]
    v_mfma_f32_16x16x32_bf16 a[104:107], v[24:27], v[80:83], a[104:107]
    v_mfma_f32_16x16x32_bf16 a[108:111], v[24:27], v[84:87], a[108:111]
    v_mfma_f32_16x16x32_bf16 a[112:115], v[28:31], v[72:75], a[112:115]
    v_mfma_f32_16x16x32_bf16 a[116:119], v[28:31], v[76:79], a[116:119]
    v_mfma_f32_16x16x32_bf16 a[120:123], v[28:31], v[80:83], a[120:123]
    v_mfma_f32_16x16x32_bf16 a[124:127], v[28:31], v[84:87], a[124:127]
    v_mfma_f32_16x16x32_bf16 a[128:131], v[32:35], v[72:75], a[128:131]
    v_mfma_f32_16x16x32_bf16 a[132:135], v[32:35], v[76:79], a[132:135]
    v_mfma_f32_16x16x32_bf16 a[136:139], v[32:35], v[80:83], a[136:139]
    v_mfma_f32_16x16x32_bf16 a[140:143], v[32:35], v[84:87], a[140:143]
    s_waitcnt lgkmcnt(0)
    s_waitcnt vmcnt(13)
    s_barrier
    s_add_u32 m0, s29, 53248
    s_nop 0
    buffer_load_dwordx4 v106, s[4:7], s12 offen lds
    s_add_u32 m0, s29, 54272
    s_nop 0
    buffer_load_dwordx4 v107, s[4:7], s12 offen lds
    s_add_u32 m0, s29, 55296
    s_nop 0
    buffer_load_dwordx4 v108, s[4:7], s12 offen lds
    s_add_u32 m0, s29, 56320
    s_nop 0
    buffer_load_dwordx4 v109, s[4:7], s12 offen lds
    s_add_u32 m0, s30, 53248
    s_nop 0
    buffer_load_dwordx4 v114, s[8:11], s13 offen lds
    s_add_u32 m0, s30, 54272
    s_nop 0
    buffer_load_dwordx4 v115, s[8:11], s13 offen lds
    s_add_u32 m0, s30, 55296
    s_nop 0
    buffer_load_dwordx4 v116, s[8:11], s13 offen lds
    s_add_u32 m0, s30, 56320
    s_nop 0
    buffer_load_dwordx4 v117, s[8:11], s13 offen lds
    s_add_u32 m0, s30, 57344
    s_nop 0
    buffer_load_dwordx4 v118, s[8:11], s13 offen lds
    s_add_u32 m0, s30, 58368
    s_nop 0
    buffer_load_dwordx4 v119, s[8:11], s13 offen lds
    s_add_u32 m0, s30, 59392
    s_nop 0
    buffer_load_dwordx4 v120, s[8:11], s13 offen lds
    s_add_u32 m0, s30, 60416
    s_nop 0
    buffer_load_dwordx4 v121, s[8:11], s13 offen lds
    s_add_u32 m0, s30, 61440
    s_nop 0
    buffer_load_dwordx4 v122, s[8:11], s13 offen lds
    s_add_u32 s12, s12, 128
    s_add_u32 s13, s13, 589824
    v_mfma_f32_16x16x32_bf16 a[0:3], v[36:39], v[88:91], a[0:3]
    ds_read_b128 v[72:75], v125 offset:0
    v_mfma_f32_16x16x32_bf16 a[4:7], v[36:39], v[92:95], a[4:7]
    ds_read_b128 v[76:79], v125 offset:2048
    v_mfma_f32_16x16x32_bf16 a[8:11], v[36:39], v[96:99], a[8:11]
    ds_read_b128 v[80:83], v125 offset:4096
    v_mfma_f32_16x16x32_bf16 a[12:15], v[36:39], v[100:103], a[12:15]
    ds_read_b128 v[84:87], v125 offset:6144
    v_mfma_f32_16x16x32_bf16 a[16:19], v[40:43], v[88:91], a[16:19]
    ds_read_b64_tr_b16 v[0:1], v133 offset:0
    ds_read_b64_tr_b16 v[2:3], v133 offset:2304
    v_mfma_f32_16x16x32_bf16 a[20:23], v[40:43], v[92:95], a[20:23]
    ds_read_b64_tr_b16 v[4:5], v133 offset:8
    v_mfma_f32_16x16x32_bf16 a[24:27], v[40:43], v[96:99], a[24:27]
    ds_read_b64_tr_b16 v[6:7], v133 offset:2312
    v_mfma_f32_16x16x32_bf16 a[28:31], v[40:43], v[100:103], a[28:31]
    ds_read_b64_tr_b16 v[8:9], v133 offset:64
    v_mfma_f32_16x16x32_bf16 a[32:35], v[44:47], v[88:91], a[32:35]
    ds_read_b64_tr_b16 v[10:11], v133 offset:2368
    ds_read_b64_tr_b16 v[12:13], v133 offset:72
    v_mfma_f32_16x16x32_bf16 a[36:39], v[44:47], v[92:95], a[36:39]
    ds_read_b64_tr_b16 v[14:15], v133 offset:2376
    v_mfma_f32_16x16x32_bf16 a[40:43], v[44:47], v[96:99], a[40:43]
    ds_read_b64_tr_b16 v[16:17], v133 offset:128
    v_mfma_f32_16x16x32_bf16 a[44:47], v[44:47], v[100:103], a[44:47]
    ds_read_b64_tr_b16 v[18:19], v133 offset:2432
    v_mfma_f32_16x16x32_bf16 a[48:51], v[48:51], v[88:91], a[48:51]
    ds_read_b64_tr_b16 v[20:21], v133 offset:136
    v_mfma_f32_16x16x32_bf16 a[52:55], v[48:51], v[92:95], a[52:55]
    ds_read_b64_tr_b16 v[22:23], v133 offset:2440
    ds_read_b64_tr_b16 v[24:25], v133 offset:192
    v_mfma_f32_16x16x32_bf16 a[56:59], v[48:51], v[96:99], a[56:59]
    ds_read_b64_tr_b16 v[26:27], v133 offset:2496
    v_mfma_f32_16x16x32_bf16 a[60:63], v[48:51], v[100:103], a[60:63]
    ds_read_b64_tr_b16 v[28:29], v133 offset:200
    v_mfma_f32_16x16x32_bf16 a[64:67], v[52:55], v[88:91], a[64:67]
    ds_read_b64_tr_b16 v[30:31], v133 offset:2504
    v_mfma_f32_16x16x32_bf16 a[68:71], v[52:55], v[92:95], a[68:71]
    ds_read_b64_tr_b16 v[32:33], v134 offset:0
    ds_read_b64_tr_b16 v[34:35], v134 offset:2304
    v_mfma_f32_16x16x32_bf16 a[72:75], v[52:55], v[96:99], a[72:75]
    v_mfma_f32_16x16x32_bf16 a[76:79], v[52:55], v[100:103], a[76:79]
    v_mfma_f32_16x16x32_bf16 a[80:83], v[56:59], v[88:91], a[80:83]
    v_mfma_f32_16x16x32_bf16 a[84:87], v[56:59], v[92:95], a[84:87]
    v_mfma_f32_16x16x32_bf16 a[88:91], v[56:59], v[96:99], a[88:91]
    v_mfma_f32_16x16x32_bf16 a[92:95], v[56:59], v[100:103], a[92:95]
    v_mfma_f32_16x16x32_bf16 a[96:99], v[60:63], v[88:91], a[96:99]
    v_mfma_f32_16x16x32_bf16 a[100:103], v[60:63], v[92:95], a[100:103]
    v_mfma_f32_16x16x32_bf16 a[104:107], v[60:63], v[96:99], a[104:107]
    v_mfma_f32_16x16x32_bf16 a[108:111], v[60:63], v[100:103], a[108:111]
    v_mfma_f32_16x16x32_bf16 a[112:115], v[64:67], v[88:91], a[112:115]
    v_mfma_f32_16x16x32_bf16 a[116:119], v[64:67], v[92:95], a[116:119]
    v_mfma_f32_16x16x32_bf16 a[120:123], v[64:67], v[96:99], a[120:123]
    v_mfma_f32_16x16x32_bf16 a[124:127], v[64:67], v[100:103], a[124:127]
    v_mfma_f32_16x16x32_bf16 a[128:131], v[68:71], v[88:91], a[128:131]
    v_mfma_f32_16x16x32_bf16 a[132:135], v[68:71], v[92:95], a[132:135]
    v_mfma_f32_16x16x32_bf16 a[136:139], v[68:71], v[96:99], a[136:139]
    v_mfma_f32_16x16x32_bf16 a[140:143], v[68:71], v[100:103], a[140:143]
    s_waitcnt lgkmcnt(0)
    v_mfma_f32_16x16x32_bf16 a[0:3], v[0:3], v[72:75], a[0:3]
    ds_read_b128 v[88:91], v128 offset:0
    v_mfma_f32_16x16x32_bf16 a[4:7], v[0:3], v[76:79], a[4:7]
    ds_read_b128 v[92:95], v128 offset:2048
    v_mfma_f32_16x16x32_bf16 a[8:11], v[0:3], v[80:83], a[8:11]
    ds_read_b128 v[96:99], v128 offset:4096
    v_mfma_f32_16x16x32_bf16 a[12:15], v[0:3], v[84:87], a[12:15]
    ds_read_b128 v[100:103], v128 offset:6144
    v_mfma_f32_16x16x32_bf16 a[16:19], v[4:7], v[72:75], a[16:19]
    ds_read_b64_tr_b16 v[36:37], v133 offset:18432
    ds_read_b64_tr_b16 v[38:39], v133 offset:20736
    v_mfma_f32_16x16x32_bf16 a[20:23], v[4:7], v[76:79], a[20:23]
    ds_read_b64_tr_b16 v[40:41], v133 offset:18440
    v_mfma_f32_16x16x32_bf16 a[24:27], v[4:7], v[80:83], a[24:27]
    ds_read_b64_tr_b16 v[42:43], v133 offset:20744
    v_mfma_f32_16x16x32_bf16 a[28:31], v[4:7], v[84:87], a[28:31]
    ds_read_b64_tr_b16 v[44:45], v133 offset:18496
    v_mfma_f32_16x16x32_bf16 a[32:35], v[8:11], v[72:75], a[32:35]
    ds_read_b64_tr_b16 v[46:47], v133 offset:20800
    ds_read_b64_tr_b16 v[48:49], v133 offset:18504
    v_mfma_f32_16x16x32_bf16 a[36:39], v[8:11], v[76:79], a[36:39]
    ds_read_b64_tr_b16 v[50:51], v133 offset:20808
    v_mfma_f32_16x16x32_bf16 a[40:43], v[8:11], v[80:83], a[40:43]
    ds_read_b64_tr_b16 v[52:53], v133 offset:18560
    v_mfma_f32_16x16x32_bf16 a[44:47], v[8:11], v[84:87], a[44:47]
    ds_read_b64_tr_b16 v[54:55], v133 offset:20864
    v_mfma_f32_16x16x32_bf16 a[48:51], v[12:15], v[72:75], a[48:51]
    ds_read_b64_tr_b16 v[56:57], v133 offset:18568
    v_mfma_f32_16x16x32_bf16 a[52:55], v[12:15], v[76:79], a[52:55]
    ds_read_b64_tr_b16 v[58:59], v133 offset:20872
    ds_read_b64_tr_b16 v[60:61], v133 offset:18624
    v_mfma_f32_16x16x32_bf16 a[56:59], v[12:15], v[80:83], a[56:59]
    ds_read_b64_tr_b16 v[62:63], v133 offset:20928
    v_mfma_f32_16x16x32_bf16 a[60:63], v[12:15], v[84:87], a[60:63]
    ds_read_b64_tr_b16 v[64:65], v133 offset:18632
    v_mfma_f32_16x16x32_bf16 a[64:67], v[16:19], v[72:75], a[64:67]
    ds_read_b64_tr_b16 v[66:67], v133 offset:20936
    v_mfma_f32_16x16x32_bf16 a[68:71], v[16:19], v[76:79], a[68:71]
    ds_read_b64_tr_b16 v[68:69], v134 offset:18432
    ds_read_b64_tr_b16 v[70:71], v134 offset:20736
    v_mfma_f32_16x16x32_bf16 a[72:75], v[16:19], v[80:83], a[72:75]
    v_mfma_f32_16x16x32_bf16 a[76:79], v[16:19], v[84:87], a[76:79]
    v_mfma_f32_16x16x32_bf16 a[80:83], v[20:23], v[72:75], a[80:83]
    v_mfma_f32_16x16x32_bf16 a[84:87], v[20:23], v[76:79], a[84:87]
    v_mfma_f32_16x16x32_bf16 a[88:91], v[20:23], v[80:83], a[88:91]
    v_mfma_f32_16x16x32_bf16 a[92:95], v[20:23], v[84:87], a[92:95]
    v_mfma_f32_16x16x32_bf16 a[96:99], v[24:27], v[72:75], a[96:99]
    v_mfma_f32_16x16x32_bf16 a[100:103], v[24:27], v[76:79], a[100:103]
    v_mfma_f32_16x16x32_bf16 a[104:107], v[24:27], v[80:83], a[104:107]
    v_mfma_f32_16x16x32_bf16 a[108:111], v[24:27], v[84:87], a[108:111]
    v_mfma_f32_16x16x32_bf16 a[112:115], v[28:31], v[72:75], a[112:115]
    v_mfma_f32_16x16x32_bf16 a[116:119], v[28:31], v[76:79], a[116:119]
    v_mfma_f32_16x16x32_bf16 a[120:123], v[28:31], v[80:83], a[120:123]
    v_mfma_f32_16x16x32_bf16 a[124:127], v[28:31], v[84:87], a[124:127]
    v_mfma_f32_16x16x32_bf16 a[128:131], v[32:35], v[72:75], a[128:131]
    v_mfma_f32_16x16x32_bf16 a[132:135], v[32:35], v[76:79], a[132:135]
    v_mfma_f32_16x16x32_bf16 a[136:139], v[32:35], v[80:83], a[136:139]
    v_mfma_f32_16x16x32_bf16 a[140:143], v[32:35], v[84:87], a[140:143]
    s_waitcnt lgkmcnt(0)
    s_waitcnt vmcnt(13)
    s_barrier
    s_add_u32 m0, s29, 106496
    s_nop 0
    buffer_load_dwordx4 v106, s[4:7], s12 offen lds
    s_add_u32 m0, s29, 107520
    s_nop 0
    buffer_load_dwordx4 v107, s[4:7], s12 offen lds
    s_add_u32 m0, s29, 108544
    s_nop 0
    buffer_load_dwordx4 v108, s[4:7], s12 offen lds
    s_add_u32 m0, s29, 109568
    s_nop 0
    buffer_load_dwordx4 v109, s[4:7], s12 offen lds
    s_add_u32 m0, s30, 106496
    s_nop 0
    buffer_load_dwordx4 v114, s[8:11], s13 offen lds
    s_add_u32 m0, s30, 107520
    s_nop 0
    buffer_load_dwordx4 v115, s[8:11], s13 offen lds
    s_add_u32 m0, s30, 108544
    s_nop 0
    buffer_load_dwordx4 v116, s[8:11], s13 offen lds
    s_add_u32 m0, s30, 109568
    s_nop 0
    buffer_load_dwordx4 v117, s[8:11], s13 offen lds
    s_add_u32 m0, s30, 110592
    s_nop 0
    buffer_load_dwordx4 v118, s[8:11], s13 offen lds
    s_add_u32 m0, s30, 111616
    s_nop 0
    buffer_load_dwordx4 v119, s[8:11], s13 offen lds
    s_add_u32 m0, s30, 112640
    s_nop 0
    buffer_load_dwordx4 v120, s[8:11], s13 offen lds
    s_add_u32 m0, s30, 113664
    s_nop 0
    buffer_load_dwordx4 v121, s[8:11], s13 offen lds
    s_add_u32 m0, s30, 114688
    s_nop 0
    buffer_load_dwordx4 v122, s[8:11], s13 offen lds
    s_add_u32 s12, s12, 128
    s_add_u32 s13, s13, 589824
    v_mfma_f32_16x16x32_bf16 a[0:3], v[36:39], v[88:91], a[0:3]
    ds_read_b128 v[72:75], v123 offset:0
    v_mfma_f32_16x16x32_bf16 a[4:7], v[36:39], v[92:95], a[4:7]
    ds_read_b128 v[76:79], v123 offset:2048
    v_mfma_f32_16x16x32_bf16 a[8:11], v[36:39], v[96:99], a[8:11]
    ds_read_b128 v[80:83], v123 offset:4096
    v_mfma_f32_16x16x32_bf16 a[12:15], v[36:39], v[100:103], a[12:15]
    ds_read_b128 v[84:87], v123 offset:6144
    v_mfma_f32_16x16x32_bf16 a[16:19], v[40:43], v[88:91], a[16:19]
    ds_read_b64_tr_b16 v[0:1], v129 offset:0
    ds_read_b64_tr_b16 v[2:3], v129 offset:2304
    v_mfma_f32_16x16x32_bf16 a[20:23], v[40:43], v[92:95], a[20:23]
    ds_read_b64_tr_b16 v[4:5], v129 offset:8
    v_mfma_f32_16x16x32_bf16 a[24:27], v[40:43], v[96:99], a[24:27]
    ds_read_b64_tr_b16 v[6:7], v129 offset:2312
    v_mfma_f32_16x16x32_bf16 a[28:31], v[40:43], v[100:103], a[28:31]
    ds_read_b64_tr_b16 v[8:9], v129 offset:64
    v_mfma_f32_16x16x32_bf16 a[32:35], v[44:47], v[88:91], a[32:35]
    ds_read_b64_tr_b16 v[10:11], v129 offset:2368
    ds_read_b64_tr_b16 v[12:13], v129 offset:72
    v_mfma_f32_16x16x32_bf16 a[36:39], v[44:47], v[92:95], a[36:39]
    ds_read_b64_tr_b16 v[14:15], v129 offset:2376
    v_mfma_f32_16x16x32_bf16 a[40:43], v[44:47], v[96:99], a[40:43]
    ds_read_b64_tr_b16 v[16:17], v129 offset:128
    v_mfma_f32_16x16x32_bf16 a[44:47], v[44:47], v[100:103], a[44:47]
    ds_read_b64_tr_b16 v[18:19], v129 offset:2432
    v_mfma_f32_16x16x32_bf16 a[48:51], v[48:51], v[88:91], a[48:51]
    ds_read_b64_tr_b16 v[20:21], v129 offset:136
    v_mfma_f32_16x16x32_bf16 a[52:55], v[48:51], v[92:95], a[52:55]
    ds_read_b64_tr_b16 v[22:23], v129 offset:2440
    ds_read_b64_tr_b16 v[24:25], v129 offset:192
    v_mfma_f32_16x16x32_bf16 a[56:59], v[48:51], v[96:99], a[56:59]
    ds_read_b64_tr_b16 v[26:27], v129 offset:2496
    v_mfma_f32_16x16x32_bf16 a[60:63], v[48:51], v[100:103], a[60:63]
    ds_read_b64_tr_b16 v[28:29], v129 offset:200
    v_mfma_f32_16x16x32_bf16 a[64:67], v[52:55], v[88:91], a[64:67]
    ds_read_b64_tr_b16 v[30:31], v129 offset:2504
    v_mfma_f32_16x16x32_bf16 a[68:71], v[52:55], v[92:95], a[68:71]
    ds_read_b64_tr_b16 v[32:33], v130 offset:0
    ds_read_b64_tr_b16 v[34:35], v130 offset:2304
    v_mfma_f32_16x16x32_bf16 a[72:75], v[52:55], v[96:99], a[72:75]
    v_mfma_f32_16x16x32_bf16 a[76:79], v[52:55], v[100:103], a[76:79]
    v_mfma_f32_16x16x32_bf16 a[80:83], v[56:59], v[88:91], a[80:83]
    v_mfma_f32_16x16x32_bf16 a[84:87], v[56:59], v[92:95], a[84:87]
    v_mfma_f32_16x16x32_bf16 a[88:91], v[56:59], v[96:99], a[88:91]
    v_mfma_f32_16x16x32_bf16 a[92:95], v[56:59], v[100:103], a[92:95]
    v_mfma_f32_16x16x32_bf16 a[96:99], v[60:63], v[88:91], a[96:99]
    v_mfma_f32_16x16x32_bf16 a[100:103], v[60:63], v[92:95], a[100:103]
    v_mfma_f32_16x16x32_bf16 a[104:107], v[60:63], v[96:99], a[104:107]
    v_mfma_f32_16x16x32_bf16 a[108:111], v[60:63], v[100:103], a[108:111]
    v_mfma_f32_16x16x32_bf16 a[112:115], v[64:67], v[88:91], a[112:115]
    v_mfma_f32_16x16x32_bf16 a[116:119], v[64:67], v[92:95], a[116:119]
    v_mfma_f32_16x16x32_bf16 a[120:123], v[64:67], v[96:99], a[120:123]
    v_mfma_f32_16x16x32_bf16 a[124:127], v[64:67], v[100:103], a[124:127]
    v_mfma_f32_16x16x32_bf16 a[128:131], v[68:71], v[88:91], a[128:131]
    v_mfma_f32_16x16x32_bf16 a[132:135], v[68:71], v[92:95], a[132:135]
    v_mfma_f32_16x16x32_bf16 a[136:139], v[68:71], v[96:99], a[136:139]
    v_mfma_f32_16x16x32_bf16 a[140:143], v[68:71], v[100:103], a[140:143]
    s_waitcnt lgkmcnt(0)
    v_mfma_f32_16x16x32_bf16 a[0:3], v[0:3], v[72:75], a[0:3]
    ds_read_b128 v[88:91], v126 offset:0
    v_mfma_f32_16x16x32_bf16 a[4:7], v[0:3], v[76:79], a[4:7]
    ds_read_b128 v[92:95], v126 offset:2048
    v_mfma_f32_16x16x32_bf16 a[8:11], v[0:3], v[80:83], a[8:11]
    ds_read_b128 v[96:99], v126 offset:4096
    v_mfma_f32_16x16x32_bf16 a[12:15], v[0:3], v[84:87], a[12:15]
    ds_read_b128 v[100:103], v126 offset:6144
    v_mfma_f32_16x16x32_bf16 a[16:19], v[4:7], v[72:75], a[16:19]
    ds_read_b64_tr_b16 v[36:37], v129 offset:18432
    ds_read_b64_tr_b16 v[38:39], v129 offset:20736
    v_mfma_f32_16x16x32_bf16 a[20:23], v[4:7], v[76:79], a[20:23]
    ds_read_b64_tr_b16 v[40:41], v129 offset:18440
    v_mfma_f32_16x16x32_bf16 a[24:27], v[4:7], v[80:83], a[24:27]
    ds_read_b64_tr_b16 v[42:43], v129 offset:20744
    v_mfma_f32_16x16x32_bf16 a[28:31], v[4:7], v[84:87], a[28:31]
    ds_read_b64_tr_b16 v[44:45], v129 offset:18496
    v_mfma_f32_16x16x32_bf16 a[32:35], v[8:11], v[72:75], a[32:35]
    ds_read_b64_tr_b16 v[46:47], v129 offset:20800
    ds_read_b64_tr_b16 v[48:49], v129 offset:18504
    v_mfma_f32_16x16x32_bf16 a[36:39], v[8:11], v[76:79], a[36:39]
    ds_read_b64_tr_b16 v[50:51], v129 offset:20808
    v_mfma_f32_16x16x32_bf16 a[40:43], v[8:11], v[80:83], a[40:43]
    ds_read_b64_tr_b16 v[52:53], v129 offset:18560
    v_mfma_f32_16x16x32_bf16 a[44:47], v[8:11], v[84:87], a[44:47]
    ds_read_b64_tr_b16 v[54:55], v129 offset:20864
    v_mfma_f32_16x16x32_bf16 a[48:51], v[12:15], v[72:75], a[48:51]
    ds_read_b64_tr_b16 v[56:57], v129 offset:18568
    v_mfma_f32_16x16x32_bf16 a[52:55], v[12:15], v[76:79], a[52:55]
    ds_read_b64_tr_b16 v[58:59], v129 offset:20872
    ds_read_b64_tr_b16 v[60:61], v129 offset:18624
    v_mfma_f32_16x16x32_bf16 a[56:59], v[12:15], v[80:83], a[56:59]
    ds_read_b64_tr_b16 v[62:63], v129 offset:20928
    v_mfma_f32_16x16x32_bf16 a[60:63], v[12:15], v[84:87], a[60:63]
    ds_read_b64_tr_b16 v[64:65], v129 offset:18632
    v_mfma_f32_16x16x32_bf16 a[64:67], v[16:19], v[72:75], a[64:67]
    ds_read_b64_tr_b16 v[66:67], v129 offset:20936
    v_mfma_f32_16x16x32_bf16 a[68:71], v[16:19], v[76:79], a[68:71]
    ds_read_b64_tr_b16 v[68:69], v130 offset:18432
    ds_read_b64_tr_b16 v[70:71], v130 offset:20736
    v_mfma_f32_16x16x32_bf16 a[72:75], v[16:19], v[80:83], a[72:75]
    v_mfma_f32_16x16x32_bf16 a[76:79], v[16:19], v[84:87], a[76:79]
    v_mfma_f32_16x16x32_bf16 a[80:83], v[20:23], v[72:75], a[80:83]
    v_mfma_f32_16x16x32_bf16 a[84:87], v[20:23], v[76:79], a[84:87]
    v_mfma_f32_16x16x32_bf16 a[88:91], v[20:23], v[80:83], a[88:91]
    v_mfma_f32_16x16x32_bf16 a[92:95], v[20:23], v[84:87], a[92:95]
    v_mfma_f32_16x16x32_bf16 a[96:99], v[24:27], v[72:75], a[96:99]
    v_mfma_f32_16x16x32_bf16 a[100:103], v[24:27], v[76:79], a[100:103]
    v_mfma_f32_16x16x32_bf16 a[104:107], v[24:27], v[80:83], a[104:107]
    v_mfma_f32_16x16x32_bf16 a[108:111], v[24:27], v[84:87], a[108:111]
    v_mfma_f32_16x16x32_bf16 a[112:115], v[28:31], v[72:75], a[112:115]
    v_mfma_f32_16x16x32_bf16 a[116:119], v[28:31], v[76:79], a[116:119]
    v_mfma_f32_16x16x32_bf16 a[120:123], v[28:31], v[80:83], a[120:123]
    v_mfma_f32_16x16x32_bf16 a[124:127], v[28:31], v[84:87], a[124:127]
    v_mfma_f32_16x16x32_bf16 a[128:131], v[32:35], v[72:75], a[128:131]
    v_mfma_f32_16x16x32_bf16 a[132:135], v[32:35], v[76:79], a[132:135]
    v_mfma_f32_16x16x32_bf16 a[136:139], v[32:35], v[80:83], a[136:139]
    v_mfma_f32_16x16x32_bf16 a[140:143], v[32:35], v[84:87], a[140:143]
    s_waitcnt lgkmcnt(0)
    s_waitcnt vmcnt(13)
    s_barrier
    s_add_u32 m0, s29, 0
    s_nop 0
    buffer_load_dwordx4 v106, s[4:7], s12 offen lds
    s_add_u32 m0, s29, 1024
    s_nop 0
    buffer_load_dwordx4 v107, s[4:7], s12 offen lds
    s_add_u32 m0, s29, 2048
    s_nop 0
    buffer_load_dwordx4 v108, s[4:7], s12 offen lds
    s_add_u32 m0, s29, 3072
    s_nop 0
    buffer_load_dwordx4 v109, s[4:7], s12 offen lds
    s_add_u32 m0, s30, 0
    s_nop 0
    buffer_load_dwordx4 v114, s[8:11], s13 offen lds
    s_add_u32 m0, s30, 1024
    s_nop 0
    buffer_load_dwordx4 v115, s[8:11], s13 offen lds
    s_add_u32 m0, s30, 2048
    s_nop 0
    buffer_load_dwordx4 v116, s[8:11], s13 offen lds
    s_add_u32 m0, s30, 3072
    s_nop 0
    buffer_load_dwordx4 v117, s[8:11], s13 offen lds
    s_add_u32 m0, s30, 4096
    s_nop 0
    buffer_load_dwordx4 v118, s[8:11], s13 offen lds
    s_add_u32 m0, s30, 5120
    s_nop 0
    buffer_load_dwordx4 v119, s[8:11], s13 offen lds
    s_add_u32 m0, s30, 6144
    s_nop 0
    buffer_load_dwordx4 v120, s[8:11], s13 offen lds
    s_add_u32 m0, s30, 7168
    s_nop 0
    buffer_load_dwordx4 v121, s[8:11], s13 offen lds
    s_add_u32 m0, s30, 8192
    s_nop 0
    buffer_load_dwordx4 v122, s[8:11], s13 offen lds
    s_add_u32 s12, s12, 128
    s_add_u32 s13, s13, 589824
    v_mfma_f32_16x16x32_bf16 a[0:3], v[36:39], v[88:91], a[0:3]
    ds_read_b128 v[72:75], v124 offset:0
    v_mfma_f32_16x16x32_bf16 a[4:7], v[36:39], v[92:95], a[4:7]
    ds_read_b128 v[76:79], v124 offset:2048
    v_mfma_f32_16x16x32_bf16 a[8:11], v[36:39], v[96:99], a[8:11]
    ds_read_b128 v[80:83], v124 offset:4096
    v_mfma_f32_16x16x32_bf16 a[12:15], v[36:39], v[100:103], a[12:15]
    ds_read_b128 v[84:87], v124 offset:6144
    v_mfma_f32_16x16x32_bf16 a[16:19], v[40:43], v[88:91], a[16:19]
    ds_read_b64_tr_b16 v[0:1], v131 offset:0
    ds_read_b64_tr_b16 v[2:3], v131 offset:2304
    v_mfma_f32_16x16x32_bf16 a[20:23], v[40:43], v[92:95], a[20:23]
    ds_read_b64_tr_b16 v[4:5], v131 offset:8
    v_mfma_f32_16x16x32_bf16 a[24:27], v[40:43], v[96:99], a[24:27]
    ds_read_b64_tr_b16 v[6:7], v131 offset:2312
    v_mfma_f32_16x16x32_bf16 a[28:31], v[40:43], v[100:103], a[28:31]
    ds_read_b64_tr_b16 v[8:9], v131 offset:64
    v_mfma_f32_16x16x32_bf16 a[32:35], v[44:47], v[88:91], a[32:35]
    ds_read_b64_tr_b16 v[10:11], v131 offset:2368
    ds_read_b64_tr_b16 v[12:13], v131 offset:72
    v_mfma_f32_16x16x32_bf16 a[36:39], v[44:47], v[92:95], a[36:39]
    ds_read_b64_tr_b16 v[14:15], v131 offset:2376
    v_mfma_f32_16x16x32_bf16 a[40:43], v[44:47], v[96:99], a[40:43]
    ds_read_b64_tr_b16 v[16:17], v131 offset:128
    v_mfma_f32_16x16x32_bf16 a[44:47], v[44:47], v[100:103], a[44:47]
    ds_read_b64_tr_b16 v[18:19], v131 offset:2432
    v_mfma_f32_16x16x32_bf16 a[48:51], v[48:51], v[88:91], a[48:51]
    ds_read_b64_tr_b16 v[20:21], v131 offset:136
    v_mfma_f32_16x16x32_bf16 a[52:55], v[48:51], v[92:95], a[52:55]
    ds_read_b64_tr_b16 v[22:23], v131 offset:2440
    ds_read_b64_tr_b16 v[24:25], v131 offset:192
    v_mfma_f32_16x16x32_bf16 a[56:59], v[48:51], v[96:99], a[56:59]
    ds_read_b64_tr_b16 v[26:27], v131 offset:2496
    v_mfma_f32_16x16x32_bf16 a[60:63], v[48:51], v[100:103], a[60:63]
    ds_read_b64_tr_b16 v[28:29], v131 offset:200
    v_mfma_f32_16x16x32_bf16 a[64:67], v[52:55], v[88:91], a[64:67]
    ds_read_b64_tr_b16 v[30:31], v131 offset:2504
    v_mfma_f32_16x16x32_bf16 a[68:71], v[52:55], v[92:95], a[68:71]
    ds_read_b64_tr_b16 v[32:33], v132 offset:0
    ds_read_b64_tr_b16 v[34:35], v132 offset:2304
    v_mfma_f32_16x16x32_bf16 a[72:75], v[52:55], v[96:99], a[72:75]
    v_mfma_f32_16x16x32_bf16 a[76:79], v[52:55], v[100:103], a[76:79]
    v_mfma_f32_16x16x32_bf16 a[80:83], v[56:59], v[88:91], a[80:83]
    v_mfma_f32_16x16x32_bf16 a[84:87], v[56:59], v[92:95], a[84:87]
    v_mfma_f32_16x16x32_bf16 a[88:91], v[56:59], v[96:99], a[88:91]
    v_mfma_f32_16x16x32_bf16 a[92:95], v[56:59], v[100:103], a[92:95]
    v_mfma_f32_16x16x32_bf16 a[96:99], v[60:63], v[88:91], a[96:99]
    v_mfma_f32_16x16x32_bf16 a[100:103], v[60:63], v[92:95], a[100:103]
    v_mfma_f32_16x16x32_bf16 a[104:107], v[60:63], v[96:99], a[104:107]
    v_mfma_f32_16x16x32_bf16 a[108:111], v[60:63], v[100:103], a[108:111]
    v_mfma_f32_16x16x32_bf16 a[112:115], v[64:67], v[88:91], a[112:115]
    v_mfma_f32_16x16x32_bf16 a[116:119], v[64:67], v[92:95], a[116:119]
    v_mfma_f32_16x16x32_bf16 a[120:123], v[64:67], v[96:99], a[120:123]
    v_mfma_f32_16x16x32_bf16 a[124:127], v[64:67], v[100:103], a[124:127]
    v_mfma_f32_16x16x32_bf16 a[128:131], v[68:71], v[88:91], a[128:131]
    v_mfma_f32_16x16x32_bf16 a[132:135], v[68:71], v[92:95], a[132:135]
    v_mfma_f32_16x16x32_bf16 a[136:139], v[68:71], v[96:99], a[136:139]
    v_mfma_f32_16x16x32_bf16 a[140:143], v[68:71], v[100:103], a[140:143]
    s_waitcnt lgkmcnt(0)
    v_mfma_f32_16x16x32_bf16 a[0:3], v[0:3], v[72:75], a[0:3]
    ds_read_b128 v[88:91], v127 offset:0
    v_mfma_f32_16x16x32_bf16 a[4:7], v[0:3], v[76:79], a[4:7]
    ds_read_b128 v[92:95], v127 offset:2048
    v_mfma_f32_16x16x32_bf16 a[8:11], v[0:3], v[80:83], a[8:11]
    ds_read_b128 v[96:99], v127 offset:4096
    v_mfma_f32_16x16x32_bf16 a[12:15], v[0:3], v[84:87], a[12:15]
    ds_read_b128 v[100:103], v127 offset:6144
    v_mfma_f32_16x16x32_bf16 a[16:19], v[4:7], v[72:75], a[16:19]
    ds_read_b64_tr_b16 v[36:37], v131 offset:18432
    ds_read_b64_tr_b16 v[38:39], v131 offset:20736
    v_mfma_f32_16x16x32_bf16 a[20:23], v[4:7], v[76:79], a[20:23]
    ds_read_b64_tr_b16 v[40:41], v131 offset:18440
    v_mfma_f32_16x16x32_bf16 a[24:27], v[4:7], v[80:83], a[24:27]
    ds_read_b64_tr_b16 v[42:43], v131 offset:20744
    v_mfma_f32_16x16x32_bf16 a[28:31], v[4:7], v[84:87], a[28:31]
    ds_read_b64_tr_b16 v[44:45], v131 offset:18496
    v_mfma_f32_16x16x32_bf16 a[32:35], v[8:11], v[72:75], a[32:35]
    ds_read_b64_tr_b16 v[46:47], v131 offset:20800
    ds_read_b64_tr_b16 v[48:49], v131 offset:18504
    v_mfma_f32_16x16x32_bf16 a[36:39], v[8:11], v[76:79], a[36:39]
    ds_read_b64_tr_b16 v[50:51], v131 offset:20808
    v_mfma_f32_16x16x32_bf16 a[40:43], v[8:11], v[80:83], a[40:43]
    ds_read_b64_tr_b16 v[52:53], v131 offset:18560
    v_mfma_f32_16x16x32_bf16 a[44:47], v[8:11], v[84:87], a[44:47]
    ds_read_b64_tr_b16 v[54:55], v131 offset:20864
    v_mfma_f32_16x16x32_bf16 a[48:51], v[12:15], v[72:75], a[48:51]
    ds_read_b64_tr_b16 v[56:57], v131 offset:18568
    v_mfma_f32_16x16x32_bf16 a[52:55], v[12:15], v[76:79], a[52:55]
    ds_read_b64_tr_b16 v[58:59], v131 offset:20872
    ds_read_b64_tr_b16 v[60:61], v131 offset:18624
    v_mfma_f32_16x16x32_bf16 a[56:59], v[12:15], v[80:83], a[56:59]
    ds_read_b64_tr_b16 v[62:63], v131 offset:20928
    v_mfma_f32_16x16x32_bf16 a[60:63], v[12:15], v[84:87], a[60:63]
    ds_read_b64_tr_b16 v[64:65], v131 offset:18632
    v_mfma_f32_16x16x32_bf16 a[64:67], v[16:19], v[72:75], a[64:67]
    ds_read_b64_tr_b16 v[66:67], v131 offset:20936
    v_mfma_f32_16x16x32_bf16 a[68:71], v[16:19], v[76:79], a[68:71]
    ds_read_b64_tr_b16 v[68:69], v132 offset:18432
    ds_read_b64_tr_b16 v[70:71], v132 offset:20736
    v_mfma_f32_16x16x32_bf16 a[72:75], v[16:19], v[80:83], a[72:75]
    v_mfma_f32_16x16x32_bf16 a[76:79], v[16:19], v[84:87], a[76:79]
    v_mfma_f32_16x16x32_bf16 a[80:83], v[20:23], v[72:75], a[80:83]
    v_mfma_f32_16x16x32_bf16 a[84:87], v[20:23], v[76:79], a[84:87]
    v_mfma_f32_16x16x32_bf16 a[88:91], v[20:23], v[80:83], a[88:91]
    v_mfma_f32_16x16x32_bf16 a[92:95], v[20:23], v[84:87], a[92:95]
    v_mfma_f32_16x16x32_bf16 a[96:99], v[24:27], v[72:75], a[96:99]
    v_mfma_f32_16x16x32_bf16 a[100:103], v[24:27], v[76:79], a[100:103]
    v_mfma_f32_16x16x32_bf16 a[104:107], v[24:27], v[80:83], a[104:107]
    v_mfma_f32_16x16x32_bf16 a[108:111], v[24:27], v[84:87], a[108:111]
    v_mfma_f32_16x16x32_bf16 a[112:115], v[28:31], v[72:75], a[112:115]
    v_mfma_f32_16x16x32_bf16 a[116:119], v[28:31], v[76:79], a[116:119]
    v_mfma_f32_16x16x32_bf16 a[120:123], v[28:31], v[80:83], a[120:123]
    v_mfma_f32_16x16x32_bf16 a[124:127], v[28:31], v[84:87], a[124:127]
    v_mfma_f32_16x16x32_bf16 a[128:131], v[32:35], v[72:75], a[128:131]
    v_mfma_f32_16x16x32_bf16 a[132:135], v[32:35], v[76:79], a[132:135]
    v_mfma_f32_16x16x32_bf16 a[136:139], v[32:35], v[80:83], a[136:139]
    v_mfma_f32_16x16x32_bf16 a[140:143], v[32:35], v[84:87], a[140:143]
    s_waitcnt lgkmcnt(0)
    s_waitcnt vmcnt(13)
    s_barrier
    s_add_u32 m0, s29, 53248
    s_nop 0
    buffer_load_dwordx4 v106, s[4:7], s12 offen lds
    s_add_u32 m0, s29, 54272
    s_nop 0
    buffer_load_dwordx4 v107, s[4:7], s12 offen lds
    s_add_u32 m0, s29, 55296
    s_nop 0
    buffer_load_dwordx4 v108, s[4:7], s12 offen lds
    s_add_u32 m0, s29, 56320
    s_nop 0
    buffer_load_dwordx4 v109, s[4:7], s12 offen lds
    s_add_u32 m0, s30, 53248
    s_nop 0
    buffer_load_dwordx4 v114, s[8:11], s13 offen lds
    s_add_u32 m0, s30, 54272
    s_nop 0
    buffer_load_dwordx4 v115, s[8:11], s13 offen lds
    s_add_u32 m0, s30, 55296
    s_nop 0
    buffer_load_dwordx4 v116, s[8:11], s13 offen lds
    s_add_u32 m0, s30, 56320
    s_nop 0
    buffer_load_dwordx4 v117, s[8:11], s13 offen lds
    s_add_u32 m0, s30, 57344
    s_nop 0
    buffer_load_dwordx4 v118, s[8:11], s13 offen lds
    s_add_u32 m0, s30, 58368
    s_nop 0
    buffer_load_dwordx4 v119, s[8:11], s13 offen lds
    s_add_u32 m0, s30, 59392
    s_nop 0
    buffer_load_dwordx4 v120, s[8:11], s13 offen lds
    s_add_u32 m0, s30, 60416
    s_nop 0
    buffer_load_dwordx4 v121, s[8:11], s13 offen lds
    s_add_u32 m0, s30, 61440
    s_nop 0
    buffer_load_dwordx4 v122, s[8:11], s13 offen lds
    s_add_u32 s12, s12, 128
    s_add_u32 s13, s13, 589824
    v_mfma_f32_16x16x32_bf16 a[0:3], v[36:39], v[88:91], a[0:3]
    ds_read_b128 v[72:75], v125 offset:0
    v_mfma_f32_16x16x32_bf16 a[4:7], v[36:39], v[92:95], a[4:7]
    ds_read_b128 v[76:79], v125 offset:2048
    v_mfma_f32_16x16x32_bf16 a[8:11], v[36:39], v[96:99], a[8:11]
    ds_read_b128 v[80:83], v125 offset:4096
    v_mfma_f32_16x16x32_bf16 a[12:15], v[36:39], v[100:103], a[12:15]
    ds_read_b128 v[84:87], v125 offset:6144
    v_mfma_f32_16x16x32_bf16 a[16:19], v[40:43], v[88:91], a[16:19]
    ds_read_b64_tr_b16 v[0:1], v133 offset:0
    ds_read_b64_tr_b16 v[2:3], v133 offset:2304
    v_mfma_f32_16x16x32_bf16 a[20:23], v[40:43], v[92:95], a[20:23]
    ds_read_b64_tr_b16 v[4:5], v133 offset:8
    v_mfma_f32_16x16x32_bf16 a[24:27], v[40:43], v[96:99], a[24:27]
    ds_read_b64_tr_b16 v[6:7], v133 offset:2312
    v_mfma_f32_16x16x32_bf16 a[28:31], v[40:43], v[100:103], a[28:31]
    ds_read_b64_tr_b16 v[8:9], v133 offset:64
    v_mfma_f32_16x16x32_bf16 a[32:35], v[44:47], v[88:91], a[32:35]
    ds_read_b64_tr_b16 v[10:11], v133 offset:2368
    ds_read_b64_tr_b16 v[12:13], v133 offset:72
    v_mfma_f32_16x16x32_bf16 a[36:39], v[44:47], v[92:95], a[36:39]
    ds_read_b64_tr_b16 v[14:15], v133 offset:2376
    v_mfma_f32_16x16x32_bf16 a[40:43], v[44:47], v[96:99], a[40:43]
    ds_read_b64_tr_b16 v[16:17], v133 offset:128
    v_mfma_f32_16x16x32_bf16 a[44:47], v[44:47], v[100:103], a[44:47]
    ds_read_b64_tr_b16 v[18:19], v133 offset:2432
    v_mfma_f32_16x16x32_bf16 a[48:51], v[48:51], v[88:91], a[48:51]
    ds_read_b64_tr_b16 v[20:21], v133 offset:136
    v_mfma_f32_16x16x32_bf16 a[52:55], v[48:51], v[92:95], a[52:55]
    ds_read_b64_tr_b16 v[22:23], v133 offset:2440
    ds_read_b64_tr_b16 v[24:25], v133 offset:192
    v_mfma_f32_16x16x32_bf16 a[56:59], v[48:51], v[96:99], a[56:59]
    ds_read_b64_tr_b16 v[26:27], v133 offset:2496
    v_mfma_f32_16x16x32_bf16 a[60:63], v[48:51], v[100:103], a[60:63]
    ds_read_b64_tr_b16 v[28:29], v133 offset:200
    v_mfma_f32_16x16x32_bf16 a[64:67], v[52:55], v[88:91], a[64:67]
    ds_read_b64_tr_b16 v[30:31], v133 offset:2504
    v_mfma_f32_16x16x32_bf16 a[68:71], v[52:55], v[92:95], a[68:71]
    ds_read_b64_tr_b16 v[32:33], v134 offset:0
    ds_read_b64_tr_b16 v[34:35], v134 offset:2304
    v_mfma_f32_16x16x32_bf16 a[72:75], v[52:55], v[96:99], a[72:75]
    v_mfma_f32_16x16x32_bf16 a[76:79], v[52:55], v[100:103], a[76:79]
    v_mfma_f32_16x16x32_bf16 a[80:83], v[56:59], v[88:91], a[80:83]
    v_mfma_f32_16x16x32_bf16 a[84:87], v[56:59], v[92:95], a[84:87]
    v_mfma_f32_16x16x32_bf16 a[88:91], v[56:59], v[96:99], a[88:91]
    v_mfma_f32_16x16x32_bf16 a[92:95], v[56:59], v[100:103], a[92:95]
    v_mfma_f32_16x16x32_bf16 a[96:99], v[60:63], v[88:91], a[96:99]
    v_mfma_f32_16x16x32_bf16 a[100:103], v[60:63], v[92:95], a[100:103]
    v_mfma_f32_16x16x32_bf16 a[104:107], v[60:63], v[96:99], a[104:107]
    v_mfma_f32_16x16x32_bf16 a[108:111], v[60:63], v[100:103], a[108:111]
    v_mfma_f32_16x16x32_bf16 a[112:115], v[64:67], v[88:91], a[112:115]
    v_mfma_f32_16x16x32_bf16 a[116:119], v[64:67], v[92:95], a[116:119]
    v_mfma_f32_16x16x32_bf16 a[120:123], v[64:67], v[96:99], a[120:123]
    v_mfma_f32_16x16x32_bf16 a[124:127], v[64:67], v[100:103], a[124:127]
    v_mfma_f32_16x16x32_bf16 a[128:131], v[68:71], v[88:91], a[128:131]
    v_mfma_f32_16x16x32_bf16 a[132:135], v[68:71], v[92:95], a[132:135]
    v_mfma_f32_16x16x32_bf16 a[136:139], v[68:71], v[96:99], a[136:139]
    v_mfma_f32_16x16x32_bf16 a[140:143], v[68:71], v[100:103], a[140:143]
    s_waitcnt lgkmcnt(0)
    v_mfma_f32_16x16x32_bf16 a[0:3], v[0:3], v[72:75], a[0:3]
    ds_read_b128 v[88:91], v128 offset:0
    v_mfma_f32_16x16x32_bf16 a[4:7], v[0:3], v[76:79], a[4:7]
    ds_read_b128 v[92:95], v128 offset:2048
    v_mfma_f32_16x16x32_bf16 a[8:11], v[0:3], v[80:83], a[8:11]
    ds_read_b128 v[96:99], v128 offset:4096
    v_mfma_f32_16x16x32_bf16 a[12:15], v[0:3], v[84:87], a[12:15]
    ds_read_b128 v[100:103], v128 offset:6144
    v_mfma_f32_16x16x32_bf16 a[16:19], v[4:7], v[72:75], a[16:19]
    ds_read_b64_tr_b16 v[36:37], v133 offset:18432
    ds_read_b64_tr_b16 v[38:39], v133 offset:20736
    v_mfma_f32_16x16x32_bf16 a[20:23], v[4:7], v[76:79], a[20:23]
    ds_read_b64_tr_b16 v[40:41], v133 offset:18440
    v_mfma_f32_16x16x32_bf16 a[24:27], v[4:7], v[80:83], a[24:27]
    ds_read_b64_tr_b16 v[42:43], v133 offset:20744
    v_mfma_f32_16x16x32_bf16 a[28:31], v[4:7], v[84:87], a[28:31]
    ds_read_b64_tr_b16 v[44:45], v133 offset:18496
    v_mfma_f32_16x16x32_bf16 a[32:35], v[8:11], v[72:75], a[32:35]
    ds_read_b64_tr_b16 v[46:47], v133 offset:20800
    ds_read_b64_tr_b16 v[48:49], v133 offset:18504
    v_mfma_f32_16x16x32_bf16 a[36:39], v[8:11], v[76:79], a[36:39]
    ds_read_b64_tr_b16 v[50:51], v133 offset:20808
    v_mfma_f32_16x16x32_bf16 a[40:43], v[8:11], v[80:83], a[40:43]
    ds_read_b64_tr_b16 v[52:53], v133 offset:18560
    v_mfma_f32_16x16x32_bf16 a[44:47], v[8:11], v[84:87], a[44:47]
    ds_read_b64_tr_b16 v[54:55], v133 offset:20864
    v_mfma_f32_16x16x32_bf16 a[48:51], v[12:15], v[72:75], a[48:51]
    ds_read_b64_tr_b16 v[56:57], v133 offset:18568
    v_mfma_f32_16x16x32_bf16 a[52:55], v[12:15], v[76:79], a[52:55]
    ds_read_b64_tr_b16 v[58:59], v133 offset:20872
    ds_read_b64_tr_b16 v[60:61], v133 offset:18624
    v_mfma_f32_16x16x32_bf16 a[56:59], v[12:15], v[80:83], a[56:59]
    ds_read_b64_tr_b16 v[62:63], v133 offset:20928
    v_mfma_f32_16x16x32_bf16 a[60:63], v[12:15], v[84:87], a[60:63]
    ds_read_b64_tr_b16 v[64:65], v133 offset:18632
    v_mfma_f32_16x16x32_bf16 a[64:67], v[16:19], v[72:75], a[64:67]
    ds_read_b64_tr_b16 v[66:67], v133 offset:20936
    v_mfma_f32_16x16x32_bf16 a[68:71], v[16:19], v[76:79], a[68:71]
    ds_read_b64_tr_b16 v[68:69], v134 offset:18432
    ds_read_b64_tr_b16 v[70:71], v134 offset:20736
    v_mfma_f32_16x16x32_bf16 a[72:75], v[16:19], v[80:83], a[72:75]
    v_mfma_f32_16x16x32_bf16 a[76:79], v[16:19], v[84:87], a[76:79]
    v_mfma_f32_16x16x32_bf16 a[80:83], v[20:23], v[72:75], a[80:83]
    v_mfma_f32_16x16x32_bf16 a[84:87], v[20:23], v[76:79], a[84:87]
    v_mfma_f32_16x16x32_bf16 a[88:91], v[20:23], v[80:83], a[88:91]
    v_mfma_f32_16x16x32_bf16 a[92:95], v[20:23], v[84:87], a[92:95]
    v_mfma_f32_16x16x32_bf16 a[96:99], v[24:27], v[72:75], a[96:99]
    v_mfma_f32_16x16x32_bf16 a[100:103], v[24:27], v[76:79], a[100:103]
    v_mfma_f32_16x16x32_bf16 a[104:107], v[24:27], v[80:83], a[104:107]
    v_mfma_f32_16x16x32_bf16 a[108:111], v[24:27], v[84:87], a[108:111]
    v_mfma_f32_16x16x32_bf16 a[112:115], v[28:31], v[72:75], a[112:115]
    v_mfma_f32_16x16x32_bf16 a[116:119], v[28:31], v[76:79], a[116:119]
    v_mfma_f32_16x16x32_bf16 a[120:123], v[28:31], v[80:83], a[120:123]
    v_mfma_f32_16x16x32_bf16 a[124:127], v[28:31], v[84:87], a[124:127]
    v_mfma_f32_16x16x32_bf16 a[128:131], v[32:35], v[72:75], a[128:131]
    v_mfma_f32_16x16x32_bf16 a[132:135], v[32:35], v[76:79], a[132:135]
    v_mfma_f32_16x16x32_bf16 a[136:139], v[32:35], v[80:83], a[136:139]
    v_mfma_f32_16x16x32_bf16 a[140:143], v[32:35], v[84:87], a[140:143]
    s_waitcnt lgkmcnt(0)
    s_waitcnt vmcnt(13)
    s_barrier
    s_add_u32 m0, s29, 106496
    s_nop 0
    buffer_load_dwordx4 v106, s[4:7], s12 offen lds
    s_add_u32 m0, s29, 107520
    s_nop 0
    buffer_load_dwordx4 v107, s[4:7], s12 offen lds
    s_add_u32 m0, s29, 108544
    s_nop 0
    buffer_load_dwordx4 v108, s[4:7], s12 offen lds
    s_add_u32 m0, s29, 109568
    s_nop 0
    buffer_load_dwordx4 v109, s[4:7], s12 offen lds
    s_add_u32 m0, s30, 106496
    s_nop 0
    buffer_load_dwordx4 v114, s[8:11], s13 offen lds
    s_add_u32 m0, s30, 107520
    s_nop 0
    buffer_load_dwordx4 v115, s[8:11], s13 offen lds
    s_add_u32 m0, s30, 108544
    s_nop 0
    buffer_load_dwordx4 v116, s[8:11], s13 offen lds
    s_add_u32 m0, s30, 109568
    s_nop 0
    buffer_load_dwordx4 v117, s[8:11], s13 offen lds
    s_add_u32 m0, s30, 110592
    s_nop 0
    buffer_load_dwordx4 v118, s[8:11], s13 offen lds
    s_add_u32 m0, s30, 111616
    s_nop 0
    buffer_load_dwordx4 v119, s[8:11], s13 offen lds
    s_add_u32 m0, s30, 112640
    s_nop 0
    buffer_load_dwordx4 v120, s[8:11], s13 offen lds
    s_add_u32 m0, s30, 113664
    s_nop 0
    buffer_load_dwordx4 v121, s[8:11], s13 offen lds
    s_add_u32 m0, s30, 114688
    s_nop 0
    buffer_load_dwordx4 v122, s[8:11], s13 offen lds
    s_add_u32 s12, s12, 128
    s_add_u32 s13, s13, 589824
    v_mfma_f32_16x16x32_bf16 a[0:3], v[36:39], v[88:91], a[0:3]
    ds_read_b128 v[72:75], v123 offset:0
    v_mfma_f32_16x16x32_bf16 a[4:7], v[36:39], v[92:95], a[4:7]
    ds_read_b128 v[76:79], v123 offset:2048
    v_mfma_f32_16x16x32_bf16 a[8:11], v[36:39], v[96:99], a[8:11]
    ds_read_b128 v[80:83], v123 offset:4096
    v_mfma_f32_16x16x32_bf16 a[12:15], v[36:39], v[100:103], a[12:15]
    ds_read_b128 v[84:87], v123 offset:6144
    v_mfma_f32_16x16x32_bf16 a[16:19], v[40:43], v[88:91], a[16:19]
    ds_read_b64_tr_b16 v[0:1], v129 offset:0
    ds_read_b64_tr_b16 v[2:3], v129 offset:2304
    v_mfma_f32_16x16x32_bf16 a[20:23], v[40:43], v[92:95], a[20:23]
    ds_read_b64_tr_b16 v[4:5], v129 offset:8
    v_mfma_f32_16x16x32_bf16 a[24:27], v[40:43], v[96:99], a[24:27]
    ds_read_b64_tr_b16 v[6:7], v129 offset:2312
    v_mfma_f32_16x16x32_bf16 a[28:31], v[40:43], v[100:103], a[28:31]
    ds_read_b64_tr_b16 v[8:9], v129 offset:64
    v_mfma_f32_16x16x32_bf16 a[32:35], v[44:47], v[88:91], a[32:35]
    ds_read_b64_tr_b16 v[10:11], v129 offset:2368
    ds_read_b64_tr_b16 v[12:13], v129 offset:72
    v_mfma_f32_16x16x32_bf16 a[36:39], v[44:47], v[92:95], a[36:39]
    ds_read_b64_tr_b16 v[14:15], v129 offset:2376
    v_mfma_f32_16x16x32_bf16 a[40:43], v[44:47], v[96:99], a[40:43]
    ds_read_b64_tr_b16 v[16:17], v129 offset:128
    v_mfma_f32_16x16x32_bf16 a[44:47], v[44:47], v[100:103], a[44:47]
    ds_read_b64_tr_b16 v[18:19], v129 offset:2432
    v_mfma_f32_16x16x32_bf16 a[48:51], v[48:51], v[88:91], a[48:51]
    ds_read_b64_tr_b16 v[20:21], v129 offset:136
    v_mfma_f32_16x16x32_bf16 a[52:55], v[48:51], v[92:95], a[52:55]
    ds_read_b64_tr_b16 v[22:23], v129 offset:2440
    ds_read_b64_tr_b16 v[24:25], v129 offset:192
    v_mfma_f32_16x16x32_bf16 a[56:59], v[48:51], v[96:99], a[56:59]
    ds_read_b64_tr_b16 v[26:27], v129 offset:2496
    v_mfma_f32_16x16x32_bf16 a[60:63], v[48:51], v[100:103], a[60:63]
    ds_read_b64_tr_b16 v[28:29], v129 offset:200
    v_mfma_f32_16x16x32_bf16 a[64:67], v[52:55], v[88:91], a[64:67]
    ds_read_b64_tr_b16 v[30:31], v129 offset:2504
    v_mfma_f32_16x16x32_bf16 a[68:71], v[52:55], v[92:95], a[68:71]
    ds_read_b64_tr_b16 v[32:33], v130 offset:0
    ds_read_b64_tr_b16 v[34:35], v130 offset:2304
    v_mfma_f32_16x16x32_bf16 a[72:75], v[52:55], v[96:99], a[72:75]
    v_mfma_f32_16x16x32_bf16 a[76:79], v[52:55], v[100:103], a[76:79]
    v_mfma_f32_16x16x32_bf16 a[80:83], v[56:59], v[88:91], a[80:83]
    v_mfma_f32_16x16x32_bf16 a[84:87], v[56:59], v[92:95], a[84:87]
    v_mfma_f32_16x16x32_bf16 a[88:91], v[56:59], v[96:99], a[88:91]
    v_mfma_f32_16x16x32_bf16 a[92:95], v[56:59], v[100:103], a[92:95]
    v_mfma_f32_16x16x32_bf16 a[96:99], v[60:63], v[88:91], a[96:99]
    v_mfma_f32_16x16x32_bf16 a[100:103], v[60:63], v[92:95], a[100:103]
    v_mfma_f32_16x16x32_bf16 a[104:107], v[60:63], v[96:99], a[104:107]
    v_mfma_f32_16x16x32_bf16 a[108:111], v[60:63], v[100:103], a[108:111]
    v_mfma_f32_16x16x32_bf16 a[112:115], v[64:67], v[88:91], a[112:115]
    v_mfma_f32_16x16x32_bf16 a[116:119], v[64:67], v[92:95], a[116:119]
    v_mfma_f32_16x16x32_bf16 a[120:123], v[64:67], v[96:99], a[120:123]
    v_mfma_f32_16x16x32_bf16 a[124:127], v[64:67], v[100:103], a[124:127]
    v_mfma_f32_16x16x32_bf16 a[128:131], v[68:71], v[88:91], a[128:131]
    v_mfma_f32_16x16x32_bf16 a[132:135], v[68:71], v[92:95], a[132:135]
    v_mfma_f32_16x16x32_bf16 a[136:139], v[68:71], v[96:99], a[136:139]
    v_mfma_f32_16x16x32_bf16 a[140:143], v[68:71], v[100:103], a[140:143]
    s_waitcnt lgkmcnt(0)
    v_mfma_f32_16x16x32_bf16 a[0:3], v[0:3], v[72:75], a[0:3]
    ds_read_b128 v[88:91], v126 offset:0
    v_mfma_f32_16x16x32_bf16 a[4:7], v[0:3], v[76:79], a[4:7]
    ds_read_b128 v[92:95], v126 offset:2048
    v_mfma_f32_16x16x32_bf16 a[8:11], v[0:3], v[80:83], a[8:11]
    ds_read_b128 v[96:99], v126 offset:4096
    v_mfma_f32_16x16x32_bf16 a[12:15], v[0:3], v[84:87], a[12:15]
    ds_read_b128 v[100:103], v126 offset:6144
    v_mfma_f32_16x16x32_bf16 a[16:19], v[4:7], v[72:75], a[16:19]
    ds_read_b64_tr_b16 v[36:37], v129 offset:18432
    ds_read_b64_tr_b16 v[38:39], v129 offset:20736
    v_mfma_f32_16x16x32_bf16 a[20:23], v[4:7], v[76:79], a[20:23]
    ds_read_b64_tr_b16 v[40:41], v129 offset:18440
    v_mfma_f32_16x16x32_bf16 a[24:27], v[4:7], v[80:83], a[24:27]
    ds_read_b64_tr_b16 v[42:43], v129 offset:20744
    v_mfma_f32_16x16x32_bf16 a[28:31], v[4:7], v[84:87], a[28:31]
    ds_read_b64_tr_b16 v[44:45], v129 offset:18496
    v_mfma_f32_16x16x32_bf16 a[32:35], v[8:11], v[72:75], a[32:35]
    ds_read_b64_tr_b16 v[46:47], v129 offset:20800
    ds_read_b64_tr_b16 v[48:49], v129 offset:18504
    v_mfma_f32_16x16x32_bf16 a[36:39], v[8:11], v[76:79], a[36:39]
    ds_read_b64_tr_b16 v[50:51], v129 offset:20808
    v_mfma_f32_16x16x32_bf16 a[40:43], v[8:11], v[80:83], a[40:43]
    ds_read_b64_tr_b16 v[52:53], v129 offset:18560
    v_mfma_f32_16x16x32_bf16 a[44:47], v[8:11], v[84:87], a[44:47]
    ds_read_b64_tr_b16 v[54:55], v129 offset:20864
    v_mfma_f32_16x16x32_bf16 a[48:51], v[12:15], v[72:75], a[48:51]
    ds_read_b64_tr_b16 v[56:57], v129 offset:18568
    v_mfma_f32_16x16x32_bf16 a[52:55], v[12:15], v[76:79], a[52:55]
    ds_read_b64_tr_b16 v[58:59], v129 offset:20872
    ds_read_b64_tr_b16 v[60:61], v129 offset:18624
    v_mfma_f32_16x16x32_bf16 a[56:59], v[12:15], v[80:83], a[56:59]
    ds_read_b64_tr_b16 v[62:63], v129 offset:20928
    v_mfma_f32_16x16x32_bf16 a[60:63], v[12:15], v[84:87], a[60:63]
    ds_read_b64_tr_b16 v[64:65], v129 offset:18632
    v_mfma_f32_16x16x32_bf16 a[64:67], v[16:19], v[72:75], a[64:67]
    ds_read_b64_tr_b16 v[66:67], v129 offset:20936
    v_mfma_f32_16x16x32_bf16 a[68:71], v[16:19], v[76:79], a[68:71]
    ds_read_b64_tr_b16 v[68:69], v130 offset:18432
    ds_read_b64_tr_b16 v[70:71], v130 offset:20736
    v_mfma_f32_16x16x32_bf16 a[72:75], v[16:19], v[80:83], a[72:75]
    v_mfma_f32_16x16x32_bf16 a[76:79], v[16:19], v[84:87], a[76:79]
    v_mfma_f32_16x16x32_bf16 a[80:83], v[20:23], v[72:75], a[80:83]
    v_mfma_f32_16x16x32_bf16 a[84:87], v[20:23], v[76:79], a[84:87]
    v_mfma_f32_16x16x32_bf16 a[88:91], v[20:23], v[80:83], a[88:91]
    v_mfma_f32_16x16x32_bf16 a[92:95], v[20:23], v[84:87], a[92:95]
    v_mfma_f32_16x16x32_bf16 a[96:99], v[24:27], v[72:75], a[96:99]
    v_mfma_f32_16x16x32_bf16 a[100:103], v[24:27], v[76:79], a[100:103]
    v_mfma_f32_16x16x32_bf16 a[104:107], v[24:27], v[80:83], a[104:107]
    v_mfma_f32_16x16x32_bf16 a[108:111], v[24:27], v[84:87], a[108:111]
    v_mfma_f32_16x16x32_bf16 a[112:115], v[28:31], v[72:75], a[112:115]
    v_mfma_f32_16x16x32_bf16 a[116:119], v[28:31], v[76:79], a[116:119]
    v_mfma_f32_16x16x32_bf16 a[120:123], v[28:31], v[80:83], a[120:123]
    v_mfma_f32_16x16x32_bf16 a[124:127], v[28:31], v[84:87], a[124:127]
    v_mfma_f32_16x16x32_bf16 a[128:131], v[32:35], v[72:75], a[128:131]
    v_mfma_f32_16x16x32_bf16 a[132:135], v[32:35], v[76:79], a[132:135]
    v_mfma_f32_16x16x32_bf16 a[136:139], v[32:35], v[80:83], a[136:139]
    v_mfma_f32_16x16x32_bf16 a[140:143], v[32:35], v[84:87], a[140:143]
    s_waitcnt lgkmcnt(0)
    s_waitcnt vmcnt(13)
    s_barrier
    v_mfma_f32_16x16x32_bf16 a[0:3], v[36:39], v[88:91], a[0:3]
    ds_read_b128 v[72:75], v124 offset:0
    v_mfma_f32_16x16x32_bf16 a[4:7], v[36:39], v[92:95], a[4:7]
    ds_read_b128 v[76:79], v124 offset:2048
    v_mfma_f32_16x16x32_bf16 a[8:11], v[36:39], v[96:99], a[8:11]
    ds_read_b128 v[80:83], v124 offset:4096
    v_mfma_f32_16x16x32_bf16 a[12:15], v[36:39], v[100:103], a[12:15]
    ds_read_b128 v[84:87], v124 offset:6144
    v_mfma_f32_16x16x32_bf16 a[16:19], v[40:43], v[88:91], a[16:19]
    ds_read_b64_tr_b16 v[0:1], v131 offset:0
    ds_read_b64_tr_b16 v[2:3], v131 offset:2304
    v_mfma_f32_16x16x32_bf16 a[20:23], v[40:43], v[92:95], a[20:23]
    ds_read_b64_tr_b16 v[4:5], v131 offset:8
    v_mfma_f32_16x16x32_bf16 a[24:27], v[40:43], v[96:99], a[24:27]
    ds_read_b64_tr_b16 v[6:7], v131 offset:2312
    v_mfma_f32_16x16x32_bf16 a[28:31], v[40:43], v[100:103], a[28:31]
    ds_read_b64_tr_b16 v[8:9], v131 offset:64
    v_mfma_f32_16x16x32_bf16 a[32:35], v[44:47], v[88:91], a[32:35]
    ds_read_b64_tr_b16 v[10:11], v131 offset:2368
    ds_read_b64_tr_b16 v[12:13], v131 offset:72
    v_mfma_f32_16x16x32_bf16 a[36:39], v[44:47], v[92:95], a[36:39]
    ds_read_b64_tr_b16 v[14:15], v131 offset:2376
    v_mfma_f32_16x16x32_bf16 a[40:43], v[44:47], v[96:99], a[40:43]
    ds_read_b64_tr_b16 v[16:17], v131 offset:128
    v_mfma_f32_16x16x32_bf16 a[44:47], v[44:47], v[100:103], a[44:47]
    ds_read_b64_tr_b16 v[18:19], v131 offset:2432
    v_mfma_f32_16x16x32_bf16 a[48:51], v[48:51], v[88:91], a[48:51]
    ds_read_b64_tr_b16 v[20:21], v131 offset:136
    v_mfma_f32_16x16x32_bf16 a[52:55], v[48:51], v[92:95], a[52:55]
    ds_read_b64_tr_b16 v[22:23], v131 offset:2440
    ds_read_b64_tr_b16 v[24:25], v131 offset:192
    v_mfma_f32_16x16x32_bf16 a[56:59], v[48:51], v[96:99], a[56:59]
    ds_read_b64_tr_b16 v[26:27], v131 offset:2496
    v_mfma_f32_16x16x32_bf16 a[60:63], v[48:51], v[100:103], a[60:63]
    ds_read_b64_tr_b16 v[28:29], v131 offset:200
    v_mfma_f32_16x16x32_bf16 a[64:67], v[52:55], v[88:91], a[64:67]
    ds_read_b64_tr_b16 v[30:31], v131 offset:2504
    v_mfma_f32_16x16x32_bf16 a[68:71], v[52:55], v[92:95], a[68:71]
    ds_read_b64_tr_b16 v[32:33], v132 offset:0
    ds_read_b64_tr_b16 v[34:35], v132 offset:2304
    v_mfma_f32_16x16x32_bf16 a[72:75], v[52:55], v[96:99], a[72:75]
    v_mfma_f32_16x16x32_bf16 a[76:79], v[52:55], v[100:103], a[76:79]
    v_mfma_f32_16x16x32_bf16 a[80:83], v[56:59], v[88:91], a[80:83]
    v_mfma_f32_16x16x32_bf16 a[84:87], v[56:59], v[92:95], a[84:87]
    v_mfma_f32_16x16x32_bf16 a[88:91], v[56:59], v[96:99], a[88:91]
    v_mfma_f32_16x16x32_bf16 a[92:95], v[56:59], v[100:103], a[92:95]
    v_mfma_f32_16x16x32_bf16 a[96:99], v[60:63], v[88:91], a[96:99]
    v_mfma_f32_16x16x32_bf16 a[100:103], v[60:63], v[92:95], a[100:103]
    v_mfma_f32_16x16x32_bf16 a[104:107], v[60:63], v[96:99], a[104:107]
    v_mfma_f32_16x16x32_bf16 a[108:111], v[60:63], v[100:103], a[108:111]
    v_mfma_f32_16x16x32_bf16 a[112:115], v[64:67], v[88:91], a[112:115]
    v_mfma_f32_16x16x32_bf16 a[116:119], v[64:67], v[92:95], a[116:119]
    v_mfma_f32_16x16x32_bf16 a[120:123], v[64:67], v[96:99], a[120:123]
    v_mfma_f32_16x16x32_bf16 a[124:127], v[64:67], v[100:103], a[124:127]
    v_mfma_f32_16x16x32_bf16 a[128:131], v[68:71], v[88:91], a[128:131]
    v_mfma_f32_16x16x32_bf16 a[132:135], v[68:71], v[92:95], a[132:135]
    v_mfma_f32_16x16x32_bf16 a[136:139], v[68:71], v[96:99], a[136:139]
    v_mfma_f32_16x16x32_bf16 a[140:143], v[68:71], v[100:103], a[140:143]
    s_waitcnt lgkmcnt(0)
    v_mfma_f32_16x16x32_bf16 a[0:3], v[0:3], v[72:75], a[0:3]
    ds_read_b128 v[88:91], v127 offset:0
    v_mfma_f32_16x16x32_bf16 a[4:7], v[0:3], v[76:79], a[4:7]
    ds_read_b128 v[92:95], v127 offset:2048
    v_mfma_f32_16x16x32_bf16 a[8:11], v[0:3], v[80:83], a[8:11]
    ds_read_b128 v[96:99], v127 offset:4096
    v_mfma_f32_16x16x32_bf16 a[12:15], v[0:3], v[84:87], a[12:15]
    ds_read_b128 v[100:103], v127 offset:6144
    v_mfma_f32_16x16x32_bf16 a[16:19], v[4:7], v[72:75], a[16:19]
    ds_read_b64_tr_b16 v[36:37], v131 offset:18432
    ds_read_b64_tr_b16 v[38:39], v131 offset:20736
    v_mfma_f32_16x16x32_bf16 a[20:23], v[4:7], v[76:79], a[20:23]
    ds_read_b64_tr_b16 v[40:41], v131 offset:18440
    v_mfma_f32_16x16x32_bf16 a[24:27], v[4:7], v[80:83], a[24:27]
    ds_read_b64_tr_b16 v[42:43], v131 offset:20744
    v_mfma_f32_16x16x32_bf16 a[28:31], v[4:7], v[84:87], a[28:31]
    ds_read_b64_tr_b16 v[44:45], v131 offset:18496
    v_mfma_f32_16x16x32_bf16 a[32:35], v[8:11], v[72:75], a[32:35]
    ds_read_b64_tr_b16 v[46:47], v131 offset:20800
    ds_read_b64_tr_b16 v[48:49], v131 offset:18504
    v_mfma_f32_16x16x32_bf16 a[36:39], v[8:11], v[76:79], a[36:39]
    ds_read_b64_tr_b16 v[50:51], v131 offset:20808
    v_mfma_f32_16x16x32_bf16 a[40:43], v[8:11], v[80:83], a[40:43]
    ds_read_b64_tr_b16 v[52:53], v131 offset:18560
    v_mfma_f32_16x16x32_bf16 a[44:47], v[8:11], v[84:87], a[44:47]
    ds_read_b64_tr_b16 v[54:55], v131 offset:20864
    v_mfma_f32_16x16x32_bf16 a[48:51], v[12:15], v[72:75], a[48:51]
    ds_read_b64_tr_b16 v[56:57], v131 offset:18568
    v_mfma_f32_16x16x32_bf16 a[52:55], v[12:15], v[76:79], a[52:55]
    ds_read_b64_tr_b16 v[58:59], v131 offset:20872
    ds_read_b64_tr_b16 v[60:61], v131 offset:18624
    v_mfma_f32_16x16x32_bf16 a[56:59], v[12:15], v[80:83], a[56:59]
    ds_read_b64_tr_b16 v[62:63], v131 offset:20928
    v_mfma_f32_16x16x32_bf16 a[60:63], v[12:15], v[84:87], a[60:63]
    ds_read_b64_tr_b16 v[64:65], v131 offset:18632
    v_mfma_f32_16x16x32_bf16 a[64:67], v[16:19], v[72:75], a[64:67]
    ds_read_b64_tr_b16 v[66:67], v131 offset:20936
    v_mfma_f32_16x16x32_bf16 a[68:71], v[16:19], v[76:79], a[68:71]
    ds_read_b64_tr_b16 v[68:69], v132 offset:18432
    ds_read_b64_tr_b16 v[70:71], v132 offset:20736
    v_mfma_f32_16x16x32_bf16 a[72:75], v[16:19], v[80:83], a[72:75]
    v_mfma_f32_16x16x32_bf16 a[76:79], v[16:19], v[84:87], a[76:79]
    v_mfma_f32_16x16x32_bf16 a[80:83], v[20:23], v[72:75], a[80:83]
    v_mfma_f32_16x16x32_bf16 a[84:87], v[20:23], v[76:79], a[84:87]
    v_mfma_f32_16x16x32_bf16 a[88:91], v[20:23], v[80:83], a[88:91]
    v_mfma_f32_16x16x32_bf16 a[92:95], v[20:23], v[84:87], a[92:95]
    v_mfma_f32_16x16x32_bf16 a[96:99], v[24:27], v[72:75], a[96:99]
    v_mfma_f32_16x16x32_bf16 a[100:103], v[24:27], v[76:79], a[100:103]
    v_mfma_f32_16x16x32_bf16 a[104:107], v[24:27], v[80:83], a[104:107]
    v_mfma_f32_16x16x32_bf16 a[108:111], v[24:27], v[84:87], a[108:111]
    v_mfma_f32_16x16x32_bf16 a[112:115], v[28:31], v[72:75], a[112:115]
    v_mfma_f32_16x16x32_bf16 a[116:119], v[28:31], v[76:79], a[116:119]
    v_mfma_f32_16x16x32_bf16 a[120:123], v[28:31], v[80:83], a[120:123]
    v_mfma_f32_16x16x32_bf16 a[124:127], v[28:31], v[84:87], a[124:127]
    v_mfma_f32_16x16x32_bf16 a[128:131], v[32:35], v[72:75], a[128:131]
    v_mfma_f32_16x16x32_bf16 a[132:135], v[32:35], v[76:79], a[132:135]
    v_mfma_f32_16x16x32_bf16 a[136:139], v[32:35], v[80:83], a[136:139]
    v_mfma_f32_16x16x32_bf16 a[140:143], v[32:35], v[84:87], a[140:143]
    s_waitcnt lgkmcnt(0)
    s_waitcnt vmcnt(0)
    s_barrier
    v_mfma_f32_16x16x32_bf16 a[0:3], v[36:39], v[88:91], a[0:3]
    ds_read_b128 v[72:75], v125 offset:0
    v_mfma_f32_16x16x32_bf16 a[4:7], v[36:39], v[92:95], a[4:7]
    ds_read_b128 v[76:79], v125 offset:2048
    v_mfma_f32_16x16x32_bf16 a[8:11], v[36:39], v[96:99], a[8:11]
    ds_read_b128 v[80:83], v125 offset:4096
    v_mfma_f32_16x16x32_bf16 a[12:15], v[36:39], v[100:103], a[12:15]
    ds_read_b128 v[84:87], v125 offset:6144
    v_mfma_f32_16x16x32_bf16 a[16:19], v[40:43], v[88:91], a[16:19]
    ds_read_b64_tr_b16 v[0:1], v133 offset:0
    ds_read_b64_tr_b16 v[2:3], v133 offset:2304
    v_mfma_f32_16x16x32_bf16 a[20:23], v[40:43], v[92:95], a[20:23]
    ds_read_b64_tr_b16 v[4:5], v133 offset:8
    v_mfma_f32_16x16x32_bf16 a[24:27], v[40:43], v[96:99], a[24:27]
    ds_read_b64_tr_b16 v[6:7], v133 offset:2312
    v_mfma_f32_16x16x32_bf16 a[28:31], v[40:43], v[100:103], a[28:31]
    ds_read_b64_tr_b16 v[8:9], v133 offset:64
    v_mfma_f32_16x16x32_bf16 a[32:35], v[44:47], v[88:91], a[32:35]
    ds_read_b64_tr_b16 v[10:11], v133 offset:2368
    ds_read_b64_tr_b16 v[12:13], v133 offset:72
    v_mfma_f32_16x16x32_bf16 a[36:39], v[44:47], v[92:95], a[36:39]
    ds_read_b64_tr_b16 v[14:15], v133 offset:2376
    v_mfma_f32_16x16x32_bf16 a[40:43], v[44:47], v[96:99], a[40:43]
    ds_read_b64_tr_b16 v[16:17], v133 offset:128
    v_mfma_f32_16x16x32_bf16 a[44:47], v[44:47], v[100:103], a[44:47]
    ds_read_b64_tr_b16 v[18:19], v133 offset:2432
    v_mfma_f32_16x16x32_bf16 a[48:51], v[48:51], v[88:91], a[48:51]
    ds_read_b64_tr_b16 v[20:21], v133 offset:136
    v_mfma_f32_16x16x32_bf16 a[52:55], v[48:51], v[92:95], a[52:55]
    ds_read_b64_tr_b16 v[22:23], v133 offset:2440
    ds_read_b64_tr_b16 v[24:25], v133 offset:192
    v_mfma_f32_16x16x32_bf16 a[56:59], v[48:51], v[96:99], a[56:59]
    ds_read_b64_tr_b16 v[26:27], v133 offset:2496
    v_mfma_f32_16x16x32_bf16 a[60:63], v[48:51], v[100:103], a[60:63]
    ds_read_b64_tr_b16 v[28:29], v133 offset:200
    v_mfma_f32_16x16x32_bf16 a[64:67], v[52:55], v[88:91], a[64:67]
    ds_read_b64_tr_b16 v[30:31], v133 offset:2504
    v_mfma_f32_16x16x32_bf16 a[68:71], v[52:55], v[92:95], a[68:71]
    ds_read_b64_tr_b16 v[32:33], v134 offset:0
    ds_read_b64_tr_b16 v[34:35], v134 offset:2304
    v_mfma_f32_16x16x32_bf16 a[72:75], v[52:55], v[96:99], a[72:75]
    v_mfma_f32_16x16x32_bf16 a[76:79], v[52:55], v[100:103], a[76:79]
    v_mfma_f32_16x16x32_bf16 a[80:83], v[56:59], v[88:91], a[80:83]
    v_mfma_f32_16x16x32_bf16 a[84:87], v[56:59], v[92:95], a[84:87]
    v_mfma_f32_16x16x32_bf16 a[88:91], v[56:59], v[96:99], a[88:91]
    v_mfma_f32_16x16x32_bf16 a[92:95], v[56:59], v[100:103], a[92:95]
    v_mfma_f32_16x16x32_bf16 a[96:99], v[60:63], v[88:91], a[96:99]
    v_mfma_f32_16x16x32_bf16 a[100:103], v[60:63], v[92:95], a[100:103]
    v_mfma_f32_16x16x32_bf16 a[104:107], v[60:63], v[96:99], a[104:107]
    v_mfma_f32_16x16x32_bf16 a[108:111], v[60:63], v[100:103], a[108:111]
    v_mfma_f32_16x16x32_bf16 a[112:115], v[64:67], v[88:91], a[112:115]
    v_mfma_f32_16x16x32_bf16 a[116:119], v[64:67], v[92:95], a[116:119]
    v_mfma_f32_16x16x32_bf16 a[120:123], v[64:67], v[96:99], a[120:123]
    v_mfma_f32_16x16x32_bf16 a[124:127], v[64:67], v[100:103], a[124:127]
    v_mfma_f32_16x16x32_bf16 a[128:131], v[68:71], v[88:91], a[128:131]
    v_mfma_f32_16x16x32_bf16 a[132:135], v[68:71], v[92:95], a[132:135]
    v_mfma_f32_16x16x32_bf16 a[136:139], v[68:71], v[96:99], a[136:139]
    v_mfma_f32_16x16x32_bf16 a[140:143], v[68:71], v[100:103], a[140:143]
    s_waitcnt lgkmcnt(0)
    v_mfma_f32_16x16x32_bf16 a[0:3], v[0:3], v[72:75], a[0:3]
    ds_read_b128 v[88:91], v128 offset:0
    v_mfma_f32_16x16x32_bf16 a[4:7], v[0:3], v[76:79], a[4:7]
    ds_read_b128 v[92:95], v128 offset:2048
    v_mfma_f32_16x16x32_bf16 a[8:11], v[0:3], v[80:83], a[8:11]
    ds_read_b128 v[96:99], v128 offset:4096
    v_mfma_f32_16x16x32_bf16 a[12:15], v[0:3], v[84:87], a[12:15]
    ds_read_b128 v[100:103], v128 offset:6144
    v_mfma_f32_16x16x32_bf16 a[16:19], v[4:7], v[72:75], a[16:19]
    ds_read_b64_tr_b16 v[36:37], v133 offset:18432
    ds_read_b64_tr_b16 v[38:39], v133 offset:20736
    v_mfma_f32_16x16x32_bf16 a[20:23], v[4:7], v[76:79], a[20:23]
    ds_read_b64_tr_b16 v[40:41], v133 offset:18440
    v_mfma_f32_16x16x32_bf16 a[24:27], v[4:7], v[80:83], a[24:27]
    ds_read_b64_tr_b16 v[42:43], v133 offset:20744
    v_mfma_f32_16x16x32_bf16 a[28:31], v[4:7], v[84:87], a[28:31]
    ds_read_b64_tr_b16 v[44:45], v133 offset:18496
    v_mfma_f32_16x16x32_bf16 a[32:35], v[8:11], v[72:75], a[32:35]
    ds_read_b64_tr_b16 v[46:47], v133 offset:20800
    ds_read_b64_tr_b16 v[48:49], v133 offset:18504
    v_mfma_f32_16x16x32_bf16 a[36:39], v[8:11], v[76:79], a[36:39]
    ds_read_b64_tr_b16 v[50:51], v133 offset:20808
    v_mfma_f32_16x16x32_bf16 a[40:43], v[8:11], v[80:83], a[40:43]
    ds_read_b64_tr_b16 v[52:53], v133 offset:18560
    v_mfma_f32_16x16x32_bf16 a[44:47], v[8:11], v[84:87], a[44:47]
    ds_read_b64_tr_b16 v[54:55], v133 offset:20864
    v_mfma_f32_16x16x32_bf16 a[48:51], v[12:15], v[72:75], a[48:51]
    ds_read_b64_tr_b16 v[56:57], v133 offset:18568
    v_mfma_f32_16x16x32_bf16 a[52:55], v[12:15], v[76:79], a[52:55]
    ds_read_b64_tr_b16 v[58:59], v133 offset:20872
    ds_read_b64_tr_b16 v[60:61], v133 offset:18624
    v_mfma_f32_16x16x32_bf16 a[56:59], v[12:15], v[80:83], a[56:59]
    ds_read_b64_tr_b16 v[62:63], v133 offset:20928
    v_mfma_f32_16x16x32_bf16 a[60:63], v[12:15], v[84:87], a[60:63]
    ds_read_b64_tr_b16 v[64:65], v133 offset:18632
    v_mfma_f32_16x16x32_bf16 a[64:67], v[16:19], v[72:75], a[64:67]
    ds_read_b64_tr_b16 v[66:67], v133 offset:20936
    v_mfma_f32_16x16x32_bf16 a[68:71], v[16:19], v[76:79], a[68:71]
    ds_read_b64_tr_b16 v[68:69], v134 offset:18432
    ds_read_b64_tr_b16 v[70:71], v134 offset:20736
    v_mfma_f32_16x16x32_bf16 a[72:75], v[16:19], v[80:83], a[72:75]
    v_mfma_f32_16x16x32_bf16 a[76:79], v[16:19], v[84:87], a[76:79]
    v_mfma_f32_16x16x32_bf16 a[80:83], v[20:23], v[72:75], a[80:83]
    v_mfma_f32_16x16x32_bf16 a[84:87], v[20:23], v[76:79], a[84:87]
    v_mfma_f32_16x16x32_bf16 a[88:91], v[20:23], v[80:83], a[88:91]
    v_mfma_f32_16x16x32_bf16 a[92:95], v[20:23], v[84:87], a[92:95]
    v_mfma_f32_16x16x32_bf16 a[96:99], v[24:27], v[72:75], a[96:99]
    v_mfma_f32_16x16x32_bf16 a[100:103], v[24:27], v[76:79], a[100:103]
    v_mfma_f32_16x16x32_bf16 a[104:107], v[24:27], v[80:83], a[104:107]
    v_mfma_f32_16x16x32_bf16 a[108:111], v[24:27], v[84:87], a[108:111]
    v_mfma_f32_16x16x32_bf16 a[112:115], v[28:31], v[72:75], a[112:115]
    v_mfma_f32_16x16x32_bf16 a[116:119], v[28:31], v[76:79], a[116:119]
    v_mfma_f32_16x16x32_bf16 a[120:123], v[28:31], v[80:83], a[120:123]
    v_mfma_f32_16x16x32_bf16 a[124:127], v[28:31], v[84:87], a[124:127]
    v_mfma_f32_16x16x32_bf16 a[128:131], v[32:35], v[72:75], a[128:131]
    v_mfma_f32_16x16x32_bf16 a[132:135], v[32:35], v[76:79], a[132:135]
    v_mfma_f32_16x16x32_bf16 a[136:139], v[32:35], v[80:83], a[136:139]
    v_mfma_f32_16x16x32_bf16 a[140:143], v[32:35], v[84:87], a[140:143]
    s_waitcnt lgkmcnt(0)
    s_waitcnt vmcnt(0)
    s_barrier
    v_mfma_f32_16x16x32_bf16 a[0:3], v[36:39], v[88:91], a[0:3]
    v_mfma_f32_16x16x32_bf16 a[4:7], v[36:39], v[92:95], a[4:7]
    v_mfma_f32_16x16x32_bf16 a[8:11], v[36:39], v[96:99], a[8:11]
    v_mfma_f32_16x16x32_bf16 a[12:15], v[36:39], v[100:103], a[12:15]
    v_mfma_f32_16x16x32_bf16 a[16:19], v[40:43], v[88:91], a[16:19]
    v_mfma_f32_16x16x32_bf16 a[20:23], v[40:43], v[92:95], a[20:23]
    v_mfma_f32_16x16x32_bf16 a[24:27], v[40:43], v[96:99], a[24:27]
    v_mfma_f32_16x16x32_bf16 a[28:31], v[40:43], v[100:103], a[28:31]
    v_mfma_f32_16x16x32_bf16 a[32:35], v[44:47], v[88:91], a[32:35]
    v_mfma_f32_16x16x32_bf16 a[36:39], v[44:47], v[92:95], a[36:39]
    v_mfma_f32_16x16x32_bf16 a[40:43], v[44:47], v[96:99], a[40:43]
    v_mfma_f32_16x16x32_bf16 a[44:47], v[44:47], v[100:103], a[44:47]
    v_mfma_f32_16x16x32_bf16 a[48:51], v[48:51], v[88:91], a[48:51]
    v_mfma_f32_16x16x32_bf16 a[52:55], v[48:51], v[92:95], a[52:55]
    v_mfma_f32_16x16x32_bf16 a[56:59], v[48:51], v[96:99], a[56:59]
    v_mfma_f32_16x16x32_bf16 a[60:63], v[48:51], v[100:103], a[60:63]
    v_mfma_f32_16x16x32_bf16 a[64:67], v[52:55], v[88:91], a[64:67]
    v_mfma_f32_16x16x32_bf16 a[68:71], v[52:55], v[92:95], a[68:71]
    v_mfma_f32_16x16x32_bf16 a[72:75], v[52:55], v[96:99], a[72:75]
    v_mfma_f32_16x16x32_bf16 a[76:79], v[52:55], v[100:103], a[76:79]
    v_mfma_f32_16x16x32_bf16 a[80:83], v[56:59], v[88:91], a[80:83]
    v_mfma_f32_16x16x32_bf16 a[84:87], v[56:59], v[92:95], a[84:87]
    v_mfma_f32_16x16x32_bf16 a[88:91], v[56:59], v[96:99], a[88:91]
    v_mfma_f32_16x16x32_bf16 a[92:95], v[56:59], v[100:103], a[92:95]
    v_mfma_f32_16x16x32_bf16 a[96:99], v[60:63], v[88:91], a[96:99]
    v_mfma_f32_16x16x32_bf16 a[100:103], v[60:63], v[92:95], a[100:103]
    v_mfma_f32_16x16x32_bf16 a[104:107], v[60:63], v[96:99], a[104:107]
    v_mfma_f32_16x16x32_bf16 a[108:111], v[60:63], v[100:103], a[108:111]
    v_mfma_f32_16x16x32_bf16 a[112:115], v[64:67], v[88:91], a[112:115]
    v_mfma_f32_16x16x32_bf16 a[116:119], v[64:67], v[92:95], a[116:119]
    v_mfma_f32_16x16x32_bf16 a[120:123], v[64:67], v[96:99], a[120:123]
    v_mfma_f32_16x16x32_bf16 a[124:127], v[64:67], v[100:103], a[124:127]
    v_mfma_f32_16x16x32_bf16 a[128:131], v[68:71], v[88:91], a[128:131]
    v_mfma_f32_16x16x32_bf16 a[132:135], v[68:71], v[92:95], a[132:135]
    v_mfma_f32_16x16x32_bf16 a[136:139], v[68:71], v[96:99], a[136:139]
    v_mfma_f32_16x16x32_bf16 a[140:143], v[68:71], v[100:103], a[140:143]
    s_nop 7
    s_nop 7
    v_lshrrev_b32 v0, 4, v104
    v_and_b32 v1, 15, v104
    s_lshl_b32 s33, s22, 7
    s_lshl_b32 s34, s31, 6
    s_add_u32 s33, s33, s34
    v_add_u32 v2, s33, v1
    s_movk_i32 s28, 9216
    v_mul_lo_u32 v2, v2, s28
    s_mul_i32 s34, s21, 576
    s_mul_i32 s35, s32, 288
    s_add_u32 s34, s34, s35
    v_lshl_add_u32 v3, v0, 4, v2
    v_add_u32 v3, s34, v3
    v_lshl_add_u32 v4, v0, 3, v2
    v_add_u32 v4, s34, v4
    s_add_u32 s36, s18, 20971520
    s_addc_u32 s37, s19, 0
    v_mov_b32 v30, 0xbfb8aa3b
    v_mov_b32 v31, 0xbfb8aa3b
    v_mov_b32 v32, 1.0
    v_mov_b32 v33, 1.0
    v_accvgpr_read_b32 v10, a0
    v_accvgpr_read_b32 v11, a1
    v_accvgpr_read_b32 v12, a2
    v_accvgpr_read_b32 v13, a3
    v_accvgpr_read_b32 v14, a16
    v_accvgpr_read_b32 v15, a17
    v_accvgpr_read_b32 v16, a18
    v_accvgpr_read_b32 v17, a19
    v_cvt_pk_bf16_f32 v20, v10, v11
    v_lshlrev_b32 v10, 16, v20
    v_and_b32 v11, 0xffff0000, v20
    v_cvt_pk_bf16_f32 v20, v12, v13
    v_lshlrev_b32 v12, 16, v20
    v_and_b32 v13, 0xffff0000, v20
    v_cvt_pk_bf16_f32 v20, v14, v15
    v_lshlrev_b32 v14, 16, v20
    v_and_b32 v15, 0xffff0000, v20
    v_cvt_pk_bf16_f32 v20, v16, v17
    v_lshlrev_b32 v16, 16, v20
    v_and_b32 v17, 0xffff0000, v20
    v_pk_mul_f32 v[40:41], v[10:11], v[30:31]
    v_pk_mul_f32 v[42:43], v[12:13], v[30:31]
    v_pk_mul_f32 v[44:45], v[14:15], v[30:31]
    v_pk_mul_f32 v[46:47], v[16:17], v[30:31]
    v_exp_f32 v40, v40
    v_exp_f32 v41, v41
    v_exp_f32 v42, v42
    v_exp_f32 v43, v43
    v_exp_f32 v44, v44
    v_exp_f32 v45, v45
    v_exp_f32 v46, v46
    v_exp_f32 v47, v47
    v_pk_add_f32 v[40:41], v[40:41], v[32:33]
    v_pk_add_f32 v[42:43], v[42:43], v[32:33]
    v_pk_add_f32 v[44:45], v[44:45], v[32:33]
    v_pk_add_f32 v[46:47], v[46:47], v[32:33]
    v_rcp_f32 v40, v40
    v_rcp_f32 v41, v41
    v_rcp_f32 v42, v42
    v_rcp_f32 v43, v43
    v_rcp_f32 v44, v44
    v_rcp_f32 v45, v45
    v_rcp_f32 v46, v46
    v_rcp_f32 v47, v47
    v_pk_mul_f32 v[10:11], v[10:11], v[40:41]
    v_pk_mul_f32 v[12:13], v[12:13], v[42:43]
    v_pk_mul_f32 v[14:15], v[14:15], v[44:45]
    v_pk_mul_f32 v[16:17], v[16:17], v[46:47]
    v_cvt_pk_bf16_f32 v24, v10, v11
    v_cvt_pk_bf16_f32 v25, v12, v13
    v_cvt_pk_bf16_f32 v26, v14, v15
    v_cvt_pk_bf16_f32 v27, v16, v17
    v_add_u32 v5, 0, v3
    global_store_dwordx4 v5, v[24:27], s[36:37]
    v_accvgpr_read_b32 v10, a32
    v_accvgpr_read_b32 v11, a33
    v_accvgpr_read_b32 v12, a34
    v_accvgpr_read_b32 v13, a35
    v_accvgpr_read_b32 v14, a48
    v_accvgpr_read_b32 v15, a49
    v_accvgpr_read_b32 v16, a50
    v_accvgpr_read_b32 v17, a51
    v_cvt_pk_bf16_f32 v20, v10, v11
    v_lshlrev_b32 v10, 16, v20
    v_and_b32 v11, 0xffff0000, v20
    v_cvt_pk_bf16_f32 v20, v12, v13
    v_lshlrev_b32 v12, 16, v20
    v_and_b32 v13, 0xffff0000, v20
    v_cvt_pk_bf16_f32 v20, v14, v15
    v_lshlrev_b32 v14, 16, v20
    v_and_b32 v15, 0xffff0000, v20
    v_cvt_pk_bf16_f32 v20, v16, v17
    v_lshlrev_b32 v16, 16, v20
    v_and_b32 v17, 0xffff0000, v20
    v_pk_mul_f32 v[40:41], v[10:11], v[30:31]
    v_pk_mul_f32 v[42:43], v[12:13], v[30:31]
    v_pk_mul_f32 v[44:45], v[14:15], v[30:31]
    v_pk_mul_f32 v[46:47], v[16:17], v[30:31]
    v_exp_f32 v40, v40
    v_exp_f32 v41, v41
    v_exp_f32 v42, v42
    v_exp_f32 v43, v43
    v_exp_f32 v44, v44
    v_exp_f32 v45, v45
    v_exp_f32 v46, v46
    v_exp_f32 v47, v47
    v_pk_add_f32 v[40:41], v[40:41], v[32:33]
    v_pk_add_f32 v[42:43], v[42:43], v[32:33]
    v_pk_add_f32 v[44:45], v[44:45], v[32:33]
    v_pk_add_f32 v[46:47], v[46:47], v[32:33]
    v_rcp_f32 v40, v40
    v_rcp_f32 v41, v41
    v_rcp_f32 v42, v42
    v_rcp_f32 v43, v43
    v_rcp_f32 v44, v44
    v_rcp_f32 v45, v45
    v_rcp_f32 v46, v46
    v_rcp_f32 v47, v47
    v_pk_mul_f32 v[10:11], v[10:11], v[40:41]
    v_pk_mul_f32 v[12:13], v[12:13], v[42:43]
    v_pk_mul_f32 v[14:15], v[14:15], v[44:45]
    v_pk_mul_f32 v[16:17], v[16:17], v[46:47]
    v_cvt_pk_bf16_f32 v24, v10, v11
    v_cvt_pk_bf16_f32 v25, v12, v13
    v_cvt_pk_bf16_f32 v26, v14, v15
    v_cvt_pk_bf16_f32 v27, v16, v17
    v_add_u32 v5, 64, v3
    global_store_dwordx4 v5, v[24:27], s[36:37]
    v_accvgpr_read_b32 v10, a64
    v_accvgpr_read_b32 v11, a65
    v_accvgpr_read_b32 v12, a66
    v_accvgpr_read_b32 v13, a67
    v_accvgpr_read_b32 v14, a80
    v_accvgpr_read_b32 v15, a81
    v_accvgpr_read_b32 v16, a82
    v_accvgpr_read_b32 v17, a83
    v_cvt_pk_bf16_f32 v20, v10, v11
    v_lshlrev_b32 v10, 16, v20
    v_and_b32 v11, 0xffff0000, v20
    v_cvt_pk_bf16_f32 v20, v12, v13
    v_lshlrev_b32 v12, 16, v20
    v_and_b32 v13, 0xffff0000, v20
    v_cvt_pk_bf16_f32 v20, v14, v15
    v_lshlrev_b32 v14, 16, v20
    v_and_b32 v15, 0xffff0000, v20
    v_cvt_pk_bf16_f32 v20, v16, v17
    v_lshlrev_b32 v16, 16, v20
    v_and_b32 v17, 0xffff0000, v20
    v_pk_mul_f32 v[40:41], v[10:11], v[30:31]
    v_pk_mul_f32 v[42:43], v[12:13], v[30:31]
    v_pk_mul_f32 v[44:45], v[14:15], v[30:31]
    v_pk_mul_f32 v[46:47], v[16:17], v[30:31]
    v_exp_f32 v40, v40
    v_exp_f32 v41, v41
    v_exp_f32 v42, v42
    v_exp_f32 v43, v43
    v_exp_f32 v44, v44
    v_exp_f32 v45, v45
    v_exp_f32 v46, v46
    v_exp_f32 v47, v47
    v_pk_add_f32 v[40:41], v[40:41], v[32:33]
    v_pk_add_f32 v[42:43], v[42:43], v[32:33]
    v_pk_add_f32 v[44:45], v[44:45], v[32:33]
    v_pk_add_f32 v[46:47], v[46:47], v[32:33]
    v_rcp_f32 v40, v40
    v_rcp_f32 v41, v41
    v_rcp_f32 v42, v42
    v_rcp_f32 v43, v43
    v_rcp_f32 v44, v44
    v_rcp_f32 v45, v45
    v_rcp_f32 v46, v46
    v_rcp_f32 v47, v47
    v_pk_mul_f32 v[10:11], v[10:11], v[40:41]
    v_pk_mul_f32 v[12:13], v[12:13], v[42:43]
    v_pk_mul_f32 v[14:15], v[14:15], v[44:45]
    v_pk_mul_f32 v[16:17], v[16:17], v[46:47]
    v_cvt_pk_bf16_f32 v24, v10, v11
    v_cvt_pk_bf16_f32 v25, v12, v13
    v_cvt_pk_bf16_f32 v26, v14, v15
    v_cvt_pk_bf16_f32 v27, v16, v17
    v_add_u32 v5, 128, v3
    global_store_dwordx4 v5, v[24:27], s[36:37]
    v_accvgpr_read_b32 v10, a96
    v_accvgpr_read_b32 v11, a97
    v_accvgpr_read_b32 v12, a98
    v_accvgpr_read_b32 v13, a99
    v_accvgpr_read_b32 v14, a112
    v_accvgpr_read_b32 v15, a113
    v_accvgpr_read_b32 v16, a114
    v_accvgpr_read_b32 v17, a115
    v_cvt_pk_bf16_f32 v20, v10, v11
    v_lshlrev_b32 v10, 16, v20
    v_and_b32 v11, 0xffff0000, v20
    v_cvt_pk_bf16_f32 v20, v12, v13
    v_lshlrev_b32 v12, 16, v20
    v_and_b32 v13, 0xffff0000, v20
    v_cvt_pk_bf16_f32 v20, v14, v15
    v_lshlrev_b32 v14, 16, v20
    v_and_b32 v15, 0xffff0000, v20
    v_cvt_pk_bf16_f32 v20, v16, v17
    v_lshlrev_b32 v16, 16, v20
    v_and_b32 v17, 0xffff0000, v20
    v_pk_mul_f32 v[40:41], v[10:11], v[30:31]
    v_pk_mul_f32 v[42:43], v[12:13], v[30:31]
    v_pk_mul_f32 v[44:45], v[14:15], v[30:31]
    v_pk_mul_f32 v[46:47], v[16:17], v[30:31]
    v_exp_f32 v40, v40
    v_exp_f32 v41, v41
    v_exp_f32 v42, v42
    v_exp_f32 v43, v43
    v_exp_f32 v44, v44
    v_exp_f32 v45, v45
    v_exp_f32 v46, v46
    v_exp_f32 v47, v47
    v_pk_add_f32 v[40:41], v[40:41], v[32:33]
    v_pk_add_f32 v[42:43], v[42:43], v[32:33]
    v_pk_add_f32 v[44:45], v[44:45], v[32:33]
    v_pk_add_f32 v[46:47], v[46:47], v[32:33]
    v_rcp_f32 v40, v40
    v_rcp_f32 v41, v41
    v_rcp_f32 v42, v42
    v_rcp_f32 v43, v43
    v_rcp_f32 v44, v44
    v_rcp_f32 v45, v45
    v_rcp_f32 v46, v46
    v_rcp_f32 v47, v47
    v_pk_mul_f32 v[10:11], v[10:11], v[40:41]
    v_pk_mul_f32 v[12:13], v[12:13], v[42:43]
    v_pk_mul_f32 v[14:15], v[14:15], v[44:45]
    v_pk_mul_f32 v[16:17], v[16:17], v[46:47]
    v_cvt_pk_bf16_f32 v24, v10, v11
    v_cvt_pk_bf16_f32 v25, v12, v13
    v_cvt_pk_bf16_f32 v26, v14, v15
    v_cvt_pk_bf16_f32 v27, v16, v17
    v_add_u32 v5, 192, v3
    global_store_dwordx4 v5, v[24:27], s[36:37]
    v_accvgpr_read_b32 v10, a128
    v_accvgpr_read_b32 v11, a129
    v_accvgpr_read_b32 v12, a130
    v_accvgpr_read_b32 v13, a131
    v_cvt_pk_bf16_f32 v20, v10, v11
    v_lshlrev_b32 v10, 16, v20
    v_and_b32 v11, 0xffff0000, v20
    v_cvt_pk_bf16_f32 v20, v12, v13
    v_lshlrev_b32 v12, 16, v20
    v_and_b32 v13, 0xffff0000, v20
    v_pk_mul_f32 v[40:41], v[10:11], v[30:31]
    v_pk_mul_f32 v[42:43], v[12:13], v[30:31]
    v_exp_f32 v40, v40
    v_exp_f32 v41, v41
    v_exp_f32 v42, v42
    v_exp_f32 v43, v43
    v_pk_add_f32 v[40:41], v[40:41], v[32:33]
    v_pk_add_f32 v[42:43], v[42:43], v[32:33]
    v_rcp_f32 v40, v40
    v_rcp_f32 v41, v41
    v_rcp_f32 v42, v42
    v_rcp_f32 v43, v43
    v_pk_mul_f32 v[10:11], v[10:11], v[40:41]
    v_pk_mul_f32 v[12:13], v[12:13], v[42:43]
    v_cvt_pk_bf16_f32 v24, v10, v11
    v_cvt_pk_bf16_f32 v25, v12, v13
    v_add_u32 v5, 256, v4
    global_store_dwordx2 v5, v[24:25], s[36:37]
    v_accvgpr_read_b32 v10, a4
    v_accvgpr_read_b32 v11, a5
    v_accvgpr_read_b32 v12, a6
    v_accvgpr_read_b32 v13, a7
    v_accvgpr_read_b32 v14, a20
    v_accvgpr_read_b32 v15, a21
    v_accvgpr_read_b32 v16, a22
    v_accvgpr_read_b32 v17, a23
    v_cvt_pk_bf16_f32 v20, v10, v11
    v_lshlrev_b32 v10, 16, v20
    v_and_b32 v11, 0xffff0000, v20
    v_cvt_pk_bf16_f32 v20, v12, v13
    v_lshlrev_b32 v12, 16, v20
    v_and_b32 v13, 0xffff0000, v20
    v_cvt_pk_bf16_f32 v20, v14, v15
    v_lshlrev_b32 v14, 16, v20
    v_and_b32 v15, 0xffff0000, v20
    v_cvt_pk_bf16_f32 v20, v16, v17
    v_lshlrev_b32 v16, 16, v20
    v_and_b32 v17, 0xffff0000, v20
    v_pk_mul_f32 v[40:41], v[10:11], v[30:31]
    v_pk_mul_f32 v[42:43], v[12:13], v[30:31]
    v_pk_mul_f32 v[44:45], v[14:15], v[30:31]
    v_pk_mul_f32 v[46:47], v[16:17], v[30:31]
    v_exp_f32 v40, v40
    v_exp_f32 v41, v41
    v_exp_f32 v42, v42
    v_exp_f32 v43, v43
    v_exp_f32 v44, v44
    v_exp_f32 v45, v45
    v_exp_f32 v46, v46
    v_exp_f32 v47, v47
    v_pk_add_f32 v[40:41], v[40:41], v[32:33]
    v_pk_add_f32 v[42:43], v[42:43], v[32:33]
    v_pk_add_f32 v[44:45], v[44:45], v[32:33]
    v_pk_add_f32 v[46:47], v[46:47], v[32:33]
    v_rcp_f32 v40, v40
    v_rcp_f32 v41, v41
    v_rcp_f32 v42, v42
    v_rcp_f32 v43, v43
    v_rcp_f32 v44, v44
    v_rcp_f32 v45, v45
    v_rcp_f32 v46, v46
    v_rcp_f32 v47, v47
    v_pk_mul_f32 v[10:11], v[10:11], v[40:41]
    v_pk_mul_f32 v[12:13], v[12:13], v[42:43]
    v_pk_mul_f32 v[14:15], v[14:15], v[44:45]
    v_pk_mul_f32 v[16:17], v[16:17], v[46:47]
    v_cvt_pk_bf16_f32 v24, v10, v11
    v_cvt_pk_bf16_f32 v25, v12, v13
    v_cvt_pk_bf16_f32 v26, v14, v15
    v_cvt_pk_bf16_f32 v27, v16, v17
    v_add_u32 v5, 147456, v3
    global_store_dwordx4 v5, v[24:27], s[36:37]
    v_accvgpr_read_b32 v10, a36
    v_accvgpr_read_b32 v11, a37
    v_accvgpr_read_b32 v12, a38
    v_accvgpr_read_b32 v13, a39
    v_accvgpr_read_b32 v14, a52
    v_accvgpr_read_b32 v15, a53
    v_accvgpr_read_b32 v16, a54
    v_accvgpr_read_b32 v17, a55
    v_cvt_pk_bf16_f32 v20, v10, v11
    v_lshlrev_b32 v10, 16, v20
    v_and_b32 v11, 0xffff0000, v20
    v_cvt_pk_bf16_f32 v20, v12, v13
    v_lshlrev_b32 v12, 16, v20
    v_and_b32 v13, 0xffff0000, v20
    v_cvt_pk_bf16_f32 v20, v14, v15
    v_lshlrev_b32 v14, 16, v20
    v_and_b32 v15, 0xffff0000, v20
    v_cvt_pk_bf16_f32 v20, v16, v17
    v_lshlrev_b32 v16, 16, v20
    v_and_b32 v17, 0xffff0000, v20
    v_pk_mul_f32 v[40:41], v[10:11], v[30:31]
    v_pk_mul_f32 v[42:43], v[12:13], v[30:31]
    v_pk_mul_f32 v[44:45], v[14:15], v[30:31]
    v_pk_mul_f32 v[46:47], v[16:17], v[30:31]
    v_exp_f32 v40, v40
    v_exp_f32 v41, v41
    v_exp_f32 v42, v42
    v_exp_f32 v43, v43
    v_exp_f32 v44, v44
    v_exp_f32 v45, v45
    v_exp_f32 v46, v46
    v_exp_f32 v47, v47
    v_pk_add_f32 v[40:41], v[40:41], v[32:33]
    v_pk_add_f32 v[42:43], v[42:43], v[32:33]
    v_pk_add_f32 v[44:45], v[44:45], v[32:33]
    v_pk_add_f32 v[46:47], v[46:47], v[32:33]
    v_rcp_f32 v40, v40
    v_rcp_f32 v41, v41
    v_rcp_f32 v42, v42
    v_rcp_f32 v43, v43
    v_rcp_f32 v44, v44
    v_rcp_f32 v45, v45
    v_rcp_f32 v46, v46
    v_rcp_f32 v47, v47
    v_pk_mul_f32 v[10:11], v[10:11], v[40:41]
    v_pk_mul_f32 v[12:13], v[12:13], v[42:43]
    v_pk_mul_f32 v[14:15], v[14:15], v[44:45]
    v_pk_mul_f32 v[16:17], v[16:17], v[46:47]
    v_cvt_pk_bf16_f32 v24, v10, v11
    v_cvt_pk_bf16_f32 v25, v12, v13
    v_cvt_pk_bf16_f32 v26, v14, v15
    v_cvt_pk_bf16_f32 v27, v16, v17
    v_add_u32 v5, 147520, v3
    global_store_dwordx4 v5, v[24:27], s[36:37]
    v_accvgpr_read_b32 v10, a68
    v_accvgpr_read_b32 v11, a69
    v_accvgpr_read_b32 v12, a70
    v_accvgpr_read_b32 v13, a71
    v_accvgpr_read_b32 v14, a84
    v_accvgpr_read_b32 v15, a85
    v_accvgpr_read_b32 v16, a86
    v_accvgpr_read_b32 v17, a87
    v_cvt_pk_bf16_f32 v20, v10, v11
    v_lshlrev_b32 v10, 16, v20
    v_and_b32 v11, 0xffff0000, v20
    v_cvt_pk_bf16_f32 v20, v12, v13
    v_lshlrev_b32 v12, 16, v20
    v_and_b32 v13, 0xffff0000, v20
    v_cvt_pk_bf16_f32 v20, v14, v15
    v_lshlrev_b32 v14, 16, v20
    v_and_b32 v15, 0xffff0000, v20
    v_cvt_pk_bf16_f32 v20, v16, v17
    v_lshlrev_b32 v16, 16, v20
    v_and_b32 v17, 0xffff0000, v20
    v_pk_mul_f32 v[40:41], v[10:11], v[30:31]
    v_pk_mul_f32 v[42:43], v[12:13], v[30:31]
    v_pk_mul_f32 v[44:45], v[14:15], v[30:31]
    v_pk_mul_f32 v[46:47], v[16:17], v[30:31]
    v_exp_f32 v40, v40
    v_exp_f32 v41, v41
    v_exp_f32 v42, v42
    v_exp_f32 v43, v43
    v_exp_f32 v44, v44
    v_exp_f32 v45, v45
    v_exp_f32 v46, v46
    v_exp_f32 v47, v47
    v_pk_add_f32 v[40:41], v[40:41], v[32:33]
    v_pk_add_f32 v[42:43], v[42:43], v[32:33]
    v_pk_add_f32 v[44:45], v[44:45], v[32:33]
    v_pk_add_f32 v[46:47], v[46:47], v[32:33]
    v_rcp_f32 v40, v40
    v_rcp_f32 v41, v41
    v_rcp_f32 v42, v42
    v_rcp_f32 v43, v43
    v_rcp_f32 v44, v44
    v_rcp_f32 v45, v45
    v_rcp_f32 v46, v46
    v_rcp_f32 v47, v47
    v_pk_mul_f32 v[10:11], v[10:11], v[40:41]
    v_pk_mul_f32 v[12:13], v[12:13], v[42:43]
    v_pk_mul_f32 v[14:15], v[14:15], v[44:45]
    v_pk_mul_f32 v[16:17], v[16:17], v[46:47]
    v_cvt_pk_bf16_f32 v24, v10, v11
    v_cvt_pk_bf16_f32 v25, v12, v13
    v_cvt_pk_bf16_f32 v26, v14, v15
    v_cvt_pk_bf16_f32 v27, v16, v17
    v_add_u32 v5, 147584, v3
    global_store_dwordx4 v5, v[24:27], s[36:37]
    v_accvgpr_read_b32 v10, a100
    v_accvgpr_read_b32 v11, a101
    v_accvgpr_read_b32 v12, a102
    v_accvgpr_read_b32 v13, a103
    v_accvgpr_read_b32 v14, a116
    v_accvgpr_read_b32 v15, a117
    v_accvgpr_read_b32 v16, a118
    v_accvgpr_read_b32 v17, a119
    v_cvt_pk_bf16_f32 v20, v10, v11
    v_lshlrev_b32 v10, 16, v20
    v_and_b32 v11, 0xffff0000, v20
    v_cvt_pk_bf16_f32 v20, v12, v13
    v_lshlrev_b32 v12, 16, v20
    v_and_b32 v13, 0xffff0000, v20
    v_cvt_pk_bf16_f32 v20, v14, v15
    v_lshlrev_b32 v14, 16, v20
    v_and_b32 v15, 0xffff0000, v20
    v_cvt_pk_bf16_f32 v20, v16, v17
    v_lshlrev_b32 v16, 16, v20
    v_and_b32 v17, 0xffff0000, v20
    v_pk_mul_f32 v[40:41], v[10:11], v[30:31]
    v_pk_mul_f32 v[42:43], v[12:13], v[30:31]
    v_pk_mul_f32 v[44:45], v[14:15], v[30:31]
    v_pk_mul_f32 v[46:47], v[16:17], v[30:31]
    v_exp_f32 v40, v40
    v_exp_f32 v41, v41
    v_exp_f32 v42, v42
    v_exp_f32 v43, v43
    v_exp_f32 v44, v44
    v_exp_f32 v45, v45
    v_exp_f32 v46, v46
    v_exp_f32 v47, v47
    v_pk_add_f32 v[40:41], v[40:41], v[32:33]
    v_pk_add_f32 v[42:43], v[42:43], v[32:33]
    v_pk_add_f32 v[44:45], v[44:45], v[32:33]
    v_pk_add_f32 v[46:47], v[46:47], v[32:33]
    v_rcp_f32 v40, v40
    v_rcp_f32 v41, v41
    v_rcp_f32 v42, v42
    v_rcp_f32 v43, v43
    v_rcp_f32 v44, v44
    v_rcp_f32 v45, v45
    v_rcp_f32 v46, v46
    v_rcp_f32 v47, v47
    v_pk_mul_f32 v[10:11], v[10:11], v[40:41]
    v_pk_mul_f32 v[12:13], v[12:13], v[42:43]
    v_pk_mul_f32 v[14:15], v[14:15], v[44:45]
    v_pk_mul_f32 v[16:17], v[16:17], v[46:47]
    v_cvt_pk_bf16_f32 v24, v10, v11
    v_cvt_pk_bf16_f32 v25, v12, v13
    v_cvt_pk_bf16_f32 v26, v14, v15
    v_cvt_pk_bf16_f32 v27, v16, v17
    v_add_u32 v5, 147648, v3
    global_store_dwordx4 v5, v[24:27], s[36:37]
    v_accvgpr_read_b32 v10, a132
    v_accvgpr_read_b32 v11, a133
    v_accvgpr_read_b32 v12, a134
    v_accvgpr_read_b32 v13, a135
    v_cvt_pk_bf16_f32 v20, v10, v11
    v_lshlrev_b32 v10, 16, v20
    v_and_b32 v11, 0xffff0000, v20
    v_cvt_pk_bf16_f32 v20, v12, v13
    v_lshlrev_b32 v12, 16, v20
    v_and_b32 v13, 0xffff0000, v20
    v_pk_mul_f32 v[40:41], v[10:11], v[30:31]
    v_pk_mul_f32 v[42:43], v[12:13], v[30:31]
    v_exp_f32 v40, v40
    v_exp_f32 v41, v41
    v_exp_f32 v42, v42
    v_exp_f32 v43, v43
    v_pk_add_f32 v[40:41], v[40:41], v[32:33]
    v_pk_add_f32 v[42:43], v[42:43], v[32:33]
    v_rcp_f32 v40, v40
    v_rcp_f32 v41, v41
    v_rcp_f32 v42, v42
    v_rcp_f32 v43, v43
    v_pk_mul_f32 v[10:11], v[10:11], v[40:41]
    v_pk_mul_f32 v[12:13], v[12:13], v[42:43]
    v_cvt_pk_bf16_f32 v24, v10, v11
    v_cvt_pk_bf16_f32 v25, v12, v13
    v_add_u32 v5, 147712, v4
    global_store_dwordx2 v5, v[24:25], s[36:37]
    v_accvgpr_read_b32 v10, a8
    v_accvgpr_read_b32 v11, a9
    v_accvgpr_read_b32 v12, a10
    v_accvgpr_read_b32 v13, a11
    v_accvgpr_read_b32 v14, a24
    v_accvgpr_read_b32 v15, a25
    v_accvgpr_read_b32 v16, a26
    v_accvgpr_read_b32 v17, a27
    v_cvt_pk_bf16_f32 v20, v10, v11
    v_lshlrev_b32 v10, 16, v20
    v_and_b32 v11, 0xffff0000, v20
    v_cvt_pk_bf16_f32 v20, v12, v13
    v_lshlrev_b32 v12, 16, v20
    v_and_b32 v13, 0xffff0000, v20
    v_cvt_pk_bf16_f32 v20, v14, v15
    v_lshlrev_b32 v14, 16, v20
    v_and_b32 v15, 0xffff0000, v20
    v_cvt_pk_bf16_f32 v20, v16, v17
    v_lshlrev_b32 v16, 16, v20
    v_and_b32 v17, 0xffff0000, v20
    v_pk_mul_f32 v[40:41], v[10:11], v[30:31]
    v_pk_mul_f32 v[42:43], v[12:13], v[30:31]
    v_pk_mul_f32 v[44:45], v[14:15], v[30:31]
    v_pk_mul_f32 v[46:47], v[16:17], v[30:31]
    v_exp_f32 v40, v40
    v_exp_f32 v41, v41
    v_exp_f32 v42, v42
    v_exp_f32 v43, v43
    v_exp_f32 v44, v44
    v_exp_f32 v45, v45
    v_exp_f32 v46, v46
    v_exp_f32 v47, v47
    v_pk_add_f32 v[40:41], v[40:41], v[32:33]
    v_pk_add_f32 v[42:43], v[42:43], v[32:33]
    v_pk_add_f32 v[44:45], v[44:45], v[32:33]
    v_pk_add_f32 v[46:47], v[46:47], v[32:33]
    v_rcp_f32 v40, v40
    v_rcp_f32 v41, v41
    v_rcp_f32 v42, v42
    v_rcp_f32 v43, v43
    v_rcp_f32 v44, v44
    v_rcp_f32 v45, v45
    v_rcp_f32 v46, v46
    v_rcp_f32 v47, v47
    v_pk_mul_f32 v[10:11], v[10:11], v[40:41]
    v_pk_mul_f32 v[12:13], v[12:13], v[42:43]
    v_pk_mul_f32 v[14:15], v[14:15], v[44:45]
    v_pk_mul_f32 v[16:17], v[16:17], v[46:47]
    v_cvt_pk_bf16_f32 v24, v10, v11
    v_cvt_pk_bf16_f32 v25, v12, v13
    v_cvt_pk_bf16_f32 v26, v14, v15
    v_cvt_pk_bf16_f32 v27, v16, v17
    v_add_u32 v5, 294912, v3
    global_store_dwordx4 v5, v[24:27], s[36:37]
    v_accvgpr_read_b32 v10, a40
    v_accvgpr_read_b32 v11, a41
    v_accvgpr_read_b32 v12, a42
    v_accvgpr_read_b32 v13, a43
    v_accvgpr_read_b32 v14, a56
    v_accvgpr_read_b32 v15, a57
    v_accvgpr_read_b32 v16, a58
    v_accvgpr_read_b32 v17, a59
    v_cvt_pk_bf16_f32 v20, v10, v11
    v_lshlrev_b32 v10, 16, v20
    v_and_b32 v11, 0xffff0000, v20
    v_cvt_pk_bf16_f32 v20, v12, v13
    v_lshlrev_b32 v12, 16, v20
    v_and_b32 v13, 0xffff0000, v20
    v_cvt_pk_bf16_f32 v20, v14, v15
    v_lshlrev_b32 v14, 16, v20
    v_and_b32 v15, 0xffff0000, v20
    v_cvt_pk_bf16_f32 v20, v16, v17
    v_lshlrev_b32 v16, 16, v20
    v_and_b32 v17, 0xffff0000, v20
    v_pk_mul_f32 v[40:41], v[10:11], v[30:31]
    v_pk_mul_f32 v[42:43], v[12:13], v[30:31]
    v_pk_mul_f32 v[44:45], v[14:15], v[30:31]
    v_pk_mul_f32 v[46:47], v[16:17], v[30:31]
    v_exp_f32 v40, v40
    v_exp_f32 v41, v41
    v_exp_f32 v42, v42
    v_exp_f32 v43, v43
    v_exp_f32 v44, v44
    v_exp_f32 v45, v45
    v_exp_f32 v46, v46
    v_exp_f32 v47, v47
    v_pk_add_f32 v[40:41], v[40:41], v[32:33]
    v_pk_add_f32 v[42:43], v[42:43], v[32:33]
    v_pk_add_f32 v[44:45], v[44:45], v[32:33]
    v_pk_add_f32 v[46:47], v[46:47], v[32:33]
    v_rcp_f32 v40, v40
    v_rcp_f32 v41, v41
    v_rcp_f32 v42, v42
    v_rcp_f32 v43, v43
    v_rcp_f32 v44, v44
    v_rcp_f32 v45, v45
    v_rcp_f32 v46, v46
    v_rcp_f32 v47, v47
    v_pk_mul_f32 v[10:11], v[10:11], v[40:41]
    v_pk_mul_f32 v[12:13], v[12:13], v[42:43]
    v_pk_mul_f32 v[14:15], v[14:15], v[44:45]
    v_pk_mul_f32 v[16:17], v[16:17], v[46:47]
    v_cvt_pk_bf16_f32 v24, v10, v11
    v_cvt_pk_bf16_f32 v25, v12, v13
    v_cvt_pk_bf16_f32 v26, v14, v15
    v_cvt_pk_bf16_f32 v27, v16, v17
    v_add_u32 v5, 294976, v3
    global_store_dwordx4 v5, v[24:27], s[36:37]
    v_accvgpr_read_b32 v10, a72
    v_accvgpr_read_b32 v11, a73
    v_accvgpr_read_b32 v12, a74
    v_accvgpr_read_b32 v13, a75
    v_accvgpr_read_b32 v14, a88
    v_accvgpr_read_b32 v15, a89
    v_accvgpr_read_b32 v16, a90
    v_accvgpr_read_b32 v17, a91
    v_cvt_pk_bf16_f32 v20, v10, v11
    v_lshlrev_b32 v10, 16, v20
    v_and_b32 v11, 0xffff0000, v20
    v_cvt_pk_bf16_f32 v20, v12, v13
    v_lshlrev_b32 v12, 16, v20
    v_and_b32 v13, 0xffff0000, v20
    v_cvt_pk_bf16_f32 v20, v14, v15
    v_lshlrev_b32 v14, 16, v20
    v_and_b32 v15, 0xffff0000, v20
    v_cvt_pk_bf16_f32 v20, v16, v17
    v_lshlrev_b32 v16, 16, v20
    v_and_b32 v17, 0xffff0000, v20
    v_pk_mul_f32 v[40:41], v[10:11], v[30:31]
    v_pk_mul_f32 v[42:43], v[12:13], v[30:31]
    v_pk_mul_f32 v[44:45], v[14:15], v[30:31]
    v_pk_mul_f32 v[46:47], v[16:17], v[30:31]
    v_exp_f32 v40, v40
    v_exp_f32 v41, v41
    v_exp_f32 v42, v42
    v_exp_f32 v43, v43
    v_exp_f32 v44, v44
    v_exp_f32 v45, v45
    v_exp_f32 v46, v46
    v_exp_f32 v47, v47
    v_pk_add_f32 v[40:41], v[40:41], v[32:33]
    v_pk_add_f32 v[42:43], v[42:43], v[32:33]
    v_pk_add_f32 v[44:45], v[44:45], v[32:33]
    v_pk_add_f32 v[46:47], v[46:47], v[32:33]
    v_rcp_f32 v40, v40
    v_rcp_f32 v41, v41
    v_rcp_f32 v42, v42
    v_rcp_f32 v43, v43
    v_rcp_f32 v44, v44
    v_rcp_f32 v45, v45
    v_rcp_f32 v46, v46
    v_rcp_f32 v47, v47
    v_pk_mul_f32 v[10:11], v[10:11], v[40:41]
    v_pk_mul_f32 v[12:13], v[12:13], v[42:43]
    v_pk_mul_f32 v[14:15], v[14:15], v[44:45]
    v_pk_mul_f32 v[16:17], v[16:17], v[46:47]
    v_cvt_pk_bf16_f32 v24, v10, v11
    v_cvt_pk_bf16_f32 v25, v12, v13
    v_cvt_pk_bf16_f32 v26, v14, v15
    v_cvt_pk_bf16_f32 v27, v16, v17
    v_add_u32 v5, 295040, v3
    global_store_dwordx4 v5, v[24:27], s[36:37]
    v_accvgpr_read_b32 v10, a104
    v_accvgpr_read_b32 v11, a105
    v_accvgpr_read_b32 v12, a106
    v_accvgpr_read_b32 v13, a107
    v_accvgpr_read_b32 v14, a120
    v_accvgpr_read_b32 v15, a121
    v_accvgpr_read_b32 v16, a122
    v_accvgpr_read_b32 v17, a123
    v_cvt_pk_bf16_f32 v20, v10, v11
    v_lshlrev_b32 v10, 16, v20
    v_and_b32 v11, 0xffff0000, v20
    v_cvt_pk_bf16_f32 v20, v12, v13
    v_lshlrev_b32 v12, 16, v20
    v_and_b32 v13, 0xffff0000, v20
    v_cvt_pk_bf16_f32 v20, v14, v15
    v_lshlrev_b32 v14, 16, v20
    v_and_b32 v15, 0xffff0000, v20
    v_cvt_pk_bf16_f32 v20, v16, v17
    v_lshlrev_b32 v16, 16, v20
    v_and_b32 v17, 0xffff0000, v20
    v_pk_mul_f32 v[40:41], v[10:11], v[30:31]
    v_pk_mul_f32 v[42:43], v[12:13], v[30:31]
    v_pk_mul_f32 v[44:45], v[14:15], v[30:31]
    v_pk_mul_f32 v[46:47], v[16:17], v[30:31]
    v_exp_f32 v40, v40
    v_exp_f32 v41, v41
    v_exp_f32 v42, v42
    v_exp_f32 v43, v43
    v_exp_f32 v44, v44
    v_exp_f32 v45, v45
    v_exp_f32 v46, v46
    v_exp_f32 v47, v47
    v_pk_add_f32 v[40:41], v[40:41], v[32:33]
    v_pk_add_f32 v[42:43], v[42:43], v[32:33]
    v_pk_add_f32 v[44:45], v[44:45], v[32:33]
    v_pk_add_f32 v[46:47], v[46:47], v[32:33]
    v_rcp_f32 v40, v40
    v_rcp_f32 v41, v41
    v_rcp_f32 v42, v42
    v_rcp_f32 v43, v43
    v_rcp_f32 v44, v44
    v_rcp_f32 v45, v45
    v_rcp_f32 v46, v46
    v_rcp_f32 v47, v47
    v_pk_mul_f32 v[10:11], v[10:11], v[40:41]
    v_pk_mul_f32 v[12:13], v[12:13], v[42:43]
    v_pk_mul_f32 v[14:15], v[14:15], v[44:45]
    v_pk_mul_f32 v[16:17], v[16:17], v[46:47]
    v_cvt_pk_bf16_f32 v24, v10, v11
    v_cvt_pk_bf16_f32 v25, v12, v13
    v_cvt_pk_bf16_f32 v26, v14, v15
    v_cvt_pk_bf16_f32 v27, v16, v17
    v_add_u32 v5, 295104, v3
    global_store_dwordx4 v5, v[24:27], s[36:37]
    v_accvgpr_read_b32 v10, a136
    v_accvgpr_read_b32 v11, a137
    v_accvgpr_read_b32 v12, a138
    v_accvgpr_read_b32 v13, a139
    v_cvt_pk_bf16_f32 v20, v10, v11
    v_lshlrev_b32 v10, 16, v20
    v_and_b32 v11, 0xffff0000, v20
    v_cvt_pk_bf16_f32 v20, v12, v13
    v_lshlrev_b32 v12, 16, v20
    v_and_b32 v13, 0xffff0000, v20
    v_pk_mul_f32 v[40:41], v[10:11], v[30:31]
    v_pk_mul_f32 v[42:43], v[12:13], v[30:31]
    v_exp_f32 v40, v40
    v_exp_f32 v41, v41
    v_exp_f32 v42, v42
    v_exp_f32 v43, v43
    v_pk_add_f32 v[40:41], v[40:41], v[32:33]
    v_pk_add_f32 v[42:43], v[42:43], v[32:33]
    v_rcp_f32 v40, v40
    v_rcp_f32 v41, v41
    v_rcp_f32 v42, v42
    v_rcp_f32 v43, v43
    v_pk_mul_f32 v[10:11], v[10:11], v[40:41]
    v_pk_mul_f32 v[12:13], v[12:13], v[42:43]
    v_cvt_pk_bf16_f32 v24, v10, v11
    v_cvt_pk_bf16_f32 v25, v12, v13
    v_add_u32 v5, 295168, v4
    global_store_dwordx2 v5, v[24:25], s[36:37]
    v_accvgpr_read_b32 v10, a12
    v_accvgpr_read_b32 v11, a13
    v_accvgpr_read_b32 v12, a14
    v_accvgpr_read_b32 v13, a15
    v_accvgpr_read_b32 v14, a28
    v_accvgpr_read_b32 v15, a29
    v_accvgpr_read_b32 v16, a30
    v_accvgpr_read_b32 v17, a31
    v_cvt_pk_bf16_f32 v20, v10, v11
    v_lshlrev_b32 v10, 16, v20
    v_and_b32 v11, 0xffff0000, v20
    v_cvt_pk_bf16_f32 v20, v12, v13
    v_lshlrev_b32 v12, 16, v20
    v_and_b32 v13, 0xffff0000, v20
    v_cvt_pk_bf16_f32 v20, v14, v15
    v_lshlrev_b32 v14, 16, v20
    v_and_b32 v15, 0xffff0000, v20
    v_cvt_pk_bf16_f32 v20, v16, v17
    v_lshlrev_b32 v16, 16, v20
    v_and_b32 v17, 0xffff0000, v20
    v_pk_mul_f32 v[40:41], v[10:11], v[30:31]
    v_pk_mul_f32 v[42:43], v[12:13], v[30:31]
    v_pk_mul_f32 v[44:45], v[14:15], v[30:31]
    v_pk_mul_f32 v[46:47], v[16:17], v[30:31]
    v_exp_f32 v40, v40
    v_exp_f32 v41, v41
    v_exp_f32 v42, v42
    v_exp_f32 v43, v43
    v_exp_f32 v44, v44
    v_exp_f32 v45, v45
    v_exp_f32 v46, v46
    v_exp_f32 v47, v47
    v_pk_add_f32 v[40:41], v[40:41], v[32:33]
    v_pk_add_f32 v[42:43], v[42:43], v[32:33]
    v_pk_add_f32 v[44:45], v[44:45], v[32:33]
    v_pk_add_f32 v[46:47], v[46:47], v[32:33]
    v_rcp_f32 v40, v40
    v_rcp_f32 v41, v41
    v_rcp_f32 v42, v42
    v_rcp_f32 v43, v43
    v_rcp_f32 v44, v44
    v_rcp_f32 v45, v45
    v_rcp_f32 v46, v46
    v_rcp_f32 v47, v47
    v_pk_mul_f32 v[10:11], v[10:11], v[40:41]
    v_pk_mul_f32 v[12:13], v[12:13], v[42:43]
    v_pk_mul_f32 v[14:15], v[14:15], v[44:45]
    v_pk_mul_f32 v[16:17], v[16:17], v[46:47]
    v_cvt_pk_bf16_f32 v24, v10, v11
    v_cvt_pk_bf16_f32 v25, v12, v13
    v_cvt_pk_bf16_f32 v26, v14, v15
    v_cvt_pk_bf16_f32 v27, v16, v17
    v_add_u32 v5, 442368, v3
    global_store_dwordx4 v5, v[24:27], s[36:37]
    v_accvgpr_read_b32 v10, a44
    v_accvgpr_read_b32 v11, a45
    v_accvgpr_read_b32 v12, a46
    v_accvgpr_read_b32 v13, a47
    v_accvgpr_read_b32 v14, a60
    v_accvgpr_read_b32 v15, a61
    v_accvgpr_read_b32 v16, a62
    v_accvgpr_read_b32 v17, a63
    v_cvt_pk_bf16_f32 v20, v10, v11
    v_lshlrev_b32 v10, 16, v20
    v_and_b32 v11, 0xffff0000, v20
    v_cvt_pk_bf16_f32 v20, v12, v13
    v_lshlrev_b32 v12, 16, v20
    v_and_b32 v13, 0xffff0000, v20
    v_cvt_pk_bf16_f32 v20, v14, v15
    v_lshlrev_b32 v14, 16, v20
    v_and_b32 v15, 0xffff0000, v20
    v_cvt_pk_bf16_f32 v20, v16, v17
    v_lshlrev_b32 v16, 16, v20
    v_and_b32 v17, 0xffff0000, v20
    v_pk_mul_f32 v[40:41], v[10:11], v[30:31]
    v_pk_mul_f32 v[42:43], v[12:13], v[30:31]
    v_pk_mul_f32 v[44:45], v[14:15], v[30:31]
    v_pk_mul_f32 v[46:47], v[16:17], v[30:31]
    v_exp_f32 v40, v40
    v_exp_f32 v41, v41
    v_exp_f32 v42, v42
    v_exp_f32 v43, v43
    v_exp_f32 v44, v44
    v_exp_f32 v45, v45
    v_exp_f32 v46, v46
    v_exp_f32 v47, v47
    v_pk_add_f32 v[40:41], v[40:41], v[32:33]
    v_pk_add_f32 v[42:43], v[42:43], v[32:33]
    v_pk_add_f32 v[44:45], v[44:45], v[32:33]
    v_pk_add_f32 v[46:47], v[46:47], v[32:33]
    v_rcp_f32 v40, v40
    v_rcp_f32 v41, v41
    v_rcp_f32 v42, v42
    v_rcp_f32 v43, v43
    v_rcp_f32 v44, v44
    v_rcp_f32 v45, v45
    v_rcp_f32 v46, v46
    v_rcp_f32 v47, v47
    v_pk_mul_f32 v[10:11], v[10:11], v[40:41]
    v_pk_mul_f32 v[12:13], v[12:13], v[42:43]
    v_pk_mul_f32 v[14:15], v[14:15], v[44:45]
    v_pk_mul_f32 v[16:17], v[16:17], v[46:47]
    v_cvt_pk_bf16_f32 v24, v10, v11
    v_cvt_pk_bf16_f32 v25, v12, v13
    v_cvt_pk_bf16_f32 v26, v14, v15
    v_cvt_pk_bf16_f32 v27, v16, v17
    v_add_u32 v5, 442432, v3
    global_store_dwordx4 v5, v[24:27], s[36:37]
    v_accvgpr_read_b32 v10, a76
    v_accvgpr_read_b32 v11, a77
    v_accvgpr_read_b32 v12, a78
    v_accvgpr_read_b32 v13, a79
    v_accvgpr_read_b32 v14, a92
    v_accvgpr_read_b32 v15, a93
    v_accvgpr_read_b32 v16, a94
    v_accvgpr_read_b32 v17, a95
    v_cvt_pk_bf16_f32 v20, v10, v11
    v_lshlrev_b32 v10, 16, v20
    v_and_b32 v11, 0xffff0000, v20
    v_cvt_pk_bf16_f32 v20, v12, v13
    v_lshlrev_b32 v12, 16, v20
    v_and_b32 v13, 0xffff0000, v20
    v_cvt_pk_bf16_f32 v20, v14, v15
    v_lshlrev_b32 v14, 16, v20
    v_and_b32 v15, 0xffff0000, v20
    v_cvt_pk_bf16_f32 v20, v16, v17
    v_lshlrev_b32 v16, 16, v20
    v_and_b32 v17, 0xffff0000, v20
    v_pk_mul_f32 v[40:41], v[10:11], v[30:31]
    v_pk_mul_f32 v[42:43], v[12:13], v[30:31]
    v_pk_mul_f32 v[44:45], v[14:15], v[30:31]
    v_pk_mul_f32 v[46:47], v[16:17], v[30:31]
    v_exp_f32 v40, v40
    v_exp_f32 v41, v41
    v_exp_f32 v42, v42
    v_exp_f32 v43, v43
    v_exp_f32 v44, v44
    v_exp_f32 v45, v45
    v_exp_f32 v46, v46
    v_exp_f32 v47, v47
    v_pk_add_f32 v[40:41], v[40:41], v[32:33]
    v_pk_add_f32 v[42:43], v[42:43], v[32:33]
    v_pk_add_f32 v[44:45], v[44:45], v[32:33]
    v_pk_add_f32 v[46:47], v[46:47], v[32:33]
    v_rcp_f32 v40, v40
    v_rcp_f32 v41, v41
    v_rcp_f32 v42, v42
    v_rcp_f32 v43, v43
    v_rcp_f32 v44, v44
    v_rcp_f32 v45, v45
    v_rcp_f32 v46, v46
    v_rcp_f32 v47, v47
    v_pk_mul_f32 v[10:11], v[10:11], v[40:41]
    v_pk_mul_f32 v[12:13], v[12:13], v[42:43]
    v_pk_mul_f32 v[14:15], v[14:15], v[44:45]
    v_pk_mul_f32 v[16:17], v[16:17], v[46:47]
    v_cvt_pk_bf16_f32 v24, v10, v11
    v_cvt_pk_bf16_f32 v25, v12, v13
    v_cvt_pk_bf16_f32 v26, v14, v15
    v_cvt_pk_bf16_f32 v27, v16, v17
    v_add_u32 v5, 442496, v3
    global_store_dwordx4 v5, v[24:27], s[36:37]
    v_accvgpr_read_b32 v10, a108
    v_accvgpr_read_b32 v11, a109
    v_accvgpr_read_b32 v12, a110
    v_accvgpr_read_b32 v13, a111
    v_accvgpr_read_b32 v14, a124
    v_accvgpr_read_b32 v15, a125
    v_accvgpr_read_b32 v16, a126
    v_accvgpr_read_b32 v17, a127
    v_cvt_pk_bf16_f32 v20, v10, v11
    v_lshlrev_b32 v10, 16, v20
    v_and_b32 v11, 0xffff0000, v20
    v_cvt_pk_bf16_f32 v20, v12, v13
    v_lshlrev_b32 v12, 16, v20
    v_and_b32 v13, 0xffff0000, v20
    v_cvt_pk_bf16_f32 v20, v14, v15
    v_lshlrev_b32 v14, 16, v20
    v_and_b32 v15, 0xffff0000, v20
    v_cvt_pk_bf16_f32 v20, v16, v17
    v_lshlrev_b32 v16, 16, v20
    v_and_b32 v17, 0xffff0000, v20
    v_pk_mul_f32 v[40:41], v[10:11], v[30:31]
    v_pk_mul_f32 v[42:43], v[12:13], v[30:31]
    v_pk_mul_f32 v[44:45], v[14:15], v[30:31]
    v_pk_mul_f32 v[46:47], v[16:17], v[30:31]
    v_exp_f32 v40, v40
    v_exp_f32 v41, v41
    v_exp_f32 v42, v42
    v_exp_f32 v43, v43
    v_exp_f32 v44, v44
    v_exp_f32 v45, v45
    v_exp_f32 v46, v46
    v_exp_f32 v47, v47
    v_pk_add_f32 v[40:41], v[40:41], v[32:33]
    v_pk_add_f32 v[42:43], v[42:43], v[32:33]
    v_pk_add_f32 v[44:45], v[44:45], v[32:33]
    v_pk_add_f32 v[46:47], v[46:47], v[32:33]
    v_rcp_f32 v40, v40
    v_rcp_f32 v41, v41
    v_rcp_f32 v42, v42
    v_rcp_f32 v43, v43
    v_rcp_f32 v44, v44
    v_rcp_f32 v45, v45
    v_rcp_f32 v46, v46
    v_rcp_f32 v47, v47
    v_pk_mul_f32 v[10:11], v[10:11], v[40:41]
    v_pk_mul_f32 v[12:13], v[12:13], v[42:43]
    v_pk_mul_f32 v[14:15], v[14:15], v[44:45]
    v_pk_mul_f32 v[16:17], v[16:17], v[46:47]
    v_cvt_pk_bf16_f32 v24, v10, v11
    v_cvt_pk_bf16_f32 v25, v12, v13
    v_cvt_pk_bf16_f32 v26, v14, v15
    v_cvt_pk_bf16_f32 v27, v16, v17
    v_add_u32 v5, 442560, v3
    global_store_dwordx4 v5, v[24:27], s[36:37]
    v_accvgpr_read_b32 v10, a140
    v_accvgpr_read_b32 v11, a141
    v_accvgpr_read_b32 v12, a142
    v_accvgpr_read_b32 v13, a143
    v_cvt_pk_bf16_f32 v20, v10, v11
    v_lshlrev_b32 v10, 16, v20
    v_and_b32 v11, 0xffff0000, v20
    v_cvt_pk_bf16_f32 v20, v12, v13
    v_lshlrev_b32 v12, 16, v20
    v_and_b32 v13, 0xffff0000, v20
    v_pk_mul_f32 v[40:41], v[10:11], v[30:31]
    v_pk_mul_f32 v[42:43], v[12:13], v[30:31]
    v_exp_f32 v40, v40
    v_exp_f32 v41, v41
    v_exp_f32 v42, v42
    v_exp_f32 v43, v43
    v_pk_add_f32 v[40:41], v[40:41], v[32:33]
    v_pk_add_f32 v[42:43], v[42:43], v[32:33]
    v_rcp_f32 v40, v40
    v_rcp_f32 v41, v41
    v_rcp_f32 v42, v42
    v_rcp_f32 v43, v43
    v_pk_mul_f32 v[10:11], v[10:11], v[40:41]
    v_pk_mul_f32 v[12:13], v[12:13], v[42:43]
    v_cvt_pk_bf16_f32 v24, v10, v11
    v_cvt_pk_bf16_f32 v25, v12, v13
    v_add_u32 v5, 442624, v4
    global_store_dwordx2 v5, v[24:25], s[36:37]
    s_waitcnt vmcnt(0)
Lg1_end:
    s_endpgm
.globl k6_gemm2_kernel
.p2align 8
.type k6_gemm2_kernel,@function
k6_gemm2_kernel:
    s_cmp_ge_u32 s2, 256
    s_cbranch_scc1 Lg2_end
    s_load_dwordx2 s[16:17], s[0:1], 40
    s_load_dwordx2 s[18:19], s[0:1], 80
    v_and_b32 v104, 63, v0
    v_lshrrev_b32 v105, 6, v0
    s_nop 0
    v_readfirstlane_b32 s20, v105
    s_waitcnt lgkmcnt(0)
    s_and_b32 s23, s2, 3
    s_lshr_b32 s21, s2, 2
    s_and_b32 s21, s21, 3
    s_lshr_b32 s22, s2, 4
    s_mul_i32 s24, s22, 1179648
    s_mul_i32 s25, s23, 2304
    s_add_u32 s24, s24, s25
    s_add_u32 s4, s18, 20971520
    s_addc_u32 s5, s19, 0
    s_add_u32 s4, s4, s24
    s_addc_u32 s5, s5, 0
    s_and_b32 s5, s5, 0xffff
    s_sub_u32 s6, 18874368, s24
    s_mov_b32 s7, 0x00020000
    s_mul_i32 s25, s21, 288
    s_mul_i32 s26, s23, 1327104
    s_add_u32 s25, s25, s26
    s_add_u32 s8, s16, s25
    s_addc_u32 s9, s17, 0
    s_and_b32 s9, s9, 0xffff
    s_sub_u32 s10, 5308416, s25
    s_mov_b32 s11, 0x00020000
    s_mul_i32 s27, s20, 512
    v_add_u32 v0, s27, v104
    v_add_u32 v0, 0, v0
    v_lshrrev_b32 v1, 4, v0
    v_and_b32 v2, 15, v0
    v_and_b32 v3, 15, v1
    v_xor_b32 v2, v2, v3
    s_movk_i32 s28, 9216
    v_mul_lo_u32 v1, v1, s28
    v_lshl_add_u32 v106, v2, 4, v1
    s_mul_i32 s27, s20, 512
    v_add_u32 v0, s27, v104
    v_add_u32 v0, 64, v0
    v_lshrrev_b32 v1, 4, v0
    v_and_b32 v2, 15, v0
    v_and_b32 v3, 15, v1
    v_xor_b32 v2, v2, v3
    s_movk_i32 s28, 9216
    v_mul_lo_u32 v1, v1, s28
    v_lshl_add_u32 v107, v2, 4, v1
    s_mul_i32 s27, s20, 512
    v_add_u32 v0, s27, v104
    v_add_u32 v0, 128, v0
    v_lshrrev_b32 v1, 4, v0
    v_and_b32 v2, 15, v0
    v_and_b32 v3, 15, v1
    v_xor_b32 v2, v2, v3
    s_movk_i32 s28, 9216
    v_mul_lo_u32 v1, v1, s28
    v_lshl_add_u32 v108, v2, 4, v1
    s_mul_i32 s27, s20, 512
    v_add_u32 v0, s27, v104
    v_add_u32 v0, 192, v0
    v_lshrrev_b32 v1, 4, v0
    v_and_b32 v2, 15, v0
    v_and_b32 v3, 15, v1
    v_xor_b32 v2, v2, v3
    s_movk_i32 s28, 9216
    v_mul_lo_u32 v1, v1, s28
    v_lshl_add_u32 v109, v2, 4, v1
    s_mul_i32 s27, s20, 512
    v_add_u32 v0, s27, v104
    v_add_u32 v0, 256, v0
    v_lshrrev_b32 v1, 4, v0
    v_and_b32 v2, 15, v0
    v_and_b32 v3, 15, v1
    v_xor_b32 v2, v2, v3
    s_movk_i32 s28, 9216
    v_mul_lo_u32 v1, v1, s28
    v_lshl_add_u32 v110, v2, 4, v1
    s_mul_i32 s27, s20, 512
    v_add_u32 v0, s27, v104
    v_add_u32 v0, 320, v0
    v_lshrrev_b32 v1, 4, v0
    v_and_b32 v2, 15, v0
    v_and_b32 v3, 15, v1
    v_xor_b32 v2, v2, v3
    s_movk_i32 s28, 9216
    v_mul_lo_u32 v1, v1, s28
    v_lshl_add_u32 v111, v2, 4, v1
    s_mul_i32 s27, s20, 512
    v_add_u32 v0, s27, v104
    v_add_u32 v0, 384, v0
    v_lshrrev_b32 v1, 4, v0
    v_and_b32 v2, 15, v0
    v_and_b32 v3, 15, v1
    v_xor_b32 v2, v2, v3
    s_movk_i32 s28, 9216
    v_mul_lo_u32 v1, v1, s28
    v_lshl_add_u32 v112, v2, 4, v1
    s_mul_i32 s27, s20, 512
    v_add_u32 v0, s27, v104
    v_add_u32 v0, 448, v0
    v_lshrrev_b32 v1, 4, v0
    v_and_b32 v2, 15, v0
    v_and_b32 v3, 15, v1
    v_xor_b32 v2, v2, v3
    s_movk_i32 s28, 9216
    v_mul_lo_u32 v1, v1, s28
    v_lshl_add_u32 v113, v2, 4, v1
    s_mul_i32 s27, s20, 576
    v_add_u32 v0, s27, v104
    v_add_u32 v0, 0, v0
    v_mul_u32_u24 v1, 3641, v0
    v_lshrrev_b32 v1, 16, v1
    v_mul_u32_u24 v2, 18, v1
    v_sub_u32 v2, v0, v2
    s_mov_b32 s28, 1152
    v_mul_lo_u32 v1, v1, s28
    v_lshl_add_u32 v114, v2, 4, v1
    s_mul_i32 s27, s20, 576
    v_add_u32 v0, s27, v104
    v_add_u32 v0, 64, v0
    v_mul_u32_u24 v1, 3641, v0
    v_lshrrev_b32 v1, 16, v1
    v_mul_u32_u24 v2, 18, v1
    v_sub_u32 v2, v0, v2
    s_mov_b32 s28, 1152
    v_mul_lo_u32 v1, v1, s28
    v_lshl_add_u32 v115, v2, 4, v1
    s_mul_i32 s27, s20, 576
    v_add_u32 v0, s27, v104
    v_add_u32 v0, 128, v0
    v_mul_u32_u24 v1, 3641, v0
    v_lshrrev_b32 v1, 16, v1
    v_mul_u32_u24 v2, 18, v1
    v_sub_u32 v2, v0, v2
    s_mov_b32 s28, 1152
    v_mul_lo_u32 v1, v1, s28
    v_lshl_add_u32 v116, v2, 4, v1
    s_mul_i32 s27, s20, 576
    v_add_u32 v0, s27, v104
    v_add_u32 v0, 192, v0
    v_mul_u32_u24 v1, 3641, v0
    v_lshrrev_b32 v1, 16, v1
    v_mul_u32_u24 v2, 18, v1
    v_sub_u32 v2, v0, v2
    s_mov_b32 s28, 1152
    v_mul_lo_u32 v1, v1, s28
    v_lshl_add_u32 v117, v2, 4, v1
    s_mul_i32 s27, s20, 576
    v_add_u32 v0, s27, v104
    v_add_u32 v0, 256, v0
    v_mul_u32_u24 v1, 3641, v0
    v_lshrrev_b32 v1, 16, v1
    v_mul_u32_u24 v2, 18, v1
    v_sub_u32 v2, v0, v2
    s_mov_b32 s28, 1152
    v_mul_lo_u32 v1, v1, s28
    v_lshl_add_u32 v118, v2, 4, v1
    s_mul_i32 s27, s20, 576
    v_add_u32 v0, s27, v104
    v_add_u32 v0, 320, v0
    v_mul_u32_u24 v1, 3641, v0
    v_lshrrev_b32 v1, 16, v1
    v_mul_u32_u24 v2, 18, v1
    v_sub_u32 v2, v0, v2
    s_mov_b32 s28, 1152
    v_mul_lo_u32 v1, v1, s28
    v_lshl_add_u32 v119, v2, 4, v1
    s_mul_i32 s27, s20, 576
    v_add_u32 v0, s27, v104
    v_add_u32 v0, 384, v0
    v_mul_u32_u24 v1, 3641, v0
    v_lshrrev_b32 v1, 16, v1
    v_mul_u32_u24 v2, 18, v1
    v_sub_u32 v2, v0, v2
    s_mov_b32 s28, 1152
    v_mul_lo_u32 v1, v1, s28
    v_lshl_add_u32 v120, v2, 4, v1
    s_mul_i32 s27, s20, 576
    v_add_u32 v0, s27, v104
    v_add_u32 v0, 448, v0
    v_mul_u32_u24 v1, 3641, v0
    v_lshrrev_b32 v1, 16, v1
    v_mul_u32_u24 v2, 18, v1
    v_sub_u32 v2, v0, v2
    s_mov_b32 s28, 1152
    v_mul_lo_u32 v1, v1, s28
    v_lshl_add_u32 v121, v2, 4, v1
    s_mul_i32 s27, s20, 576
    v_add_u32 v0, s27, v104
    v_add_u32 v0, 512, v0
    v_mul_u32_u24 v1, 3641, v0
    v_lshrrev_b32 v1, 16, v1
    v_mul_u32_u24 v2, 18, v1
    v_sub_u32 v2, v0, v2
    s_mov_b32 s28, 1152
    v_mul_lo_u32 v1, v1, s28
    v_lshl_add_u32 v122, v2, 4, v1
    s_mul_i32 s29, s20, 8192
    s_mul_i32 s30, s20, 9216
    s_add_u32 s30, s30, 32768
    v_lshrrev_b32 v0, 4, v104
    v_and_b32 v1, 15, v104
    s_lshr_b32 s31, s20, 1
    s_and_b32 s32, s20, 1
    s_lshl_b32 s33, s31, 6
    v_add_u32 v2, s33, v1
    v_mul_u32_u24 v2, 256, v2
    v_and_b32 v3, 15, v1
    s_lshl_b32 s34, s32, 3
    s_add_u32 s34, s34, 0
    v_add_u32 v4, s34, v0
    v_xor_b32 v4, v4, v3
    v_lshl_add_u32 v123, v4, 4, v2
    v_lshl_add_u32 v124, v4, 4, v2
    v_add_u32 v124, 69632, v124
    s_lshl_b32 s34, s32, 3
    s_add_u32 s34, s34, 4
    v_add_u32 v4, s34, v0
    v_xor_b32 v4, v4, v3
    v_lshl_add_u32 v125, v4, 4, v2
    v_lshl_add_u32 v126, v4, 4, v2
    v_add_u32 v126, 69632, v126
    v_lshrrev_b32 v4, 2, v1
    v_lshl_add_u32 v4, v0, 3, v4
    s_lshl_b32 s34, s32, 6
    v_add_u32 v4, s34, v4
    v_mul_u32_u24 v4, 288, v4
    v_add_u32 v4, 32768, v4
    v_and_b32 v5, 3, v1
    v_lshl_add_u32 v127, v5, 4, v4
    v_lshl_add_u32 v128, v5, 3, v4
    v_add_u32 v128, 256, v128
    v_lshl_add_u32 v129, v5, 4, v4
    v_lshl_add_u32 v130, v5, 3, v4
    v_add_u32 v130, 256, v130
    v_add_u32 v129, 69632, v129
    v_add_u32 v130, 69632, v130
    s_mov_b32 s12, 0
    s_mov_b32 s13, 0
    s_add_u32 m0, s29, 0
    s_nop 0
    buffer_load_dwordx4 v106, s[4:7], s12 offen lds
    s_add_u32 m0, s29, 1024
    s_nop 0
    buffer_load_dwordx4 v107, s[4:7], s12 offen lds
    s_add_u32 m0, s29, 2048
    s_nop 0
    buffer_load_dwordx4 v108, s[4:7], s12 offen lds
    s_add_u32 m0, s29, 3072
    s_nop 0
    buffer_load_dwordx4 v109, s[4:7], s12 offen lds
    s_add_u32 m0, s29, 4096
    s_nop 0
    buffer_load_dwordx4 v110, s[4:7], s12 offen lds
    s_add_u32 m0, s29, 5120
    s_nop 0
    buffer_load_dwordx4 v111, s[4:7], s12 offen lds
    s_add_u32 m0, s29, 6144
    s_nop 0
    buffer_load_dwordx4 v112, s[4:7], s12 offen lds
    s_add_u32 m0, s29, 7168
    s_nop 0
    buffer_load_dwordx4 v113, s[4:7], s12 offen lds
    s_add_u32 m0, s30, 0
    s_nop 0
    buffer_load_dwordx4 v114, s[8:11], s13 offen lds
    s_add_u32 m0, s30, 1024
    s_nop 0
    buffer_load_dwordx4 v115, s[8:11], s13 offen lds
    s_add_u32 m0, s30, 2048
    s_nop 0
    buffer_load_dwordx4 v116, s[8:11], s13 offen lds
    s_add_u32 m0, s30, 3072
    s_nop 0
    buffer_load_dwordx4 v117, s[8:11], s13 offen lds
    s_add_u32 m0, s30, 4096
    s_nop 0
    buffer_load_dwordx4 v118, s[8:11], s13 offen lds
    s_add_u32 m0, s30, 5120
    s_nop 0
    buffer_load_dwordx4 v119, s[8:11], s13 offen lds
    s_add_u32 m0, s30, 6144
    s_nop 0
    buffer_load_dwordx4 v120, s[8:11], s13 offen lds
    s_add_u32 m0, s30, 7168
    s_nop 0
    buffer_load_dwordx4 v121, s[8:11], s13 offen lds
    s_add_u32 m0, s30, 8192
    s_nop 0
    buffer_load_dwordx4 v122, s[8:11], s13 offen lds
    s_add_u32 s12, s12, 256
    s_add_u32 s13, s13, 147456
    s_add_u32 m0, s29, 69632
    s_nop 0
    buffer_load_dwordx4 v106, s[4:7], s12 offen lds
    s_add_u32 m0, s29, 70656
    s_nop 0
    buffer_load_dwordx4 v107, s[4:7], s12 offen lds
    s_add_u32 m0, s29, 71680
    s_nop 0
    buffer_load_dwordx4 v108, s[4:7], s12 offen lds
    s_add_u32 m0, s29, 72704
    s_nop 0
    buffer_load_dwordx4 v109, s[4:7], s12 offen lds
    s_add_u32 m0, s29, 73728
    s_nop 0
    buffer_load_dwordx4 v110, s[4:7], s12 offen lds
    s_add_u32 m0, s29, 74752
    s_nop 0
    buffer_load_dwordx4 v111, s[4:7], s12 offen lds
    s_add_u32 m0, s29, 75776
    s_nop 0
    buffer_load_dwordx4 v112, s[4:7], s12 offen lds
    s_add_u32 m0, s29, 76800
    s_nop 0
    buffer_load_dwordx4 v113, s[4:7], s12 offen lds
    s_add_u32 m0, s30, 69632
    s_nop 0
    buffer_load_dwordx4 v114, s[8:11], s13 offen lds
    s_add_u32 m0, s30, 70656
    s_nop 0
    buffer_load_dwordx4 v115, s[8:11], s13 offen lds
    s_add_u32 m0, s30, 71680
    s_nop 0
    buffer_load_dwordx4 v116, s[8:11], s13 offen lds
    s_add_u32 m0, s30, 72704
    s_nop 0
    buffer_load_dwordx4 v117, s[8:11], s13 offen lds
    s_add_u32 m0, s30, 73728
    s_nop 0
    buffer_load_dwordx4 v118, s[8:11], s13 offen lds
    s_add_u32 m0, s30, 74752
    s_nop 0
    buffer_load_dwordx4 v119, s[8:11], s13 offen lds
    s_add_u32 m0, s30, 75776
    s_nop 0
    buffer_load_dwordx4 v120, s[8:11], s13 offen lds
    s_add_u32 m0, s30, 76800
    s_nop 0
    buffer_load_dwordx4 v121, s[8:11], s13 offen lds
    s_add_u32 m0, s30, 77824
    s_nop 0
    buffer_load_dwordx4 v122, s[8:11], s13 offen lds
    s_add_u32 s12, s12, 256
    s_add_u32 s13, s13, 147456
    s_waitcnt vmcnt(17)
    s_barrier
    ds_read_b128 v[72:75], v123 offset:0
    ds_read_b128 v[76:79], v123 offset:4096
    ds_read_b128 v[80:83], v123 offset:8192
    ds_read_b128 v[84:87], v123 offset:12288
    ds_read_b64_tr_b16 v[0:1], v127 offset:0
    ds_read_b64_tr_b16 v[2:3], v127 offset:1152
    ds_read_b64_tr_b16 v[4:5], v127 offset:8
    ds_read_b64_tr_b16 v[6:7], v127 offset:1160
    ds_read_b64_tr_b16 v[8:9], v127 offset:64
    ds_read_b64_tr_b16 v[10:11], v127 offset:1216
    ds_read_b64_tr_b16 v[12:13], v127 offset:72
    ds_read_b64_tr_b16 v[14:15], v127 offset:1224
    ds_read_b64_tr_b16 v[16:17], v127 offset:128
    ds_read_b64_tr_b16 v[18:19], v127 offset:1280
    ds_read_b64_tr_b16 v[20:21], v127 offset:136
    ds_read_b64_tr_b16 v[22:23], v127 offset:1288
    ds_read_b64_tr_b16 v[24:25], v127 offset:192
    ds_read_b64_tr_b16 v[26:27], v127 offset:1344
    ds_read_b64_tr_b16 v[28:29], v127 offset:200
    ds_read_b64_tr_b16 v[30:31], v127 offset:1352
    ds_read_b64_tr_b16 v[32:33], v128 offset:0
    ds_read_b64_tr_b16 v[34:35], v128 offset:1152
    s_waitcnt lgkmcnt(0)
    v_mfma_f32_16x16x32_bf16 a[0:3], v[0:3], v[72:75], 0
    ds_read_b128 v[88:91], v125 offset:0
    v_mfma_f32_16x16x32_bf16 a[4:7], v[0:3], v[76:79], 0
    ds_read_b128 v[92:95], v125 offset:4096
    v_mfma_f32_16x16x32_bf16 a[8:11], v[0:3], v[80:83], 0
    ds_read_b128 v[96:99], v125 offset:8192
    v_mfma_f32_16x16x32_bf16 a[12:15], v[0:3], v[84:87], 0
    ds_read_b128 v[100:103], v125 offset:12288
    v_mfma_f32_16x16x32_bf16 a[16:19], v[4:7], v[72:75], 0
    ds_read_b64_tr_b16 v[36:37], v127 offset:9216
    ds_read_b64_tr_b16 v[38:39], v127 offset:10368
    v_mfma_f32_16x16x32_bf16 a[20:23], v[4:7], v[76:79], 0
    ds_read_b64_tr_b16 v[40:41], v127 offset:9224
    v_mfma_f32_16x16x32_bf16 a[24:27], v[4:7], v[80:83], 0
    ds_read_b64_tr_b16 v[42:43], v127 offset:10376
    v_mfma_f32_16x16x32_bf16 a[28:31], v[4:7], v[84:87], 0
    ds_read_b64_tr_b16 v[44:45], v127 offset:9280
    v_mfma_f32_16x16x32_bf16 a[32:35], v[8:11], v[72:75], 0
    ds_read_b64_tr_b16 v[46:47], v127 offset:10432
    ds_read_b64_tr_b16 v[48:49], v127 offset:9288
    v_mfma_f32_16x16x32_bf16 a[36:39], v[8:11], v[76:79], 0
    ds_read_b64_tr_b16 v[50:51], v127 offset:10440
    v_mfma_f32_16x16x32_bf16 a[40:43], v[8:11], v[80:83], 0
    ds_read_b64_tr_b16 v[52:53], v127 offset:9344
    v_mfma_f32_16x16x32_bf16 a[44:47], v[8:11], v[84:87], 0
    ds_read_b64_tr_b16 v[54:55], v127 offset:10496
    v_mfma_f32_16x16x32_bf16 a[48:51], v[12:15], v[72:75], 0
    ds_read_b64_tr_b16 v[56:57], v127 offset:9352
    v_mfma_f32_16x16x32_bf16 a[52:55], v[12:15], v[76:79], 0
    ds_read_b64_tr_b16 v[58:59], v127 offset:10504
    ds_read_b64_tr_b16 v[60:61], v127 offset:9408
    v_mfma_f32_16x16x32_bf16 a[56:59], v[12:15], v[80:83], 0
    ds_read_b64_tr_b16 v[62:63], v127 offset:10560
    v_mfma_f32_16x16x32_bf16 a[60:63], v[12:15], v[84:87], 0
    ds_read_b64_tr_b16 v[64:65], v127 offset:9416
    v_mfma_f32_16x16x32_bf16 a[64:67], v[16:19], v[72:75], 0
    ds_read_b64_tr_b16 v[66:67], v127 offset:10568
    v_mfma_f32_16x16x32_bf16 a[68:71], v[16:19], v[76:79], 0
    ds_read_b64_tr_b16 v[68:69], v128 offset:9216
    ds_read_b64_tr_b16 v[70:71], v128 offset:10368
    v_mfma_f32_16x16x32_bf16 a[72:75], v[16:19], v[80:83], 0
    v_mfma_f32_16x16x32_bf16 a[76:79], v[16:19], v[84:87], 0
    v_mfma_f32_16x16x32_bf16 a[80:83], v[20:23], v[72:75], 0
    v_mfma_f32_16x16x32_bf16 a[84:87], v[20:23], v[76:79], 0
    v_mfma_f32_16x16x32_bf16 a[88:91], v[20:23], v[80:83], 0
    v_mfma_f32_16x16x32_bf16 a[92:95], v[20:23], v[84:87], 0
    v_mfma_f32_16x16x32_bf16 a[96:99], v[24:27], v[72:75], 0
    v_mfma_f32_16x16x32_bf16 a[100:103], v[24:27], v[76:79], 0
    v_mfma_f32_16x16x32_bf16 a[104:107], v[24:27], v[80:83], 0
    v_mfma_f32_16x16x32_bf16 a[108:111], v[24:27], v[84:87], 0
    v_mfma_f32_16x16x32_bf16 a[112:115], v[28:31], v[72:75], 0
    v_mfma_f32_16x16x32_bf16 a[116:119], v[28:31], v[76:79], 0
    v_mfma_f32_16x16x32_bf16 a[120:123], v[28:31], v[80:83], 0
    v_mfma_f32_16x16x32_bf16 a[124:127], v[28:31], v[84:87], 0
    v_mfma_f32_16x16x32_bf16 a[128:131], v[32:35], v[72:75], 0
    v_mfma_f32_16x16x32_bf16 a[132:135], v[32:35], v[76:79], 0
    v_mfma_f32_16x16x32_bf16 a[136:139], v[32:35], v[80:83], 0
    v_mfma_f32_16x16x32_bf16 a[140:143], v[32:35], v[84:87], 0
    s_waitcnt lgkmcnt(0)
    s_waitcnt vmcnt(0)
    s_barrier
    s_add_u32 m0, s29, 0
    s_nop 0
    buffer_load_dwordx4 v106, s[4:7], s12 offen lds
    s_add_u32 m0, s29, 1024
    s_nop 0
    buffer_load_dwordx4 v107, s[4:7], s12 offen lds
    s_add_u32 m0, s29, 2048
    s_nop 0
    buffer_load_dwordx4 v108, s[4:7], s12 offen lds
    s_add_u32 m0, s29, 3072
    s_nop 0
    buffer_load_dwordx4 v109, s[4:7], s12 offen lds
    s_add_u32 m0, s29, 4096
    s_nop 0
    buffer_load_dwordx4 v110, s[4:7], s12 offen lds
    s_add_u32 m0, s29, 5120
    s_nop 0
    buffer_load_dwordx4 v111, s[4:7], s12 offen lds
    s_add_u32 m0, s29, 6144
    s_nop 0
    buffer_load_dwordx4 v112, s[4:7], s12 offen lds
    s_add_u32 m0, s29, 7168
    s_nop 0
    buffer_load_dwordx4 v113, s[4:7], s12 offen lds
    s_add_u32 m0, s30, 0
    s_nop 0
    buffer_load_dwordx4 v114, s[8:11], s13 offen lds
    s_add_u32 m0, s30, 1024
    s_nop 0
    buffer_load_dwordx4 v115, s[8:11], s13 offen lds
    s_add_u32 m0, s30, 2048
    s_nop 0
    buffer_load_dwordx4 v116, s[8:11], s13 offen lds
    s_add_u32 m0, s30, 3072
    s_nop 0
    buffer_load_dwordx4 v117, s[8:11], s13 offen lds
    s_add_u32 m0, s30, 4096
    s_nop 0
    buffer_load_dwordx4 v118, s[8:11], s13 offen lds
    s_add_u32 m0, s30, 5120
    s_nop 0
    buffer_load_dwordx4 v119, s[8:11], s13 offen lds
    s_add_u32 m0, s30, 6144
    s_nop 0
    buffer_load_dwordx4 v120, s[8:11], s13 offen lds
    s_add_u32 m0, s30, 7168
    s_nop 0
    buffer_load_dwordx4 v121, s[8:11], s13 offen lds
    s_add_u32 m0, s30, 8192
    s_nop 0
    buffer_load_dwordx4 v122, s[8:11], s13 offen lds
    s_add_u32 s12, s12, 256
    s_add_u32 s13, s13, 147456
    v_mfma_f32_16x16x32_bf16 a[0:3], v[36:39], v[88:91], a[0:3]
    ds_read_b128 v[72:75], v124 offset:0
    v_mfma_f32_16x16x32_bf16 a[4:7], v[36:39], v[92:95], a[4:7]
    ds_read_b128 v[76:79], v124 offset:4096
    v_mfma_f32_16x16x32_bf16 a[8:11], v[36:39], v[96:99], a[8:11]
    ds_read_b128 v[80:83], v124 offset:8192
    v_mfma_f32_16x16x32_bf16 a[12:15], v[36:39], v[100:103], a[12:15]
    ds_read_b128 v[84:87], v124 offset:12288
    v_mfma_f32_16x16x32_bf16 a[16:19], v[40:43], v[88:91], a[16:19]
    ds_read_b64_tr_b16 v[0:1], v129 offset:0
    ds_read_b64_tr_b16 v[2:3], v129 offset:1152
    v_mfma_f32_16x16x32_bf16 a[20:23], v[40:43], v[92:95], a[20:23]
    ds_read_b64_tr_b16 v[4:5], v129 offset:8
    v_mfma_f32_16x16x32_bf16 a[24:27], v[40:43], v[96:99], a[24:27]
    ds_read_b64_tr_b16 v[6:7], v129 offset:1160
    v_mfma_f32_16x16x32_bf16 a[28:31], v[40:43], v[100:103], a[28:31]
    ds_read_b64_tr_b16 v[8:9], v129 offset:64
    v_mfma_f32_16x16x32_bf16 a[32:35], v[44:47], v[88:91], a[32:35]
    ds_read_b64_tr_b16 v[10:11], v129 offset:1216
    ds_read_b64_tr_b16 v[12:13], v129 offset:72
    v_mfma_f32_16x16x32_bf16 a[36:39], v[44:47], v[92:95], a[36:39]
    ds_read_b64_tr_b16 v[14:15], v129 offset:1224
    v_mfma_f32_16x16x32_bf16 a[40:43], v[44:47], v[96:99], a[40:43]
    ds_read_b64_tr_b16 v[16:17], v129 offset:128
    v_mfma_f32_16x16x32_bf16 a[44:47], v[44:47], v[100:103], a[44:47]
    ds_read_b64_tr_b16 v[18:19], v129 offset:1280
    v_mfma_f32_16x16x32_bf16 a[48:51], v[48:51], v[88:91], a[48:51]
    ds_read_b64_tr_b16 v[20:21], v129 offset:136
    v_mfma_f32_16x16x32_bf16 a[52:55], v[48:51], v[92:95], a[52:55]
    ds_read_b64_tr_b16 v[22:23], v129 offset:1288
    ds_read_b64_tr_b16 v[24:25], v129 offset:192
    v_mfma_f32_16x16x32_bf16 a[56:59], v[48:51], v[96:99], a[56:59]
    ds_read_b64_tr_b16 v[26:27], v129 offset:1344
    v_mfma_f32_16x16x32_bf16 a[60:63], v[48:51], v[100:103], a[60:63]
    ds_read_b64_tr_b16 v[28:29], v129 offset:200
    v_mfma_f32_16x16x32_bf16 a[64:67], v[52:55], v[88:91], a[64:67]
    ds_read_b64_tr_b16 v[30:31], v129 offset:1352
    v_mfma_f32_16x16x32_bf16 a[68:71], v[52:55], v[92:95], a[68:71]
    ds_read_b64_tr_b16 v[32:33], v130 offset:0
    ds_read_b64_tr_b16 v[34:35], v130 offset:1152
    v_mfma_f32_16x16x32_bf16 a[72:75], v[52:55], v[96:99], a[72:75]
    v_mfma_f32_16x16x32_bf16 a[76:79], v[52:55], v[100:103], a[76:79]
    v_mfma_f32_16x16x32_bf16 a[80:83], v[56:59], v[88:91], a[80:83]
    v_mfma_f32_16x16x32_bf16 a[84:87], v[56:59], v[92:95], a[84:87]
    v_mfma_f32_16x16x32_bf16 a[88:91], v[56:59], v[96:99], a[88:91]
    v_mfma_f32_16x16x32_bf16 a[92:95], v[56:59], v[100:103], a[92:95]
    v_mfma_f32_16x16x32_bf16 a[96:99], v[60:63], v[88:91], a[96:99]
    v_mfma_f32_16x16x32_bf16 a[100:103], v[60:63], v[92:95], a[100:103]
    v_mfma_f32_16x16x32_bf16 a[104:107], v[60:63], v[96:99], a[104:107]
    v_mfma_f32_16x16x32_bf16 a[108:111], v[60:63], v[100:103], a[108:111]
    v_mfma_f32_16x16x32_bf16 a[112:115], v[64:67], v[88:91], a[112:115]
    v_mfma_f32_16x16x32_bf16 a[116:119], v[64:67], v[92:95], a[116:119]
    v_mfma_f32_16x16x32_bf16 a[120:123], v[64:67], v[96:99], a[120:123]
    v_mfma_f32_16x16x32_bf16 a[124:127], v[64:67], v[100:103], a[124:127]
    v_mfma_f32_16x16x32_bf16 a[128:131], v[68:71], v[88:91], a[128:131]
    v_mfma_f32_16x16x32_bf16 a[132:135], v[68:71], v[92:95], a[132:135]
    v_mfma_f32_16x16x32_bf16 a[136:139], v[68:71], v[96:99], a[136:139]
    v_mfma_f32_16x16x32_bf16 a[140:143], v[68:71], v[100:103], a[140:143]
    s_waitcnt lgkmcnt(0)
    v_mfma_f32_16x16x32_bf16 a[0:3], v[0:3], v[72:75], a[0:3]
    ds_read_b128 v[88:91], v126 offset:0
    v_mfma_f32_16x16x32_bf16 a[4:7], v[0:3], v[76:79], a[4:7]
    ds_read_b128 v[92:95], v126 offset:4096
    v_mfma_f32_16x16x32_bf16 a[8:11], v[0:3], v[80:83], a[8:11]
    ds_read_b128 v[96:99], v126 offset:8192
    v_mfma_f32_16x16x32_bf16 a[12:15], v[0:3], v[84:87], a[12:15]
    ds_read_b128 v[100:103], v126 offset:12288
    v_mfma_f32_16x16x32_bf16 a[16:19], v[4:7], v[72:75], a[16:19]
    ds_read_b64_tr_b16 v[36:37], v129 offset:9216
    ds_read_b64_tr_b16 v[38:39], v129 offset:10368
    v_mfma_f32_16x16x32_bf16 a[20:23], v[4:7], v[76:79], a[20:23]
    ds_read_b64_tr_b16 v[40:41], v129 offset:9224
    v_mfma_f32_16x16x32_bf16 a[24:27], v[4:7], v[80:83], a[24:27]
    ds_read_b64_tr_b16 v[42:43], v129 offset:10376
    v_mfma_f32_16x16x32_bf16 a[28:31], v[4:7], v[84:87], a[28:31]
    ds_read_b64_tr_b16 v[44:45], v129 offset:9280
    v_mfma_f32_16x16x32_bf16 a[32:35], v[8:11], v[72:75], a[32:35]
    ds_read_b64_tr_b16 v[46:47], v129 offset:10432
    ds_read_b64_tr_b16 v[48:49], v129 offset:9288
    v_mfma_f32_16x16x32_bf16 a[36:39], v[8:11], v[76:79], a[36:39]
    ds_read_b64_tr_b16 v[50:51], v129 offset:10440
    v_mfma_f32_16x16x32_bf16 a[40:43], v[8:11], v[80:83], a[40:43]
    ds_read_b64_tr_b16 v[52:53], v129 offset:9344
    v_mfma_f32_16x16x32_bf16 a[44:47], v[8:11], v[84:87], a[44:47]
    ds_read_b64_tr_b16 v[54:55], v129 offset:10496
    v_mfma_f32_16x16x32_bf16 a[48:51], v[12:15], v[72:75], a[48:51]
    ds_read_b64_tr_b16 v[56:57], v129 offset:9352
    v_mfma_f32_16x16x32_bf16 a[52:55], v[12:15], v[76:79], a[52:55]
    ds_read_b64_tr_b16 v[58:59], v129 offset:10504
    ds_read_b64_tr_b16 v[60:61], v129 offset:9408
    v_mfma_f32_16x16x32_bf16 a[56:59], v[12:15], v[80:83], a[56:59]
    ds_read_b64_tr_b16 v[62:63], v129 offset:10560
    v_mfma_f32_16x16x32_bf16 a[60:63], v[12:15], v[84:87], a[60:63]
    ds_read_b64_tr_b16 v[64:65], v129 offset:9416
    v_mfma_f32_16x16x32_bf16 a[64:67], v[16:19], v[72:75], a[64:67]
    ds_read_b64_tr_b16 v[66:67], v129 offset:10568
    v_mfma_f32_16x16x32_bf16 a[68:71], v[16:19], v[76:79], a[68:71]
    ds_read_b64_tr_b16 v[68:69], v130 offset:9216
    ds_read_b64_tr_b16 v[70:71], v130 offset:10368
    v_mfma_f32_16x16x32_bf16 a[72:75], v[16:19], v[80:83], a[72:75]
    v_mfma_f32_16x16x32_bf16 a[76:79], v[16:19], v[84:87], a[76:79]
    v_mfma_f32_16x16x32_bf16 a[80:83], v[20:23], v[72:75], a[80:83]
    v_mfma_f32_16x16x32_bf16 a[84:87], v[20:23], v[76:79], a[84:87]
    v_mfma_f32_16x16x32_bf16 a[88:91], v[20:23], v[80:83], a[88:91]
    v_mfma_f32_16x16x32_bf16 a[92:95], v[20:23], v[84:87], a[92:95]
    v_mfma_f32_16x16x32_bf16 a[96:99], v[24:27], v[72:75], a[96:99]
    v_mfma_f32_16x16x32_bf16 a[100:103], v[24:27], v[76:79], a[100:103]
    v_mfma_f32_16x16x32_bf16 a[104:107], v[24:27], v[80:83], a[104:107]
    v_mfma_f32_16x16x32_bf16 a[108:111], v[24:27], v[84:87], a[108:111]
    v_mfma_f32_16x16x32_bf16 a[112:115], v[28:31], v[72:75], a[112:115]
    v_mfma_f32_16x16x32_bf16 a[116:119], v[28:31], v[76:79], a[116:119]
    v_mfma_f32_16x16x32_bf16 a[120:123], v[28:31], v[80:83], a[120:123]
    v_mfma_f32_16x16x32_bf16 a[124:127], v[28:31], v[84:87], a[124:127]
    v_mfma_f32_16x16x32_bf16 a[128:131], v[32:35], v[72:75], a[128:131]
    v_mfma_f32_16x16x32_bf16 a[132:135], v[32:35], v[76:79], a[132:135]
    v_mfma_f32_16x16x32_bf16 a[136:139], v[32:35], v[80:83], a[136:139]
    v_mfma_f32_16x16x32_bf16 a[140:143], v[32:35], v[84:87], a[140:143]
    s_waitcnt lgkmcnt(0)
    s_waitcnt vmcnt(0)
    s_barrier
    s_add_u32 m0, s29, 69632
    s_nop 0
    buffer_load_dwordx4 v106, s[4:7], s12 offen lds
    s_add_u32 m0, s29, 70656
    s_nop 0
    buffer_load_dwordx4 v107, s[4:7], s12 offen lds
    s_add_u32 m0, s29, 71680
    s_nop 0
    buffer_load_dwordx4 v108, s[4:7], s12 offen lds
    s_add_u32 m0, s29, 72704
    s_nop 0
    buffer_load_dwordx4 v109, s[4:7], s12 offen lds
    s_add_u32 m0, s29, 73728
    s_nop 0
    buffer_load_dwordx4 v110, s[4:7], s12 offen lds
    s_add_u32 m0, s29, 74752
    s_nop 0
    buffer_load_dwordx4 v111, s[4:7], s12 offen lds
    s_add_u32 m0, s29, 75776
    s_nop 0
    buffer_load_dwordx4 v112, s[4:7], s12 offen lds
    s_add_u32 m0, s29, 76800
    s_nop 0
    buffer_load_dwordx4 v113, s[4:7], s12 offen lds
    s_add_u32 m0, s30, 69632
    s_nop 0
    buffer_load_dwordx4 v114, s[8:11], s13 offen lds
    s_add_u32 m0, s30, 70656
    s_nop 0
    buffer_load_dwordx4 v115, s[8:11], s13 offen lds
    s_add_u32 m0, s30, 71680
    s_nop 0
    buffer_load_dwordx4 v116, s[8:11], s13 offen lds
    s_add_u32 m0, s30, 72704
    s_nop 0
    buffer_load_dwordx4 v117, s[8:11], s13 offen lds
    s_add_u32 m0, s30, 73728
    s_nop 0
    buffer_load_dwordx4 v118, s[8:11], s13 offen lds
    s_add_u32 m0, s30, 74752
    s_nop 0
    buffer_load_dwordx4 v119, s[8:11], s13 offen lds
    s_add_u32 m0, s30, 75776
    s_nop 0
    buffer_load_dwordx4 v120, s[8:11], s13 offen lds
    s_add_u32 m0, s30, 76800
    s_nop 0
    buffer_load_dwordx4 v121, s[8:11], s13 offen lds
    s_add_u32 m0, s30, 77824
    s_nop 0
    buffer_load_dwordx4 v122, s[8:11], s13 offen lds
    s_add_u32 s12, s12, 256
    s_add_u32 s13, s13, 147456
    v_mfma_f32_16x16x32_bf16 a[0:3], v[36:39], v[88:91], a[0:3]
    ds_read_b128 v[72:75], v123 offset:0
    v_mfma_f32_16x16x32_bf16 a[4:7], v[36:39], v[92:95], a[4:7]
    ds_read_b128 v[76:79], v123 offset:4096
    v_mfma_f32_16x16x32_bf16 a[8:11], v[36:39], v[96:99], a[8:11]
    ds_read_b128 v[80:83], v123 offset:8192
    v_mfma_f32_16x16x32_bf16 a[12:15], v[36:39], v[100:103], a[12:15]
    ds_read_b128 v[84:87], v123 offset:12288
    v_mfma_f32_16x16x32_bf16 a[16:19], v[40:43], v[88:91], a[16:19]
    ds_read_b64_tr_b16 v[0:1], v127 offset:0
    ds_read_b64_tr_b16 v[2:3], v127 offset:1152
    v_mfma_f32_16x16x32_bf16 a[20:23], v[40:43], v[92:95], a[20:23]
    ds_read_b64_tr_b16 v[4:5], v127 offset:8
    v_mfma_f32_16x16x32_bf16 a[24:27], v[40:43], v[96:99], a[24:27]
    ds_read_b64_tr_b16 v[6:7], v127 offset:1160
    v_mfma_f32_16x16x32_bf16 a[28:31], v[40:43], v[100:103], a[28:31]
    ds_read_b64_tr_b16 v[8:9], v127 offset:64
    v_mfma_f32_16x16x32_bf16 a[32:35], v[44:47], v[88:91], a[32:35]
    ds_read_b64_tr_b16 v[10:11], v127 offset:1216
    ds_read_b64_tr_b16 v[12:13], v127 offset:72
    v_mfma_f32_16x16x32_bf16 a[36:39], v[44:47], v[92:95], a[36:39]
    ds_read_b64_tr_b16 v[14:15], v127 offset:1224
    v_mfma_f32_16x16x32_bf16 a[40:43], v[44:47], v[96:99], a[40:43]
    ds_read_b64_tr_b16 v[16:17], v127 offset:128
    v_mfma_f32_16x16x32_bf16 a[44:47], v[44:47], v[100:103], a[44:47]
    ds_read_b64_tr_b16 v[18:19], v127 offset:1280
    v_mfma_f32_16x16x32_bf16 a[48:51], v[48:51], v[88:91], a[48:51]
    ds_read_b64_tr_b16 v[20:21], v127 offset:136
    v_mfma_f32_16x16x32_bf16 a[52:55], v[48:51], v[92:95], a[52:55]
    ds_read_b64_tr_b16 v[22:23], v127 offset:1288
    ds_read_b64_tr_b16 v[24:25], v127 offset:192
    v_mfma_f32_16x16x32_bf16 a[56:59], v[48:51], v[96:99], a[56:59]
    ds_read_b64_tr_b16 v[26:27], v127 offset:1344
    v_mfma_f32_16x16x32_bf16 a[60:63], v[48:51], v[100:103], a[60:63]
    ds_read_b64_tr_b16 v[28:29], v127 offset:200
    v_mfma_f32_16x16x32_bf16 a[64:67], v[52:55], v[88:91], a[64:67]
    ds_read_b64_tr_b16 v[30:31], v127 offset:1352
    v_mfma_f32_16x16x32_bf16 a[68:71], v[52:55], v[92:95], a[68:71]
    ds_read_b64_tr_b16 v[32:33], v128 offset:0
    ds_read_b64_tr_b16 v[34:35], v128 offset:1152
    v_mfma_f32_16x16x32_bf16 a[72:75], v[52:55], v[96:99], a[72:75]
    v_mfma_f32_16x16x32_bf16 a[76:79], v[52:55], v[100:103], a[76:79]
    v_mfma_f32_16x16x32_bf16 a[80:83], v[56:59], v[88:91], a[80:83]
    v_mfma_f32_16x16x32_bf16 a[84:87], v[56:59], v[92:95], a[84:87]
    v_mfma_f32_16x16x32_bf16 a[88:91], v[56:59], v[96:99], a[88:91]
    v_mfma_f32_16x16x32_bf16 a[92:95], v[56:59], v[100:103], a[92:95]
    v_mfma_f32_16x16x32_bf16 a[96:99], v[60:63], v[88:91], a[96:99]
    v_mfma_f32_16x16x32_bf16 a[100:103], v[60:63], v[92:95], a[100:103]
    v_mfma_f32_16x16x32_bf16 a[104:107], v[60:63], v[96:99], a[104:107]
    v_mfma_f32_16x16x32_bf16 a[108:111], v[60:63], v[100:103], a[108:111]
    v_mfma_f32_16x16x32_bf16 a[112:115], v[64:67], v[88:91], a[112:115]
    v_mfma_f32_16x16x32_bf16 a[116:119], v[64:67], v[92:95], a[116:119]
    v_mfma_f32_16x16x32_bf16 a[120:123], v[64:67], v[96:99], a[120:123]
    v_mfma_f32_16x16x32_bf16 a[124:127], v[64:67], v[100:103], a[124:127]
    v_mfma_f32_16x16x32_bf16 a[128:131], v[68:71], v[88:91], a[128:131]
    v_mfma_f32_16x16x32_bf16 a[132:135], v[68:71], v[92:95], a[132:135]
    v_mfma_f32_16x16x32_bf16 a[136:139], v[68:71], v[96:99], a[136:139]
    v_mfma_f32_16x16x32_bf16 a[140:143], v[68:71], v[100:103], a[140:143]
    s_waitcnt lgkmcnt(0)
    v_mfma_f32_16x16x32_bf16 a[0:3], v[0:3], v[72:75], a[0:3]
    ds_read_b128 v[88:91], v125 offset:0
    v_mfma_f32_16x16x32_bf16 a[4:7], v[0:3], v[76:79], a[4:7]
    ds_read_b128 v[92:95], v125 offset:4096
    v_mfma_f32_16x16x32_bf16 a[8:11], v[0:3], v[80:83], a[8:11]
    ds_read_b128 v[96:99], v125 offset:8192
    v_mfma_f32_16x16x32_bf16 a[12:15], v[0:3], v[84:87], a[12:15]
    ds_read_b128 v[100:103], v125 offset:12288
    v_mfma_f32_16x16x32_bf16 a[16:19], v[4:7], v[72:75], a[16:19]
    ds_read_b64_tr_b16 v[36:37], v127 offset:9216
    ds_read_b64_tr_b16 v[38:39], v127 offset:10368
    v_mfma_f32_16x16x32_bf16 a[20:23], v[4:7], v[76:79], a[20:23]
    ds_read_b64_tr_b16 v[40:41], v127 offset:9224
    v_mfma_f32_16x16x32_bf16 a[24:27], v[4:7], v[80:83], a[24:27]
    ds_read_b64_tr_b16 v[42:43], v127 offset:10376
    v_mfma_f32_16x16x32_bf16 a[28:31], v[4:7], v[84:87], a[28:31]
    ds_read_b64_tr_b16 v[44:45], v127 offset:9280
    v_mfma_f32_16x16x32_bf16 a[32:35], v[8:11], v[72:75], a[32:35]
    ds_read_b64_tr_b16 v[46:47], v127 offset:10432
    ds_read_b64_tr_b16 v[48:49], v127 offset:9288
    v_mfma_f32_16x16x32_bf16 a[36:39], v[8:11], v[76:79], a[36:39]
    ds_read_b64_tr_b16 v[50:51], v127 offset:10440
    v_mfma_f32_16x16x32_bf16 a[40:43], v[8:11], v[80:83], a[40:43]
    ds_read_b64_tr_b16 v[52:53], v127 offset:9344
    v_mfma_f32_16x16x32_bf16 a[44:47], v[8:11], v[84:87], a[44:47]
    ds_read_b64_tr_b16 v[54:55], v127 offset:10496
    v_mfma_f32_16x16x32_bf16 a[48:51], v[12:15], v[72:75], a[48:51]
    ds_read_b64_tr_b16 v[56:57], v127 offset:9352
    v_mfma_f32_16x16x32_bf16 a[52:55], v[12:15], v[76:79], a[52:55]
    ds_read_b64_tr_b16 v[58:59], v127 offset:10504
    ds_read_b64_tr_b16 v[60:61], v127 offset:9408
    v_mfma_f32_16x16x32_bf16 a[56:59], v[12:15], v[80:83], a[56:59]
    ds_read_b64_tr_b16 v[62:63], v127 offset:10560
    v_mfma_f32_16x16x32_bf16 a[60:63], v[12:15], v[84:87], a[60:63]
    ds_read_b64_tr_b16 v[64:65], v127 offset:9416
    v_mfma_f32_16x16x32_bf16 a[64:67], v[16:19], v[72:75], a[64:67]
    ds_read_b64_tr_b16 v[66:67], v127 offset:10568
    v_mfma_f32_16x16x32_bf16 a[68:71], v[16:19], v[76:79], a[68:71]
    ds_read_b64_tr_b16 v[68:69], v128 offset:9216
    ds_read_b64_tr_b16 v[70:71], v128 offset:10368
    v_mfma_f32_16x16x32_bf16 a[72:75], v[16:19], v[80:83], a[72:75]
    v_mfma_f32_16x16x32_bf16 a[76:79], v[16:19], v[84:87], a[76:79]
    v_mfma_f32_16x16x32_bf16 a[80:83], v[20:23], v[72:75], a[80:83]
    v_mfma_f32_16x16x32_bf16 a[84:87], v[20:23], v[76:79], a[84:87]
    v_mfma_f32_16x16x32_bf16 a[88:91], v[20:23], v[80:83], a[88:91]
    v_mfma_f32_16x16x32_bf16 a[92:95], v[20:23], v[84:87], a[92:95]
    v_mfma_f32_16x16x32_bf16 a[96:99], v[24:27], v[72:75], a[96:99]
    v_mfma_f32_16x16x32_bf16 a[100:103], v[24:27], v[76:79], a[100:103]
    v_mfma_f32_16x16x32_bf16 a[104:107], v[24:27], v[80:83], a[104:107]
    v_mfma_f32_16x16x32_bf16 a[108:111], v[24:27], v[84:87], a[108:111]
    v_mfma_f32_16x16x32_bf16 a[112:115], v[28:31], v[72:75], a[112:115]
    v_mfma_f32_16x16x32_bf16 a[116:119], v[28:31], v[76:79], a[116:119]
    v_mfma_f32_16x16x32_bf16 a[120:123], v[28:31], v[80:83], a[120:123]
    v_mfma_f32_16x16x32_bf16 a[124:127], v[28:31], v[84:87], a[124:127]
    v_mfma_f32_16x16x32_bf16 a[128:131], v[32:35], v[72:75], a[128:131]
    v_mfma_f32_16x16x32_bf16 a[132:135], v[32:35], v[76:79], a[132:135]
    v_mfma_f32_16x16x32_bf16 a[136:139], v[32:35], v[80:83], a[136:139]
    v_mfma_f32_16x16x32_bf16 a[140:143], v[32:35], v[84:87], a[140:143]
    s_waitcnt lgkmcnt(0)
    s_waitcnt vmcnt(0)
    s_barrier
    s_add_u32 m0, s29, 0
    s_nop 0
    buffer_load_dwordx4 v106, s[4:7], s12 offen lds
    s_add_u32 m0, s29, 1024
    s_nop 0
    buffer_load_dwordx4 v107, s[4:7], s12 offen lds
    s_add_u32 m0, s29, 2048
    s_nop 0
    buffer_load_dwordx4 v108, s[4:7], s12 offen lds
    s_add_u32 m0, s29, 3072
    s_nop 0
    buffer_load_dwordx4 v109, s[4:7], s12 offen lds
    s_add_u32 m0, s29, 4096
    s_nop 0
    buffer_load_dwordx4 v110, s[4:7], s12 offen lds
    s_add_u32 m0, s29, 5120
    s_nop 0
    buffer_load_dwordx4 v111, s[4:7], s12 offen lds
    s_add_u32 m0, s29, 6144
    s_nop 0
    buffer_load_dwordx4 v112, s[4:7], s12 offen lds
    s_add_u32 m0, s29, 7168
    s_nop 0
    buffer_load_dwordx4 v113, s[4:7], s12 offen lds
    s_add_u32 m0, s30, 0
    s_nop 0
    buffer_load_dwordx4 v114, s[8:11], s13 offen lds
    s_add_u32 m0, s30, 1024
    s_nop 0
    buffer_load_dwordx4 v115, s[8:11], s13 offen lds
    s_add_u32 m0, s30, 2048
    s_nop 0
    buffer_load_dwordx4 v116, s[8:11], s13 offen lds
    s_add_u32 m0, s30, 3072
    s_nop 0
    buffer_load_dwordx4 v117, s[8:11], s13 offen lds
    s_add_u32 m0, s30, 4096
    s_nop 0
    buffer_load_dwordx4 v118, s[8:11], s13 offen lds
    s_add_u32 m0, s30, 5120
    s_nop 0
    buffer_load_dwordx4 v119, s[8:11], s13 offen lds
    s_add_u32 m0, s30, 6144
    s_nop 0
    buffer_load_dwordx4 v120, s[8:11], s13 offen lds
    s_add_u32 m0, s30, 7168
    s_nop 0
    buffer_load_dwordx4 v121, s[8:11], s13 offen lds
    s_add_u32 m0, s30, 8192
    s_nop 0
    buffer_load_dwordx4 v122, s[8:11], s13 offen lds
    s_add_u32 s12, s12, 256
    s_add_u32 s13, s13, 147456
    v_mfma_f32_16x16x32_bf16 a[0:3], v[36:39], v[88:91], a[0:3]
    ds_read_b128 v[72:75], v124 offset:0
    v_mfma_f32_16x16x32_bf16 a[4:7], v[36:39], v[92:95], a[4:7]
    ds_read_b128 v[76:79], v124 offset:4096
    v_mfma_f32_16x16x32_bf16 a[8:11], v[36:39], v[96:99], a[8:11]
    ds_read_b128 v[80:83], v124 offset:8192
    v_mfma_f32_16x16x32_bf16 a[12:15], v[36:39], v[100:103], a[12:15]
    ds_read_b128 v[84:87], v124 offset:12288
    v_mfma_f32_16x16x32_bf16 a[16:19], v[40:43], v[88:91], a[16:19]
    ds_read_b64_tr_b16 v[0:1], v129 offset:0
    ds_read_b64_tr_b16 v[2:3], v129 offset:1152
    v_mfma_f32_16x16x32_bf16 a[20:23], v[40:43], v[92:95], a[20:23]
    ds_read_b64_tr_b16 v[4:5], v129 offset:8
    v_mfma_f32_16x16x32_bf16 a[24:27], v[40:43], v[96:99], a[24:27]
    ds_read_b64_tr_b16 v[6:7], v129 offset:1160
    v_mfma_f32_16x16x32_bf16 a[28:31], v[40:43], v[100:103], a[28:31]
    ds_read_b64_tr_b16 v[8:9], v129 offset:64
    v_mfma_f32_16x16x32_bf16 a[32:35], v[44:47], v[88:91], a[32:35]
    ds_read_b64_tr_b16 v[10:11], v129 offset:1216
    ds_read_b64_tr_b16 v[12:13], v129 offset:72
    v_mfma_f32_16x16x32_bf16 a[36:39], v[44:47], v[92:95], a[36:39]
    ds_read_b64_tr_b16 v[14:15], v129 offset:1224
    v_mfma_f32_16x16x32_bf16 a[40:43], v[44:47], v[96:99], a[40:43]
    ds_read_b64_tr_b16 v[16:17], v129 offset:128
    v_mfma_f32_16x16x32_bf16 a[44:47], v[44:47], v[100:103], a[44:47]
    ds_read_b64_tr_b16 v[18:19], v129 offset:1280
    v_mfma_f32_16x16x32_bf16 a[48:51], v[48:51], v[88:91], a[48:51]
    ds_read_b64_tr_b16 v[20:21], v129 offset:136
    v_mfma_f32_16x16x32_bf16 a[52:55], v[48:51], v[92:95], a[52:55]
    ds_read_b64_tr_b16 v[22:23], v129 offset:1288
    ds_read_b64_tr_b16 v[24:25], v129 offset:192
    v_mfma_f32_16x16x32_bf16 a[56:59], v[48:51], v[96:99], a[56:59]
    ds_read_b64_tr_b16 v[26:27], v129 offset:1344
    v_mfma_f32_16x16x32_bf16 a[60:63], v[48:51], v[100:103], a[60:63]
    ds_read_b64_tr_b16 v[28:29], v129 offset:200
    v_mfma_f32_16x16x32_bf16 a[64:67], v[52:55], v[88:91], a[64:67]
    ds_read_b64_tr_b16 v[30:31], v129 offset:1352
    v_mfma_f32_16x16x32_bf16 a[68:71], v[52:55], v[92:95], a[68:71]
    ds_read_b64_tr_b16 v[32:33], v130 offset:0
    ds_read_b64_tr_b16 v[34:35], v130 offset:1152
    v_mfma_f32_16x16x32_bf16 a[72:75], v[52:55], v[96:99], a[72:75]
    v_mfma_f32_16x16x32_bf16 a[76:79], v[52:55], v[100:103], a[76:79]
    v_mfma_f32_16x16x32_bf16 a[80:83], v[56:59], v[88:91], a[80:83]
    v_mfma_f32_16x16x32_bf16 a[84:87], v[56:59], v[92:95], a[84:87]
    v_mfma_f32_16x16x32_bf16 a[88:91], v[56:59], v[96:99], a[88:91]
    v_mfma_f32_16x16x32_bf16 a[92:95], v[56:59], v[100:103], a[92:95]
    v_mfma_f32_16x16x32_bf16 a[96:99], v[60:63], v[88:91], a[96:99]
    v_mfma_f32_16x16x32_bf16 a[100:103], v[60:63], v[92:95], a[100:103]
    v_mfma_f32_16x16x32_bf16 a[104:107], v[60:63], v[96:99], a[104:107]
    v_mfma_f32_16x16x32_bf16 a[108:111], v[60:63], v[100:103], a[108:111]
    v_mfma_f32_16x16x32_bf16 a[112:115], v[64:67], v[88:91], a[112:115]
    v_mfma_f32_16x16x32_bf16 a[116:119], v[64:67], v[92:95], a[116:119]
    v_mfma_f32_16x16x32_bf16 a[120:123], v[64:67], v[96:99], a[120:123]
    v_mfma_f32_16x16x32_bf16 a[124:127], v[64:67], v[100:103], a[124:127]
    v_mfma_f32_16x16x32_bf16 a[128:131], v[68:71], v[88:91], a[128:131]
    v_mfma_f32_16x16x32_bf16 a[132:135], v[68:71], v[92:95], a[132:135]
    v_mfma_f32_16x16x32_bf16 a[136:139], v[68:71], v[96:99], a[136:139]
    v_mfma_f32_16x16x32_bf16 a[140:143], v[68:71], v[100:103], a[140:143]
    s_waitcnt lgkmcnt(0)
    v_mfma_f32_16x16x32_bf16 a[0:3], v[0:3], v[72:75], a[0:3]
    ds_read_b128 v[88:91], v126 offset:0
    v_mfma_f32_16x16x32_bf16 a[4:7], v[0:3], v[76:79], a[4:7]
    ds_read_b128 v[92:95], v126 offset:4096
    v_mfma_f32_16x16x32_bf16 a[8:11], v[0:3], v[80:83], a[8:11]
    ds_read_b128 v[96:99], v126 offset:8192
    v_mfma_f32_16x16x32_bf16 a[12:15], v[0:3], v[84:87], a[12:15]
    ds_read_b128 v[100:103], v126 offset:12288
    v_mfma_f32_16x16x32_bf16 a[16:19], v[4:7], v[72:75], a[16:19]
    ds_read_b64_tr_b16 v[36:37], v129 offset:9216
    ds_read_b64_tr_b16 v[38:39], v129 offset:10368
    v_mfma_f32_16x16x32_bf16 a[20:23], v[4:7], v[76:79], a[20:23]
    ds_read_b64_tr_b16 v[40:41], v129 offset:9224
    v_mfma_f32_16x16x32_bf16 a[24:27], v[4:7], v[80:83], a[24:27]
    ds_read_b64_tr_b16 v[42:43], v129 offset:10376
    v_mfma_f32_16x16x32_bf16 a[28:31], v[4:7], v[84:87], a[28:31]
    ds_read_b64_tr_b16 v[44:45], v129 offset:9280
    v_mfma_f32_16x16x32_bf16 a[32:35], v[8:11], v[72:75], a[32:35]
    ds_read_b64_tr_b16 v[46:47], v129 offset:10432
    ds_read_b64_tr_b16 v[48:49], v129 offset:9288
    v_mfma_f32_16x16x32_bf16 a[36:39], v[8:11], v[76:79], a[36:39]
    ds_read_b64_tr_b16 v[50:51], v129 offset:10440
    v_mfma_f32_16x16x32_bf16 a[40:43], v[8:11], v[80:83], a[40:43]
    ds_read_b64_tr_b16 v[52:53], v129 offset:9344
    v_mfma_f32_16x16x32_bf16 a[44:47], v[8:11], v[84:87], a[44:47]
    ds_read_b64_tr_b16 v[54:55], v129 offset:10496
    v_mfma_f32_16x16x32_bf16 a[48:51], v[12:15], v[72:75], a[48:51]
    ds_read_b64_tr_b16 v[56:57], v129 offset:9352
    v_mfma_f32_16x16x32_bf16 a[52:55], v[12:15], v[76:79], a[52:55]
    ds_read_b64_tr_b16 v[58:59], v129 offset:10504
    ds_read_b64_tr_b16 v[60:61], v129 offset:9408
    v_mfma_f32_16x16x32_bf16 a[56:59], v[12:15], v[80:83], a[56:59]
    ds_read_b64_tr_b16 v[62:63], v129 offset:10560
    v_mfma_f32_16x16x32_bf16 a[60:63], v[12:15], v[84:87], a[60:63]
    ds_read_b64_tr_b16 v[64:65], v129 offset:9416
    v_mfma_f32_16x16x32_bf16 a[64:67], v[16:19], v[72:75], a[64:67]
    ds_read_b64_tr_b16 v[66:67], v129 offset:10568
    v_mfma_f32_16x16x32_bf16 a[68:71], v[16:19], v[76:79], a[68:71]
    ds_read_b64_tr_b16 v[68:69], v130 offset:9216
    ds_read_b64_tr_b16 v[70:71], v130 offset:10368
    v_mfma_f32_16x16x32_bf16 a[72:75], v[16:19], v[80:83], a[72:75]
    v_mfma_f32_16x16x32_bf16 a[76:79], v[16:19], v[84:87], a[76:79]
    v_mfma_f32_16x16x32_bf16 a[80:83], v[20:23], v[72:75], a[80:83]
    v_mfma_f32_16x16x32_bf16 a[84:87], v[20:23], v[76:79], a[84:87]
    v_mfma_f32_16x16x32_bf16 a[88:91], v[20:23], v[80:83], a[88:91]
    v_mfma_f32_16x16x32_bf16 a[92:95], v[20:23], v[84:87], a[92:95]
    v_mfma_f32_16x16x32_bf16 a[96:99], v[24:27], v[72:75], a[96:99]
    v_mfma_f32_16x16x32_bf16 a[100:103], v[24:27], v[76:79], a[100:103]
    v_mfma_f32_16x16x32_bf16 a[104:107], v[24:27], v[80:83], a[104:107]
    v_mfma_f32_16x16x32_bf16 a[108:111], v[24:27], v[84:87], a[108:111]
    v_mfma_f32_16x16x32_bf16 a[112:115], v[28:31], v[72:75], a[112:115]
    v_mfma_f32_16x16x32_bf16 a[116:119], v[28:31], v[76:79], a[116:119]
    v_mfma_f32_16x16x32_bf16 a[120:123], v[28:31], v[80:83], a[120:123]
    v_mfma_f32_16x16x32_bf16 a[124:127], v[28:31], v[84:87], a[124:127]
    v_mfma_f32_16x16x32_bf16 a[128:131], v[32:35], v[72:75], a[128:131]
    v_mfma_f32_16x16x32_bf16 a[132:135], v[32:35], v[76:79], a[132:135]
    v_mfma_f32_16x16x32_bf16 a[136:139], v[32:35], v[80:83], a[136:139]
    v_mfma_f32_16x16x32_bf16 a[140:143], v[32:35], v[84:87], a[140:143]
    s_waitcnt lgkmcnt(0)
    s_waitcnt vmcnt(0)
    s_barrier
    s_add_u32 m0, s29, 69632
    s_nop 0
    buffer_load_dwordx4 v106, s[4:7], s12 offen lds
    s_add_u32 m0, s29, 70656
    s_nop 0
    buffer_load_dwordx4 v107, s[4:7], s12 offen lds
    s_add_u32 m0, s29, 71680
    s_nop 0
    buffer_load_dwordx4 v108, s[4:7], s12 offen lds
    s_add_u32 m0, s29, 72704
    s_nop 0
    buffer_load_dwordx4 v109, s[4:7], s12 offen lds
    s_add_u32 m0, s29, 73728
    s_nop 0
    buffer_load_dwordx4 v110, s[4:7], s12 offen lds
    s_add_u32 m0, s29, 74752
    s_nop 0
    buffer_load_dwordx4 v111, s[4:7], s12 offen lds
    s_add_u32 m0, s29, 75776
    s_nop 0
    buffer_load_dwordx4 v112, s[4:7], s12 offen lds
    s_add_u32 m0, s29, 76800
    s_nop 0
    buffer_load_dwordx4 v113, s[4:7], s12 offen lds
    s_add_u32 m0, s30, 69632
    s_nop 0
    buffer_load_dwordx4 v114, s[8:11], s13 offen lds
    s_add_u32 m0, s30, 70656
    s_nop 0
    buffer_load_dwordx4 v115, s[8:11], s13 offen lds
    s_add_u32 m0, s30, 71680
    s_nop 0
    buffer_load_dwordx4 v116, s[8:11], s13 offen lds
    s_add_u32 m0, s30, 72704
    s_nop 0
    buffer_load_dwordx4 v117, s[8:11], s13 offen lds
    s_add_u32 m0, s30, 73728
    s_nop 0
    buffer_load_dwordx4 v118, s[8:11], s13 offen lds
    s_add_u32 m0, s30, 74752
    s_nop 0
    buffer_load_dwordx4 v119, s[8:11], s13 offen lds
    s_add_u32 m0, s30, 75776
    s_nop 0
    buffer_load_dwordx4 v120, s[8:11], s13 offen lds
    s_add_u32 m0, s30, 76800
    s_nop 0
    buffer_load_dwordx4 v121, s[8:11], s13 offen lds
    s_add_u32 m0, s30, 77824
    s_nop 0
    buffer_load_dwordx4 v122, s[8:11], s13 offen lds
    s_add_u32 s12, s12, 256
    s_add_u32 s13, s13, 147456
    v_mfma_f32_16x16x32_bf16 a[0:3], v[36:39], v[88:91], a[0:3]
    ds_read_b128 v[72:75], v123 offset:0
    v_mfma_f32_16x16x32_bf16 a[4:7], v[36:39], v[92:95], a[4:7]
    ds_read_b128 v[76:79], v123 offset:4096
    v_mfma_f32_16x16x32_bf16 a[8:11], v[36:39], v[96:99], a[8:11]
    ds_read_b128 v[80:83], v123 offset:8192
    v_mfma_f32_16x16x32_bf16 a[12:15], v[36:39], v[100:103], a[12:15]
    ds_read_b128 v[84:87], v123 offset:12288
    v_mfma_f32_16x16x32_bf16 a[16:19], v[40:43], v[88:91], a[16:19]
    ds_read_b64_tr_b16 v[0:1], v127 offset:0
    ds_read_b64_tr_b16 v[2:3], v127 offset:1152
    v_mfma_f32_16x16x32_bf16 a[20:23], v[40:43], v[92:95], a[20:23]
    ds_read_b64_tr_b16 v[4:5], v127 offset:8
    v_mfma_f32_16x16x32_bf16 a[24:27], v[40:43], v[96:99], a[24:27]
    ds_read_b64_tr_b16 v[6:7], v127 offset:1160
    v_mfma_f32_16x16x32_bf16 a[28:31], v[40:43], v[100:103], a[28:31]
    ds_read_b64_tr_b16 v[8:9], v127 offset:64
    v_mfma_f32_16x16x32_bf16 a[32:35], v[44:47], v[88:91], a[32:35]
    ds_read_b64_tr_b16 v[10:11], v127 offset:1216
    ds_read_b64_tr_b16 v[12:13], v127 offset:72
    v_mfma_f32_16x16x32_bf16 a[36:39], v[44:47], v[92:95], a[36:39]
    ds_read_b64_tr_b16 v[14:15], v127 offset:1224
    v_mfma_f32_16x16x32_bf16 a[40:43], v[44:47], v[96:99], a[40:43]
    ds_read_b64_tr_b16 v[16:17], v127 offset:128
    v_mfma_f32_16x16x32_bf16 a[44:47], v[44:47], v[100:103], a[44:47]
    ds_read_b64_tr_b16 v[18:19], v127 offset:1280
    v_mfma_f32_16x16x32_bf16 a[48:51], v[48:51], v[88:91], a[48:51]
    ds_read_b64_tr_b16 v[20:21], v127 offset:136
    v_mfma_f32_16x16x32_bf16 a[52:55], v[48:51], v[92:95], a[52:55]
    ds_read_b64_tr_b16 v[22:23], v127 offset:1288
    ds_read_b64_tr_b16 v[24:25], v127 offset:192
    v_mfma_f32_16x16x32_bf16 a[56:59], v[48:51], v[96:99], a[56:59]
    ds_read_b64_tr_b16 v[26:27], v127 offset:1344
    v_mfma_f32_16x16x32_bf16 a[60:63], v[48:51], v[100:103], a[60:63]
    ds_read_b64_tr_b16 v[28:29], v127 offset:200
    v_mfma_f32_16x16x32_bf16 a[64:67], v[52:55], v[88:91], a[64:67]
    ds_read_b64_tr_b16 v[30:31], v127 offset:1352
    v_mfma_f32_16x16x32_bf16 a[68:71], v[52:55], v[92:95], a[68:71]
    ds_read_b64_tr_b16 v[32:33], v128 offset:0
    ds_read_b64_tr_b16 v[34:35], v128 offset:1152
    v_mfma_f32_16x16x32_bf16 a[72:75], v[52:55], v[96:99], a[72:75]
    v_mfma_f32_16x16x32_bf16 a[76:79], v[52:55], v[100:103], a[76:79]
    v_mfma_f32_16x16x32_bf16 a[80:83], v[56:59], v[88:91], a[80:83]
    v_mfma_f32_16x16x32_bf16 a[84:87], v[56:59], v[92:95], a[84:87]
    v_mfma_f32_16x16x32_bf16 a[88:91], v[56:59], v[96:99], a[88:91]
    v_mfma_f32_16x16x32_bf16 a[92:95], v[56:59], v[100:103], a[92:95]
    v_mfma_f32_16x16x32_bf16 a[96:99], v[60:63], v[88:91], a[96:99]
    v_mfma_f32_16x16x32_bf16 a[100:103], v[60:63], v[92:95], a[100:103]
    v_mfma_f32_16x16x32_bf16 a[104:107], v[60:63], v[96:99], a[104:107]
    v_mfma_f32_16x16x32_bf16 a[108:111], v[60:63], v[100:103], a[108:111]
    v_mfma_f32_16x16x32_bf16 a[112:115], v[64:67], v[88:91], a[112:115]
    v_mfma_f32_16x16x32_bf16 a[116:119], v[64:67], v[92:95], a[116:119]
    v_mfma_f32_16x16x32_bf16 a[120:123], v[64:67], v[96:99], a[120:123]
    v_mfma_f32_16x16x32_bf16 a[124:127], v[64:67], v[100:103], a[124:127]
    v_mfma_f32_16x16x32_bf16 a[128:131], v[68:71], v[88:91], a[128:131]
    v_mfma_f32_16x16x32_bf16 a[132:135], v[68:71], v[92:95], a[132:135]
    v_mfma_f32_16x16x32_bf16 a[136:139], v[68:71], v[96:99], a[136:139]
    v_mfma_f32_16x16x32_bf16 a[140:143], v[68:71], v[100:103], a[140:143]
    s_waitcnt lgkmcnt(0)
    v_mfma_f32_16x16x32_bf16 a[0:3], v[0:3], v[72:75], a[0:3]
    ds_read_b128 v[88:91], v125 offset:0
    v_mfma_f32_16x16x32_bf16 a[4:7], v[0:3], v[76:79], a[4:7]
    ds_read_b128 v[92:95], v125 offset:4096
    v_mfma_f32_16x16x32_bf16 a[8:11], v[0:3], v[80:83], a[8:11]
    ds_read_b128 v[96:99], v125 offset:8192
    v_mfma_f32_16x16x32_bf16 a[12:15], v[0:3], v[84:87], a[12:15]
    ds_read_b128 v[100:103], v125 offset:12288
    v_mfma_f32_16x16x32_bf16 a[16:19], v[4:7], v[72:75], a[16:19]
    ds_read_b64_tr_b16 v[36:37], v127 offset:9216
    ds_read_b64_tr_b16 v[38:39], v127 offset:10368
    v_mfma_f32_16x16x32_bf16 a[20:23], v[4:7], v[76:79], a[20:23]
    ds_read_b64_tr_b16 v[40:41], v127 offset:9224
    v_mfma_f32_16x16x32_bf16 a[24:27], v[4:7], v[80:83], a[24:27]
    ds_read_b64_tr_b16 v[42:43], v127 offset:10376
    v_mfma_f32_16x16x32_bf16 a[28:31], v[4:7], v[84:87], a[28:31]
    ds_read_b64_tr_b16 v[44:45], v127 offset:9280
    v_mfma_f32_16x16x32_bf16 a[32:35], v[8:11], v[72:75], a[32:35]
    ds_read_b64_tr_b16 v[46:47], v127 offset:10432
    ds_read_b64_tr_b16 v[48:49], v127 offset:9288
    v_mfma_f32_16x16x32_bf16 a[36:39], v[8:11], v[76:79], a[36:39]
    ds_read_b64_tr_b16 v[50:51], v127 offset:10440
    v_mfma_f32_16x16x32_bf16 a[40:43], v[8:11], v[80:83], a[40:43]
    ds_read_b64_tr_b16 v[52:53], v127 offset:9344
    v_mfma_f32_16x16x32_bf16 a[44:47], v[8:11], v[84:87], a[44:47]
    ds_read_b64_tr_b16 v[54:55], v127 offset:10496
    v_mfma_f32_16x16x32_bf16 a[48:51], v[12:15], v[72:75], a[48:51]
    ds_read_b64_tr_b16 v[56:57], v127 offset:9352
    v_mfma_f32_16x16x32_bf16 a[52:55], v[12:15], v[76:79], a[52:55]
    ds_read_b64_tr_b16 v[58:59], v127 offset:10504
    ds_read_b64_tr_b16 v[60:61], v127 offset:9408
    v_mfma_f32_16x16x32_bf16 a[56:59], v[12:15], v[80:83], a[56:59]
    ds_read_b64_tr_b16 v[62:63], v127 offset:10560
    v_mfma_f32_16x16x32_bf16 a[60:63], v[12:15], v[84:87], a[60:63]
    ds_read_b64_tr_b16 v[64:65], v127 offset:9416
    v_mfma_f32_16x16x32_bf16 a[64:67], v[16:19], v[72:75], a[64:67]
    ds_read_b64_tr_b16 v[66:67], v127 offset:10568
    v_mfma_f32_16x16x32_bf16 a[68:71], v[16:19], v[76:79], a[68:71]
    ds_read_b64_tr_b16 v[68:69], v128 offset:9216
    ds_read_b64_tr_b16 v[70:71], v128 offset:10368
    v_mfma_f32_16x16x32_bf16 a[72:75], v[16:19], v[80:83], a[72:75]
    v_mfma_f32_16x16x32_bf16 a[76:79], v[16:19], v[84:87], a[76:79]
    v_mfma_f32_16x16x32_bf16 a[80:83], v[20:23], v[72:75], a[80:83]
    v_mfma_f32_16x16x32_bf16 a[84:87], v[20:23], v[76:79], a[84:87]
    v_mfma_f32_16x16x32_bf16 a[88:91], v[20:23], v[80:83], a[88:91]
    v_mfma_f32_16x16x32_bf16 a[92:95], v[20:23], v[84:87], a[92:95]
    v_mfma_f32_16x16x32_bf16 a[96:99], v[24:27], v[72:75], a[96:99]
    v_mfma_f32_16x16x32_bf16 a[100:103], v[24:27], v[76:79], a[100:103]
    v_mfma_f32_16x16x32_bf16 a[104:107], v[24:27], v[80:83], a[104:107]
    v_mfma_f32_16x16x32_bf16 a[108:111], v[24:27], v[84:87], a[108:111]
    v_mfma_f32_16x16x32_bf16 a[112:115], v[28:31], v[72:75], a[112:115]
    v_mfma_f32_16x16x32_bf16 a[116:119], v[28:31], v[76:79], a[116:119]
    v_mfma_f32_16x16x32_bf16 a[120:123], v[28:31], v[80:83], a[120:123]
    v_mfma_f32_16x16x32_bf16 a[124:127], v[28:31], v[84:87], a[124:127]
    v_mfma_f32_16x16x32_bf16 a[128:131], v[32:35], v[72:75], a[128:131]
    v_mfma_f32_16x16x32_bf16 a[132:135], v[32:35], v[76:79], a[132:135]
    v_mfma_f32_16x16x32_bf16 a[136:139], v[32:35], v[80:83], a[136:139]
    v_mfma_f32_16x16x32_bf16 a[140:143], v[32:35], v[84:87], a[140:143]
    s_waitcnt lgkmcnt(0)
    s_waitcnt vmcnt(0)
    s_barrier
    s_add_u32 m0, s29, 0
    s_nop 0
    buffer_load_dwordx4 v106, s[4:7], s12 offen lds
    s_add_u32 m0, s29, 1024
    s_nop 0
    buffer_load_dwordx4 v107, s[4:7], s12 offen lds
    s_add_u32 m0, s29, 2048
    s_nop 0
    buffer_load_dwordx4 v108, s[4:7], s12 offen lds
    s_add_u32 m0, s29, 3072
    s_nop 0
    buffer_load_dwordx4 v109, s[4:7], s12 offen lds
    s_add_u32 m0, s29, 4096
    s_nop 0
    buffer_load_dwordx4 v110, s[4:7], s12 offen lds
    s_add_u32 m0, s29, 5120
    s_nop 0
    buffer_load_dwordx4 v111, s[4:7], s12 offen lds
    s_add_u32 m0, s29, 6144
    s_nop 0
    buffer_load_dwordx4 v112, s[4:7], s12 offen lds
    s_add_u32 m0, s29, 7168
    s_nop 0
    buffer_load_dwordx4 v113, s[4:7], s12 offen lds
    s_add_u32 m0, s30, 0
    s_nop 0
    buffer_load_dwordx4 v114, s[8:11], s13 offen lds
    s_add_u32 m0, s30, 1024
    s_nop 0
    buffer_load_dwordx4 v115, s[8:11], s13 offen lds
    s_add_u32 m0, s30, 2048
    s_nop 0
    buffer_load_dwordx4 v116, s[8:11], s13 offen lds
    s_add_u32 m0, s30, 3072
    s_nop 0
    buffer_load_dwordx4 v117, s[8:11], s13 offen lds
    s_add_u32 m0, s30, 4096
    s_nop 0
    buffer_load_dwordx4 v118, s[8:11], s13 offen lds
    s_add_u32 m0, s30, 5120
    s_nop 0
    buffer_load_dwordx4 v119, s[8:11], s13 offen lds
    s_add_u32 m0, s30, 6144
    s_nop 0
    buffer_load_dwordx4 v120, s[8:11], s13 offen lds
    s_add_u32 m0, s30, 7168
    s_nop 0
    buffer_load_dwordx4 v121, s[8:11], s13 offen lds
    s_add_u32 m0, s30, 8192
    s_nop 0
    buffer_load_dwordx4 v122, s[8:11], s13 offen lds
    s_add_u32 s12, s12, 256
    s_add_u32 s13, s13, 147456
    v_mfma_f32_16x16x32_bf16 a[0:3], v[36:39], v[88:91], a[0:3]
    ds_read_b128 v[72:75], v124 offset:0
    v_mfma_f32_16x16x32_bf16 a[4:7], v[36:39], v[92:95], a[4:7]
    ds_read_b128 v[76:79], v124 offset:4096
    v_mfma_f32_16x16x32_bf16 a[8:11], v[36:39], v[96:99], a[8:11]
    ds_read_b128 v[80:83], v124 offset:8192
    v_mfma_f32_16x16x32_bf16 a[12:15], v[36:39], v[100:103], a[12:15]
    ds_read_b128 v[84:87], v124 offset:12288
    v_mfma_f32_16x16x32_bf16 a[16:19], v[40:43], v[88:91], a[16:19]
    ds_read_b64_tr_b16 v[0:1], v129 offset:0
    ds_read_b64_tr_b16 v[2:3], v129 offset:1152
    v_mfma_f32_16x16x32_bf16 a[20:23], v[40:43], v[92:95], a[20:23]
    ds_read_b64_tr_b16 v[4:5], v129 offset:8
    v_mfma_f32_16x16x32_bf16 a[24:27], v[40:43], v[96:99], a[24:27]
    ds_read_b64_tr_b16 v[6:7], v129 offset:1160
    v_mfma_f32_16x16x32_bf16 a[28:31], v[40:43], v[100:103], a[28:31]
    ds_read_b64_tr_b16 v[8:9], v129 offset:64
    v_mfma_f32_16x16x32_bf16 a[32:35], v[44:47], v[88:91], a[32:35]
    ds_read_b64_tr_b16 v[10:11], v129 offset:1216
    ds_read_b64_tr_b16 v[12:13], v129 offset:72
    v_mfma_f32_16x16x32_bf16 a[36:39], v[44:47], v[92:95], a[36:39]
    ds_read_b64_tr_b16 v[14:15], v129 offset:1224
    v_mfma_f32_16x16x32_bf16 a[40:43], v[44:47], v[96:99], a[40:43]
    ds_read_b64_tr_b16 v[16:17], v129 offset:128
    v_mfma_f32_16x16x32_bf16 a[44:47], v[44:47], v[100:103], a[44:47]
    ds_read_b64_tr_b16 v[18:19], v129 offset:1280
    v_mfma_f32_16x16x32_bf16 a[48:51], v[48:51], v[88:91], a[48:51]
    ds_read_b64_tr_b16 v[20:21], v129 offset:136
    v_mfma_f32_16x16x32_bf16 a[52:55], v[48:51], v[92:95], a[52:55]
    ds_read_b64_tr_b16 v[22:23], v129 offset:1288
    ds_read_b64_tr_b16 v[24:25], v129 offset:192
    v_mfma_f32_16x16x32_bf16 a[56:59], v[48:51], v[96:99], a[56:59]
    ds_read_b64_tr_b16 v[26:27], v129 offset:1344
    v_mfma_f32_16x16x32_bf16 a[60:63], v[48:51], v[100:103], a[60:63]
    ds_read_b64_tr_b16 v[28:29], v129 offset:200
    v_mfma_f32_16x16x32_bf16 a[64:67], v[52:55], v[88:91], a[64:67]
    ds_read_b64_tr_b16 v[30:31], v129 offset:1352
    v_mfma_f32_16x16x32_bf16 a[68:71], v[52:55], v[92:95], a[68:71]
    ds_read_b64_tr_b16 v[32:33], v130 offset:0
    ds_read_b64_tr_b16 v[34:35], v130 offset:1152
    v_mfma_f32_16x16x32_bf16 a[72:75], v[52:55], v[96:99], a[72:75]
    v_mfma_f32_16x16x32_bf16 a[76:79], v[52:55], v[100:103], a[76:79]
    v_mfma_f32_16x16x32_bf16 a[80:83], v[56:59], v[88:91], a[80:83]
    v_mfma_f32_16x16x32_bf16 a[84:87], v[56:59], v[92:95], a[84:87]
    v_mfma_f32_16x16x32_bf16 a[88:91], v[56:59], v[96:99], a[88:91]
    v_mfma_f32_16x16x32_bf16 a[92:95], v[56:59], v[100:103], a[92:95]
    v_mfma_f32_16x16x32_bf16 a[96:99], v[60:63], v[88:91], a[96:99]
    v_mfma_f32_16x16x32_bf16 a[100:103], v[60:63], v[92:95], a[100:103]
    v_mfma_f32_16x16x32_bf16 a[104:107], v[60:63], v[96:99], a[104:107]
    v_mfma_f32_16x16x32_bf16 a[108:111], v[60:63], v[100:103], a[108:111]
    v_mfma_f32_16x16x32_bf16 a[112:115], v[64:67], v[88:91], a[112:115]
    v_mfma_f32_16x16x32_bf16 a[116:119], v[64:67], v[92:95], a[116:119]
    v_mfma_f32_16x16x32_bf16 a[120:123], v[64:67], v[96:99], a[120:123]
    v_mfma_f32_16x16x32_bf16 a[124:127], v[64:67], v[100:103], a[124:127]
    v_mfma_f32_16x16x32_bf16 a[128:131], v[68:71], v[88:91], a[128:131]
    v_mfma_f32_16x16x32_bf16 a[132:135], v[68:71], v[92:95], a[132:135]
    v_mfma_f32_16x16x32_bf16 a[136:139], v[68:71], v[96:99], a[136:139]
    v_mfma_f32_16x16x32_bf16 a[140:143], v[68:71], v[100:103], a[140:143]
    s_waitcnt lgkmcnt(0)
    v_mfma_f32_16x16x32_bf16 a[0:3], v[0:3], v[72:75], a[0:3]
    ds_read_b128 v[88:91], v126 offset:0
    v_mfma_f32_16x16x32_bf16 a[4:7], v[0:3], v[76:79], a[4:7]
    ds_read_b128 v[92:95], v126 offset:4096
    v_mfma_f32_16x16x32_bf16 a[8:11], v[0:3], v[80:83], a[8:11]
    ds_read_b128 v[96:99], v126 offset:8192
    v_mfma_f32_16x16x32_bf16 a[12:15], v[0:3], v[84:87], a[12:15]
    ds_read_b128 v[100:103], v126 offset:12288
    v_mfma_f32_16x16x32_bf16 a[16:19], v[4:7], v[72:75], a[16:19]
    ds_read_b64_tr_b16 v[36:37], v129 offset:9216
    ds_read_b64_tr_b16 v[38:39], v129 offset:10368
    v_mfma_f32_16x16x32_bf16 a[20:23], v[4:7], v[76:79], a[20:23]
    ds_read_b64_tr_b16 v[40:41], v129 offset:9224
    v_mfma_f32_16x16x32_bf16 a[24:27], v[4:7], v[80:83], a[24:27]
    ds_read_b64_tr_b16 v[42:43], v129 offset:10376
    v_mfma_f32_16x16x32_bf16 a[28:31], v[4:7], v[84:87], a[28:31]
    ds_read_b64_tr_b16 v[44:45], v129 offset:9280
    v_mfma_f32_16x16x32_bf16 a[32:35], v[8:11], v[72:75], a[32:35]
    ds_read_b64_tr_b16 v[46:47], v129 offset:10432
    ds_read_b64_tr_b16 v[48:49], v129 offset:9288
    v_mfma_f32_16x16x32_bf16 a[36:39], v[8:11], v[76:79], a[36:39]
    ds_read_b64_tr_b16 v[50:51], v129 offset:10440
    v_mfma_f32_16x16x32_bf16 a[40:43], v[8:11], v[80:83], a[40:43]
    ds_read_b64_tr_b16 v[52:53], v129 offset:9344
    v_mfma_f32_16x16x32_bf16 a[44:47], v[8:11], v[84:87], a[44:47]
    ds_read_b64_tr_b16 v[54:55], v129 offset:10496
    v_mfma_f32_16x16x32_bf16 a[48:51], v[12:15], v[72:75], a[48:51]
    ds_read_b64_tr_b16 v[56:57], v129 offset:9352
    v_mfma_f32_16x16x32_bf16 a[52:55], v[12:15], v[76:79], a[52:55]
    ds_read_b64_tr_b16 v[58:59], v129 offset:10504
    ds_read_b64_tr_b16 v[60:61], v129 offset:9408
    v_mfma_f32_16x16x32_bf16 a[56:59], v[12:15], v[80:83], a[56:59]
    ds_read_b64_tr_b16 v[62:63], v129 offset:10560
    v_mfma_f32_16x16x32_bf16 a[60:63], v[12:15], v[84:87], a[60:63]
    ds_read_b64_tr_b16 v[64:65], v129 offset:9416
    v_mfma_f32_16x16x32_bf16 a[64:67], v[16:19], v[72:75], a[64:67]
    ds_read_b64_tr_b16 v[66:67], v129 offset:10568
    v_mfma_f32_16x16x32_bf16 a[68:71], v[16:19], v[76:79], a[68:71]
    ds_read_b64_tr_b16 v[68:69], v130 offset:9216
    ds_read_b64_tr_b16 v[70:71], v130 offset:10368
    v_mfma_f32_16x16x32_bf16 a[72:75], v[16:19], v[80:83], a[72:75]
    v_mfma_f32_16x16x32_bf16 a[76:79], v[16:19], v[84:87], a[76:79]
    v_mfma_f32_16x16x32_bf16 a[80:83], v[20:23], v[72:75], a[80:83]
    v_mfma_f32_16x16x32_bf16 a[84:87], v[20:23], v[76:79], a[84:87]
    v_mfma_f32_16x16x32_bf16 a[88:91], v[20:23], v[80:83], a[88:91]
    v_mfma_f32_16x16x32_bf16 a[92:95], v[20:23], v[84:87], a[92:95]
    v_mfma_f32_16x16x32_bf16 a[96:99], v[24:27], v[72:75], a[96:99]
    v_mfma_f32_16x16x32_bf16 a[100:103], v[24:27], v[76:79], a[100:103]
    v_mfma_f32_16x16x32_bf16 a[104:107], v[24:27], v[80:83], a[104:107]
    v_mfma_f32_16x16x32_bf16 a[108:111], v[24:27], v[84:87], a[108:111]
    v_mfma_f32_16x16x32_bf16 a[112:115], v[28:31], v[72:75], a[112:115]
    v_mfma_f32_16x16x32_bf16 a[116:119], v[28:31], v[76:79], a[116:119]
    v_mfma_f32_16x16x32_bf16 a[120:123], v[28:31], v[80:83], a[120:123]
    v_mfma_f32_16x16x32_bf16 a[124:127], v[28:31], v[84:87], a[124:127]
    v_mfma_f32_16x16x32_bf16 a[128:131], v[32:35], v[72:75], a[128:131]
    v_mfma_f32_16x16x32_bf16 a[132:135], v[32:35], v[76:79], a[132:135]
    v_mfma_f32_16x16x32_bf16 a[136:139], v[32:35], v[80:83], a[136:139]
    v_mfma_f32_16x16x32_bf16 a[140:143], v[32:35], v[84:87], a[140:143]
    s_waitcnt lgkmcnt(0)
    s_waitcnt vmcnt(0)
    s_barrier
    s_add_u32 m0, s29, 69632
    s_nop 0
    buffer_load_dwordx4 v106, s[4:7], s12 offen lds
    s_add_u32 m0, s29, 70656
    s_nop 0
    buffer_load_dwordx4 v107, s[4:7], s12 offen lds
    s_add_u32 m0, s29, 71680
    s_nop 0
    buffer_load_dwordx4 v108, s[4:7], s12 offen lds
    s_add_u32 m0, s29, 72704
    s_nop 0
    buffer_load_dwordx4 v109, s[4:7], s12 offen lds
    s_add_u32 m0, s29, 73728
    s_nop 0
    buffer_load_dwordx4 v110, s[4:7], s12 offen lds
    s_add_u32 m0, s29, 74752
    s_nop 0
    buffer_load_dwordx4 v111, s[4:7], s12 offen lds
    s_add_u32 m0, s29, 75776
    s_nop 0
    buffer_load_dwordx4 v112, s[4:7], s12 offen lds
    s_add_u32 m0, s29, 76800
    s_nop 0
    buffer_load_dwordx4 v113, s[4:7], s12 offen lds
    s_add_u32 m0, s30, 69632
    s_nop 0
    buffer_load_dwordx4 v114, s[8:11], s13 offen lds
    s_add_u32 m0, s30, 70656
    s_nop 0
    buffer_load_dwordx4 v115, s[8:11], s13 offen lds
    s_add_u32 m0, s30, 71680
    s_nop 0
    buffer_load_dwordx4 v116, s[8:11], s13 offen lds
    s_add_u32 m0, s30, 72704
    s_nop 0
    buffer_load_dwordx4 v117, s[8:11], s13 offen lds
    s_add_u32 m0, s30, 73728
    s_nop 0
    buffer_load_dwordx4 v118, s[8:11], s13 offen lds
    s_add_u32 m0, s30, 74752
    s_nop 0
    buffer_load_dwordx4 v119, s[8:11], s13 offen lds
    s_add_u32 m0, s30, 75776
    s_nop 0
    buffer_load_dwordx4 v120, s[8:11], s13 offen lds
    s_add_u32 m0, s30, 76800
    s_nop 0
    buffer_load_dwordx4 v121, s[8:11], s13 offen lds
    s_add_u32 m0, s30, 77824
    s_nop 0
    buffer_load_dwordx4 v122, s[8:11], s13 offen lds
    s_add_u32 s12, s12, 256
    s_add_u32 s13, s13, 147456
    v_mfma_f32_16x16x32_bf16 a[0:3], v[36:39], v[88:91], a[0:3]
    ds_read_b128 v[72:75], v123 offset:0
    v_mfma_f32_16x16x32_bf16 a[4:7], v[36:39], v[92:95], a[4:7]
    ds_read_b128 v[76:79], v123 offset:4096
    v_mfma_f32_16x16x32_bf16 a[8:11], v[36:39], v[96:99], a[8:11]
    ds_read_b128 v[80:83], v123 offset:8192
    v_mfma_f32_16x16x32_bf16 a[12:15], v[36:39], v[100:103], a[12:15]
    ds_read_b128 v[84:87], v123 offset:12288
    v_mfma_f32_16x16x32_bf16 a[16:19], v[40:43], v[88:91], a[16:19]
    ds_read_b64_tr_b16 v[0:1], v127 offset:0
    ds_read_b64_tr_b16 v[2:3], v127 offset:1152
    v_mfma_f32_16x16x32_bf16 a[20:23], v[40:43], v[92:95], a[20:23]
    ds_read_b64_tr_b16 v[4:5], v127 offset:8
    v_mfma_f32_16x16x32_bf16 a[24:27], v[40:43], v[96:99], a[24:27]
    ds_read_b64_tr_b16 v[6:7], v127 offset:1160
    v_mfma_f32_16x16x32_bf16 a[28:31], v[40:43], v[100:103], a[28:31]
    ds_read_b64_tr_b16 v[8:9], v127 offset:64
    v_mfma_f32_16x16x32_bf16 a[32:35], v[44:47], v[88:91], a[32:35]
    ds_read_b64_tr_b16 v[10:11], v127 offset:1216
    ds_read_b64_tr_b16 v[12:13], v127 offset:72
    v_mfma_f32_16x16x32_bf16 a[36:39], v[44:47], v[92:95], a[36:39]
    ds_read_b64_tr_b16 v[14:15], v127 offset:1224
    v_mfma_f32_16x16x32_bf16 a[40:43], v[44:47], v[96:99], a[40:43]
    ds_read_b64_tr_b16 v[16:17], v127 offset:128
    v_mfma_f32_16x16x32_bf16 a[44:47], v[44:47], v[100:103], a[44:47]
    ds_read_b64_tr_b16 v[18:19], v127 offset:1280
    v_mfma_f32_16x16x32_bf16 a[48:51], v[48:51], v[88:91], a[48:51]
    ds_read_b64_tr_b16 v[20:21], v127 offset:136
    v_mfma_f32_16x16x32_bf16 a[52:55], v[48:51], v[92:95], a[52:55]
    ds_read_b64_tr_b16 v[22:23], v127 offset:1288
    ds_read_b64_tr_b16 v[24:25], v127 offset:192
    v_mfma_f32_16x16x32_bf16 a[56:59], v[48:51], v[96:99], a[56:59]
    ds_read_b64_tr_b16 v[26:27], v127 offset:1344
    v_mfma_f32_16x16x32_bf16 a[60:63], v[48:51], v[100:103], a[60:63]
    ds_read_b64_tr_b16 v[28:29], v127 offset:200
    v_mfma_f32_16x16x32_bf16 a[64:67], v[52:55], v[88:91], a[64:67]
    ds_read_b64_tr_b16 v[30:31], v127 offset:1352
    v_mfma_f32_16x16x32_bf16 a[68:71], v[52:55], v[92:95], a[68:71]
    ds_read_b64_tr_b16 v[32:33], v128 offset:0
    ds_read_b64_tr_b16 v[34:35], v128 offset:1152
    v_mfma_f32_16x16x32_bf16 a[72:75], v[52:55], v[96:99], a[72:75]
    v_mfma_f32_16x16x32_bf16 a[76:79], v[52:55], v[100:103], a[76:79]
    v_mfma_f32_16x16x32_bf16 a[80:83], v[56:59], v[88:91], a[80:83]
    v_mfma_f32_16x16x32_bf16 a[84:87], v[56:59], v[92:95], a[84:87]
    v_mfma_f32_16x16x32_bf16 a[88:91], v[56:59], v[96:99], a[88:91]
    v_mfma_f32_16x16x32_bf16 a[92:95], v[56:59], v[100:103], a[92:95]
    v_mfma_f32_16x16x32_bf16 a[96:99], v[60:63], v[88:91], a[96:99]
    v_mfma_f32_16x16x32_bf16 a[100:103], v[60:63], v[92:95], a[100:103]
    v_mfma_f32_16x16x32_bf16 a[104:107], v[60:63], v[96:99], a[104:107]
    v_mfma_f32_16x16x32_bf16 a[108:111], v[60:63], v[100:103], a[108:111]
    v_mfma_f32_16x16x32_bf16 a[112:115], v[64:67], v[88:91], a[112:115]
    v_mfma_f32_16x16x32_bf16 a[116:119], v[64:67], v[92:95], a[116:119]
    v_mfma_f32_16x16x32_bf16 a[120:123], v[64:67], v[96:99], a[120:123]
    v_mfma_f32_16x16x32_bf16 a[124:127], v[64:67], v[100:103], a[124:127]
    v_mfma_f32_16x16x32_bf16 a[128:131], v[68:71], v[88:91], a[128:131]
    v_mfma_f32_16x16x32_bf16 a[132:135], v[68:71], v[92:95], a[132:135]
    v_mfma_f32_16x16x32_bf16 a[136:139], v[68:71], v[96:99], a[136:139]
    v_mfma_f32_16x16x32_bf16 a[140:143], v[68:71], v[100:103], a[140:143]
    s_waitcnt lgkmcnt(0)
    v_mfma_f32_16x16x32_bf16 a[0:3], v[0:3], v[72:75], a[0:3]
    ds_read_b128 v[88:91], v125 offset:0
    v_mfma_f32_16x16x32_bf16 a[4:7], v[0:3], v[76:79], a[4:7]
    ds_read_b128 v[92:95], v125 offset:4096
    v_mfma_f32_16x16x32_bf16 a[8:11], v[0:3], v[80:83], a[8:11]
    ds_read_b128 v[96:99], v125 offset:8192
    v_mfma_f32_16x16x32_bf16 a[12:15], v[0:3], v[84:87], a[12:15]
    ds_read_b128 v[100:103], v125 offset:12288
    v_mfma_f32_16x16x32_bf16 a[16:19], v[4:7], v[72:75], a[16:19]
    ds_read_b64_tr_b16 v[36:37], v127 offset:9216
    ds_read_b64_tr_b16 v[38:39], v127 offset:10368
    v_mfma_f32_16x16x32_bf16 a[20:23], v[4:7], v[76:79], a[20:23]
    ds_read_b64_tr_b16 v[40:41], v127 offset:9224
    v_mfma_f32_16x16x32_bf16 a[24:27], v[4:7], v[80:83], a[24:27]
    ds_read_b64_tr_b16 v[42:43], v127 offset:10376
    v_mfma_f32_16x16x32_bf16 a[28:31], v[4:7], v[84:87], a[28:31]
    ds_read_b64_tr_b16 v[44:45], v127 offset:9280
    v_mfma_f32_16x16x32_bf16 a[32:35], v[8:11], v[72:75], a[32:35]
    ds_read_b64_tr_b16 v[46:47], v127 offset:10432
    ds_read_b64_tr_b16 v[48:49], v127 offset:9288
    v_mfma_f32_16x16x32_bf16 a[36:39], v[8:11], v[76:79], a[36:39]
    ds_read_b64_tr_b16 v[50:51], v127 offset:10440
    v_mfma_f32_16x16x32_bf16 a[40:43], v[8:11], v[80:83], a[40:43]
    ds_read_b64_tr_b16 v[52:53], v127 offset:9344
    v_mfma_f32_16x16x32_bf16 a[44:47], v[8:11], v[84:87], a[44:47]
    ds_read_b64_tr_b16 v[54:55], v127 offset:10496
    v_mfma_f32_16x16x32_bf16 a[48:51], v[12:15], v[72:75], a[48:51]
    ds_read_b64_tr_b16 v[56:57], v127 offset:9352
    v_mfma_f32_16x16x32_bf16 a[52:55], v[12:15], v[76:79], a[52:55]
    ds_read_b64_tr_b16 v[58:59], v127 offset:10504
    ds_read_b64_tr_b16 v[60:61], v127 offset:9408
    v_mfma_f32_16x16x32_bf16 a[56:59], v[12:15], v[80:83], a[56:59]
    ds_read_b64_tr_b16 v[62:63], v127 offset:10560
    v_mfma_f32_16x16x32_bf16 a[60:63], v[12:15], v[84:87], a[60:63]
    ds_read_b64_tr_b16 v[64:65], v127 offset:9416
    v_mfma_f32_16x16x32_bf16 a[64:67], v[16:19], v[72:75], a[64:67]
    ds_read_b64_tr_b16 v[66:67], v127 offset:10568
    v_mfma_f32_16x16x32_bf16 a[68:71], v[16:19], v[76:79], a[68:71]
    ds_read_b64_tr_b16 v[68:69], v128 offset:9216
    ds_read_b64_tr_b16 v[70:71], v128 offset:10368
    v_mfma_f32_16x16x32_bf16 a[72:75], v[16:19], v[80:83], a[72:75]
    v_mfma_f32_16x16x32_bf16 a[76:79], v[16:19], v[84:87], a[76:79]
    v_mfma_f32_16x16x32_bf16 a[80:83], v[20:23], v[72:75], a[80:83]
    v_mfma_f32_16x16x32_bf16 a[84:87], v[20:23], v[76:79], a[84:87]
    v_mfma_f32_16x16x32_bf16 a[88:91], v[20:23], v[80:83], a[88:91]
    v_mfma_f32_16x16x32_bf16 a[92:95], v[20:23], v[84:87], a[92:95]
    v_mfma_f32_16x16x32_bf16 a[96:99], v[24:27], v[72:75], a[96:99]
    v_mfma_f32_16x16x32_bf16 a[100:103], v[24:27], v[76:79], a[100:103]
    v_mfma_f32_16x16x32_bf16 a[104:107], v[24:27], v[80:83], a[104:107]
    v_mfma_f32_16x16x32_bf16 a[108:111], v[24:27], v[84:87], a[108:111]
    v_mfma_f32_16x16x32_bf16 a[112:115], v[28:31], v[72:75], a[112:115]
    v_mfma_f32_16x16x32_bf16 a[116:119], v[28:31], v[76:79], a[116:119]
    v_mfma_f32_16x16x32_bf16 a[120:123], v[28:31], v[80:83], a[120:123]
    v_mfma_f32_16x16x32_bf16 a[124:127], v[28:31], v[84:87], a[124:127]
    v_mfma_f32_16x16x32_bf16 a[128:131], v[32:35], v[72:75], a[128:131]
    v_mfma_f32_16x16x32_bf16 a[132:135], v[32:35], v[76:79], a[132:135]
    v_mfma_f32_16x16x32_bf16 a[136:139], v[32:35], v[80:83], a[136:139]
    v_mfma_f32_16x16x32_bf16 a[140:143], v[32:35], v[84:87], a[140:143]
    s_waitcnt lgkmcnt(0)
    s_waitcnt vmcnt(0)
    s_barrier
    s_add_u32 m0, s29, 0
    s_nop 0
    buffer_load_dwordx4 v106, s[4:7], s12 offen lds
    s_add_u32 m0, s29, 1024
    s_nop 0
    buffer_load_dwordx4 v107, s[4:7], s12 offen lds
    s_add_u32 m0, s29, 2048
    s_nop 0
    buffer_load_dwordx4 v108, s[4:7], s12 offen lds
    s_add_u32 m0, s29, 3072
    s_nop 0
    buffer_load_dwordx4 v109, s[4:7], s12 offen lds
    s_add_u32 m0, s29, 4096
    s_nop 0
    buffer_load_dwordx4 v110, s[4:7], s12 offen lds
    s_add_u32 m0, s29, 5120
    s_nop 0
    buffer_load_dwordx4 v111, s[4:7], s12 offen lds
    s_add_u32 m0, s29, 6144
    s_nop 0
    buffer_load_dwordx4 v112, s[4:7], s12 offen lds
    s_add_u32 m0, s29, 7168
    s_nop 0
    buffer_load_dwordx4 v113, s[4:7], s12 offen lds
    s_add_u32 m0, s30, 0
    s_nop 0
    buffer_load_dwordx4 v114, s[8:11], s13 offen lds
    s_add_u32 m0, s30, 1024
    s_nop 0
    buffer_load_dwordx4 v115, s[8:11], s13 offen lds
    s_add_u32 m0, s30, 2048
    s_nop 0
    buffer_load_dwordx4 v116, s[8:11], s13 offen lds
    s_add_u32 m0, s30, 3072
    s_nop 0
    buffer_load_dwordx4 v117, s[8:11], s13 offen lds
    s_add_u32 m0, s30, 4096
    s_nop 0
    buffer_load_dwordx4 v118, s[8:11], s13 offen lds
    s_add_u32 m0, s30, 5120
    s_nop 0
    buffer_load_dwordx4 v119, s[8:11], s13 offen lds
    s_add_u32 m0, s30, 6144
    s_nop 0
    buffer_load_dwordx4 v120, s[8:11], s13 offen lds
    s_add_u32 m0, s30, 7168
    s_nop 0
    buffer_load_dwordx4 v121, s[8:11], s13 offen lds
    s_add_u32 m0, s30, 8192
    s_nop 0
    buffer_load_dwordx4 v122, s[8:11], s13 offen lds
    s_add_u32 s12, s12, 256
    s_add_u32 s13, s13, 147456
    v_mfma_f32_16x16x32_bf16 a[0:3], v[36:39], v[88:91], a[0:3]
    ds_read_b128 v[72:75], v124 offset:0
    v_mfma_f32_16x16x32_bf16 a[4:7], v[36:39], v[92:95], a[4:7]
    ds_read_b128 v[76:79], v124 offset:4096
    v_mfma_f32_16x16x32_bf16 a[8:11], v[36:39], v[96:99], a[8:11]
    ds_read_b128 v[80:83], v124 offset:8192
    v_mfma_f32_16x16x32_bf16 a[12:15], v[36:39], v[100:103], a[12:15]
    ds_read_b128 v[84:87], v124 offset:12288
    v_mfma_f32_16x16x32_bf16 a[16:19], v[40:43], v[88:91], a[16:19]
    ds_read_b64_tr_b16 v[0:1], v129 offset:0
    ds_read_b64_tr_b16 v[2:3], v129 offset:1152
    v_mfma_f32_16x16x32_bf16 a[20:23], v[40:43], v[92:95], a[20:23]
    ds_read_b64_tr_b16 v[4:5], v129 offset:8
    v_mfma_f32_16x16x32_bf16 a[24:27], v[40:43], v[96:99], a[24:27]
    ds_read_b64_tr_b16 v[6:7], v129 offset:1160
    v_mfma_f32_16x16x32_bf16 a[28:31], v[40:43], v[100:103], a[28:31]
    ds_read_b64_tr_b16 v[8:9], v129 offset:64
    v_mfma_f32_16x16x32_bf16 a[32:35], v[44:47], v[88:91], a[32:35]
    ds_read_b64_tr_b16 v[10:11], v129 offset:1216
    ds_read_b64_tr_b16 v[12:13], v129 offset:72
    v_mfma_f32_16x16x32_bf16 a[36:39], v[44:47], v[92:95], a[36:39]
    ds_read_b64_tr_b16 v[14:15], v129 offset:1224
    v_mfma_f32_16x16x32_bf16 a[40:43], v[44:47], v[96:99], a[40:43]
    ds_read_b64_tr_b16 v[16:17], v129 offset:128
    v_mfma_f32_16x16x32_bf16 a[44:47], v[44:47], v[100:103], a[44:47]
    ds_read_b64_tr_b16 v[18:19], v129 offset:1280
    v_mfma_f32_16x16x32_bf16 a[48:51], v[48:51], v[88:91], a[48:51]
    ds_read_b64_tr_b16 v[20:21], v129 offset:136
    v_mfma_f32_16x16x32_bf16 a[52:55], v[48:51], v[92:95], a[52:55]
    ds_read_b64_tr_b16 v[22:23], v129 offset:1288
    ds_read_b64_tr_b16 v[24:25], v129 offset:192
    v_mfma_f32_16x16x32_bf16 a[56:59], v[48:51], v[96:99], a[56:59]
    ds_read_b64_tr_b16 v[26:27], v129 offset:1344
    v_mfma_f32_16x16x32_bf16 a[60:63], v[48:51], v[100:103], a[60:63]
    ds_read_b64_tr_b16 v[28:29], v129 offset:200
    v_mfma_f32_16x16x32_bf16 a[64:67], v[52:55], v[88:91], a[64:67]
    ds_read_b64_tr_b16 v[30:31], v129 offset:1352
    v_mfma_f32_16x16x32_bf16 a[68:71], v[52:55], v[92:95], a[68:71]
    ds_read_b64_tr_b16 v[32:33], v130 offset:0
    ds_read_b64_tr_b16 v[34:35], v130 offset:1152
    v_mfma_f32_16x16x32_bf16 a[72:75], v[52:55], v[96:99], a[72:75]
    v_mfma_f32_16x16x32_bf16 a[76:79], v[52:55], v[100:103], a[76:79]
    v_mfma_f32_16x16x32_bf16 a[80:83], v[56:59], v[88:91], a[80:83]
    v_mfma_f32_16x16x32_bf16 a[84:87], v[56:59], v[92:95], a[84:87]
    v_mfma_f32_16x16x32_bf16 a[88:91], v[56:59], v[96:99], a[88:91]
    v_mfma_f32_16x16x32_bf16 a[92:95], v[56:59], v[100:103], a[92:95]
    v_mfma_f32_16x16x32_bf16 a[96:99], v[60:63], v[88:91], a[96:99]
    v_mfma_f32_16x16x32_bf16 a[100:103], v[60:63], v[92:95], a[100:103]
    v_mfma_f32_16x16x32_bf16 a[104:107], v[60:63], v[96:99], a[104:107]
    v_mfma_f32_16x16x32_bf16 a[108:111], v[60:63], v[100:103], a[108:111]
    v_mfma_f32_16x16x32_bf16 a[112:115], v[64:67], v[88:91], a[112:115]
    v_mfma_f32_16x16x32_bf16 a[116:119], v[64:67], v[92:95], a[116:119]
    v_mfma_f32_16x16x32_bf16 a[120:123], v[64:67], v[96:99], a[120:123]
    v_mfma_f32_16x16x32_bf16 a[124:127], v[64:67], v[100:103], a[124:127]
    v_mfma_f32_16x16x32_bf16 a[128:131], v[68:71], v[88:91], a[128:131]
    v_mfma_f32_16x16x32_bf16 a[132:135], v[68:71], v[92:95], a[132:135]
    v_mfma_f32_16x16x32_bf16 a[136:139], v[68:71], v[96:99], a[136:139]
    v_mfma_f32_16x16x32_bf16 a[140:143], v[68:71], v[100:103], a[140:143]
    s_waitcnt lgkmcnt(0)
    v_mfma_f32_16x16x32_bf16 a[0:3], v[0:3], v[72:75], a[0:3]
    ds_read_b128 v[88:91], v126 offset:0
    v_mfma_f32_16x16x32_bf16 a[4:7], v[0:3], v[76:79], a[4:7]
    ds_read_b128 v[92:95], v126 offset:4096
    v_mfma_f32_16x16x32_bf16 a[8:11], v[0:3], v[80:83], a[8:11]
    ds_read_b128 v[96:99], v126 offset:8192
    v_mfma_f32_16x16x32_bf16 a[12:15], v[0:3], v[84:87], a[12:15]
    ds_read_b128 v[100:103], v126 offset:12288
    v_mfma_f32_16x16x32_bf16 a[16:19], v[4:7], v[72:75], a[16:19]
    ds_read_b64_tr_b16 v[36:37], v129 offset:9216
    ds_read_b64_tr_b16 v[38:39], v129 offset:10368
    v_mfma_f32_16x16x32_bf16 a[20:23], v[4:7], v[76:79], a[20:23]
    ds_read_b64_tr_b16 v[40:41], v129 offset:9224
    v_mfma_f32_16x16x32_bf16 a[24:27], v[4:7], v[80:83], a[24:27]
    ds_read_b64_tr_b16 v[42:43], v129 offset:10376
    v_mfma_f32_16x16x32_bf16 a[28:31], v[4:7], v[84:87], a[28:31]
    ds_read_b64_tr_b16 v[44:45], v129 offset:9280
    v_mfma_f32_16x16x32_bf16 a[32:35], v[8:11], v[72:75], a[32:35]
    ds_read_b64_tr_b16 v[46:47], v129 offset:10432
    ds_read_b64_tr_b16 v[48:49], v129 offset:9288
    v_mfma_f32_16x16x32_bf16 a[36:39], v[8:11], v[76:79], a[36:39]
    ds_read_b64_tr_b16 v[50:51], v129 offset:10440
    v_mfma_f32_16x16x32_bf16 a[40:43], v[8:11], v[80:83], a[40:43]
    ds_read_b64_tr_b16 v[52:53], v129 offset:9344
    v_mfma_f32_16x16x32_bf16 a[44:47], v[8:11], v[84:87], a[44:47]
    ds_read_b64_tr_b16 v[54:55], v129 offset:10496
    v_mfma_f32_16x16x32_bf16 a[48:51], v[12:15], v[72:75], a[48:51]
    ds_read_b64_tr_b16 v[56:57], v129 offset:9352
    v_mfma_f32_16x16x32_bf16 a[52:55], v[12:15], v[76:79], a[52:55]
    ds_read_b64_tr_b16 v[58:59], v129 offset:10504
    ds_read_b64_tr_b16 v[60:61], v129 offset:9408
    v_mfma_f32_16x16x32_bf16 a[56:59], v[12:15], v[80:83], a[56:59]
    ds_read_b64_tr_b16 v[62:63], v129 offset:10560
    v_mfma_f32_16x16x32_bf16 a[60:63], v[12:15], v[84:87], a[60:63]
    ds_read_b64_tr_b16 v[64:65], v129 offset:9416
    v_mfma_f32_16x16x32_bf16 a[64:67], v[16:19], v[72:75], a[64:67]
    ds_read_b64_tr_b16 v[66:67], v129 offset:10568
    v_mfma_f32_16x16x32_bf16 a[68:71], v[16:19], v[76:79], a[68:71]
    ds_read_b64_tr_b16 v[68:69], v130 offset:9216
    ds_read_b64_tr_b16 v[70:71], v130 offset:10368
    v_mfma_f32_16x16x32_bf16 a[72:75], v[16:19], v[80:83], a[72:75]
    v_mfma_f32_16x16x32_bf16 a[76:79], v[16:19], v[84:87], a[76:79]
    v_mfma_f32_16x16x32_bf16 a[80:83], v[20:23], v[72:75], a[80:83]
    v_mfma_f32_16x16x32_bf16 a[84:87], v[20:23], v[76:79], a[84:87]
    v_mfma_f32_16x16x32_bf16 a[88:91], v[20:23], v[80:83], a[88:91]
    v_mfma_f32_16x16x32_bf16 a[92:95], v[20:23], v[84:87], a[92:95]
    v_mfma_f32_16x16x32_bf16 a[96:99], v[24:27], v[72:75], a[96:99]
    v_mfma_f32_16x16x32_bf16 a[100:103], v[24:27], v[76:79], a[100:103]
    v_mfma_f32_16x16x32_bf16 a[104:107], v[24:27], v[80:83], a[104:107]
    v_mfma_f32_16x16x32_bf16 a[108:111], v[24:27], v[84:87], a[108:111]
    v_mfma_f32_16x16x32_bf16 a[112:115], v[28:31], v[72:75], a[112:115]
    v_mfma_f32_16x16x32_bf16 a[116:119], v[28:31], v[76:79], a[116:119]
    v_mfma_f32_16x16x32_bf16 a[120:123], v[28:31], v[80:83], a[120:123]
    v_mfma_f32_16x16x32_bf16 a[124:127], v[28:31], v[84:87], a[124:127]
    v_mfma_f32_16x16x32_bf16 a[128:131], v[32:35], v[72:75], a[128:131]
    v_mfma_f32_16x16x32_bf16 a[132:135], v[32:35], v[76:79], a[132:135]
    v_mfma_f32_16x16x32_bf16 a[136:139], v[32:35], v[80:83], a[136:139]
    v_mfma_f32_16x16x32_bf16 a[140:143], v[32:35], v[84:87], a[140:143]
    s_waitcnt lgkmcnt(0)
    s_waitcnt vmcnt(0)
    s_barrier
    v_mfma_f32_16x16x32_bf16 a[0:3], v[36:39], v[88:91], a[0:3]
    ds_read_b128 v[72:75], v123 offset:0
    v_mfma_f32_16x16x32_bf16 a[4:7], v[36:39], v[92:95], a[4:7]
    ds_read_b128 v[76:79], v123 offset:4096
    v_mfma_f32_16x16x32_bf16 a[8:11], v[36:39], v[96:99], a[8:11]
    ds_read_b128 v[80:83], v123 offset:8192
    v_mfma_f32_16x16x32_bf16 a[12:15], v[36:39], v[100:103], a[12:15]
    ds_read_b128 v[84:87], v123 offset:12288
    v_mfma_f32_16x16x32_bf16 a[16:19], v[40:43], v[88:91], a[16:19]
    ds_read_b64_tr_b16 v[0:1], v127 offset:0
    ds_read_b64_tr_b16 v[2:3], v127 offset:1152
    v_mfma_f32_16x16x32_bf16 a[20:23], v[40:43], v[92:95], a[20:23]
    ds_read_b64_tr_b16 v[4:5], v127 offset:8
    v_mfma_f32_16x16x32_bf16 a[24:27], v[40:43], v[96:99], a[24:27]
    ds_read_b64_tr_b16 v[6:7], v127 offset:1160
    v_mfma_f32_16x16x32_bf16 a[28:31], v[40:43], v[100:103], a[28:31]
    ds_read_b64_tr_b16 v[8:9], v127 offset:64
    v_mfma_f32_16x16x32_bf16 a[32:35], v[44:47], v[88:91], a[32:35]
    ds_read_b64_tr_b16 v[10:11], v127 offset:1216
    ds_read_b64_tr_b16 v[12:13], v127 offset:72
    v_mfma_f32_16x16x32_bf16 a[36:39], v[44:47], v[92:95], a[36:39]
    ds_read_b64_tr_b16 v[14:15], v127 offset:1224
    v_mfma_f32_16x16x32_bf16 a[40:43], v[44:47], v[96:99], a[40:43]
    ds_read_b64_tr_b16 v[16:17], v127 offset:128
    v_mfma_f32_16x16x32_bf16 a[44:47], v[44:47], v[100:103], a[44:47]
    ds_read_b64_tr_b16 v[18:19], v127 offset:1280
    v_mfma_f32_16x16x32_bf16 a[48:51], v[48:51], v[88:91], a[48:51]
    ds_read_b64_tr_b16 v[20:21], v127 offset:136
    v_mfma_f32_16x16x32_bf16 a[52:55], v[48:51], v[92:95], a[52:55]
    ds_read_b64_tr_b16 v[22:23], v127 offset:1288
    ds_read_b64_tr_b16 v[24:25], v127 offset:192
    v_mfma_f32_16x16x32_bf16 a[56:59], v[48:51], v[96:99], a[56:59]
    ds_read_b64_tr_b16 v[26:27], v127 offset:1344
    v_mfma_f32_16x16x32_bf16 a[60:63], v[48:51], v[100:103], a[60:63]
    ds_read_b64_tr_b16 v[28:29], v127 offset:200
    v_mfma_f32_16x16x32_bf16 a[64:67], v[52:55], v[88:91], a[64:67]
    ds_read_b64_tr_b16 v[30:31], v127 offset:1352
    v_mfma_f32_16x16x32_bf16 a[68:71], v[52:55], v[92:95], a[68:71]
    ds_read_b64_tr_b16 v[32:33], v128 offset:0
    ds_read_b64_tr_b16 v[34:35], v128 offset:1152
    v_mfma_f32_16x16x32_bf16 a[72:75], v[52:55], v[96:99], a[72:75]
    v_mfma_f32_16x16x32_bf16 a[76:79], v[52:55], v[100:103], a[76:79]
    v_mfma_f32_16x16x32_bf16 a[80:83], v[56:59], v[88:91], a[80:83]
    v_mfma_f32_16x16x32_bf16 a[84:87], v[56:59], v[92:95], a[84:87]
    v_mfma_f32_16x16x32_bf16 a[88:91], v[56:59], v[96:99], a[88:91]
    v_mfma_f32_16x16x32_bf16 a[92:95], v[56:59], v[100:103], a[92:95]
    v_mfma_f32_16x16x32_bf16 a[96:99], v[60:63], v[88:91], a[96:99]
    v_mfma_f32_16x16x32_bf16 a[100:103], v[60:63], v[92:95], a[100:103]
    v_mfma_f32_16x16x32_bf16 a[104:107], v[60:63], v[96:99], a[104:107]
    v_mfma_f32_16x16x32_bf16 a[108:111], v[60:63], v[100:103], a[108:111]
    v_mfma_f32_16x16x32_bf16 a[112:115], v[64:67], v[88:91], a[112:115]
    v_mfma_f32_16x16x32_bf16 a[116:119], v[64:67], v[92:95], a[116:119]
    v_mfma_f32_16x16x32_bf16 a[120:123], v[64:67], v[96:99], a[120:123]
    v_mfma_f32_16x16x32_bf16 a[124:127], v[64:67], v[100:103], a[124:127]
    v_mfma_f32_16x16x32_bf16 a[128:131], v[68:71], v[88:91], a[128:131]
    v_mfma_f32_16x16x32_bf16 a[132:135], v[68:71], v[92:95], a[132:135]
    v_mfma_f32_16x16x32_bf16 a[136:139], v[68:71], v[96:99], a[136:139]
    v_mfma_f32_16x16x32_bf16 a[140:143], v[68:71], v[100:103], a[140:143]
    s_waitcnt lgkmcnt(0)
    v_mfma_f32_16x16x32_bf16 a[0:3], v[0:3], v[72:75], a[0:3]
    ds_read_b128 v[88:91], v125 offset:0
    v_mfma_f32_16x16x32_bf16 a[4:7], v[0:3], v[76:79], a[4:7]
    ds_read_b128 v[92:95], v125 offset:4096
    v_mfma_f32_16x16x32_bf16 a[8:11], v[0:3], v[80:83], a[8:11]
    ds_read_b128 v[96:99], v125 offset:8192
    v_mfma_f32_16x16x32_bf16 a[12:15], v[0:3], v[84:87], a[12:15]
    ds_read_b128 v[100:103], v125 offset:12288
    v_mfma_f32_16x16x32_bf16 a[16:19], v[4:7], v[72:75], a[16:19]
    ds_read_b64_tr_b16 v[36:37], v127 offset:9216
    ds_read_b64_tr_b16 v[38:39], v127 offset:10368
    v_mfma_f32_16x16x32_bf16 a[20:23], v[4:7], v[76:79], a[20:23]
    ds_read_b64_tr_b16 v[40:41], v127 offset:9224
    v_mfma_f32_16x16x32_bf16 a[24:27], v[4:7], v[80:83], a[24:27]
    ds_read_b64_tr_b16 v[42:43], v127 offset:10376
    v_mfma_f32_16x16x32_bf16 a[28:31], v[4:7], v[84:87], a[28:31]
    ds_read_b64_tr_b16 v[44:45], v127 offset:9280
    v_mfma_f32_16x16x32_bf16 a[32:35], v[8:11], v[72:75], a[32:35]
    ds_read_b64_tr_b16 v[46:47], v127 offset:10432
    ds_read_b64_tr_b16 v[48:49], v127 offset:9288
    v_mfma_f32_16x16x32_bf16 a[36:39], v[8:11], v[76:79], a[36:39]
    ds_read_b64_tr_b16 v[50:51], v127 offset:10440
    v_mfma_f32_16x16x32_bf16 a[40:43], v[8:11], v[80:83], a[40:43]
    ds_read_b64_tr_b16 v[52:53], v127 offset:9344
    v_mfma_f32_16x16x32_bf16 a[44:47], v[8:11], v[84:87], a[44:47]
    ds_read_b64_tr_b16 v[54:55], v127 offset:10496
    v_mfma_f32_16x16x32_bf16 a[48:51], v[12:15], v[72:75], a[48:51]
    ds_read_b64_tr_b16 v[56:57], v127 offset:9352
    v_mfma_f32_16x16x32_bf16 a[52:55], v[12:15], v[76:79], a[52:55]
    ds_read_b64_tr_b16 v[58:59], v127 offset:10504
    ds_read_b64_tr_b16 v[60:61], v127 offset:9408
    v_mfma_f32_16x16x32_bf16 a[56:59], v[12:15], v[80:83], a[56:59]
    ds_read_b64_tr_b16 v[62:63], v127 offset:10560
    v_mfma_f32_16x16x32_bf16 a[60:63], v[12:15], v[84:87], a[60:63]
    ds_read_b64_tr_b16 v[64:65], v127 offset:9416
    v_mfma_f32_16x16x32_bf16 a[64:67], v[16:19], v[72:75], a[64:67]
    ds_read_b64_tr_b16 v[66:67], v127 offset:10568
    v_mfma_f32_16x16x32_bf16 a[68:71], v[16:19], v[76:79], a[68:71]
    ds_read_b64_tr_b16 v[68:69], v128 offset:9216
    ds_read_b64_tr_b16 v[70:71], v128 offset:10368
    v_mfma_f32_16x16x32_bf16 a[72:75], v[16:19], v[80:83], a[72:75]
    v_mfma_f32_16x16x32_bf16 a[76:79], v[16:19], v[84:87], a[76:79]
    v_mfma_f32_16x16x32_bf16 a[80:83], v[20:23], v[72:75], a[80:83]
    v_mfma_f32_16x16x32_bf16 a[84:87], v[20:23], v[76:79], a[84:87]
    v_mfma_f32_16x16x32_bf16 a[88:91], v[20:23], v[80:83], a[88:91]
    v_mfma_f32_16x16x32_bf16 a[92:95], v[20:23], v[84:87], a[92:95]
    v_mfma_f32_16x16x32_bf16 a[96:99], v[24:27], v[72:75], a[96:99]
    v_mfma_f32_16x16x32_bf16 a[100:103], v[24:27], v[76:79], a[100:103]
    v_mfma_f32_16x16x32_bf16 a[104:107], v[24:27], v[80:83], a[104:107]
    v_mfma_f32_16x16x32_bf16 a[108:111], v[24:27], v[84:87], a[108:111]
    v_mfma_f32_16x16x32_bf16 a[112:115], v[28:31], v[72:75], a[112:115]
    v_mfma_f32_16x16x32_bf16 a[116:119], v[28:31], v[76:79], a[116:119]
    v_mfma_f32_16x16x32_bf16 a[120:123], v[28:31], v[80:83], a[120:123]
    v_mfma_f32_16x16x32_bf16 a[124:127], v[28:31], v[84:87], a[124:127]
    v_mfma_f32_16x16x32_bf16 a[128:131], v[32:35], v[72:75], a[128:131]
    v_mfma_f32_16x16x32_bf16 a[132:135], v[32:35], v[76:79], a[132:135]
    v_mfma_f32_16x16x32_bf16 a[136:139], v[32:35], v[80:83], a[136:139]
    v_mfma_f32_16x16x32_bf16 a[140:143], v[32:35], v[84:87], a[140:143]
    s_waitcnt lgkmcnt(0)
    s_waitcnt vmcnt(0)
    s_barrier
    v_mfma_f32_16x16x32_bf16 a[0:3], v[36:39], v[88:91], a[0:3]
    v_mfma_f32_16x16x32_bf16 a[4:7], v[36:39], v[92:95], a[4:7]
    v_mfma_f32_16x16x32_bf16 a[8:11], v[36:39], v[96:99], a[8:11]
    v_mfma_f32_16x16x32_bf16 a[12:15], v[36:39], v[100:103], a[12:15]
    v_mfma_f32_16x16x32_bf16 a[16:19], v[40:43], v[88:91], a[16:19]
    v_mfma_f32_16x16x32_bf16 a[20:23], v[40:43], v[92:95], a[20:23]
    v_mfma_f32_16x16x32_bf16 a[24:27], v[40:43], v[96:99], a[24:27]
    v_mfma_f32_16x16x32_bf16 a[28:31], v[40:43], v[100:103], a[28:31]
    v_mfma_f32_16x16x32_bf16 a[32:35], v[44:47], v[88:91], a[32:35]
    v_mfma_f32_16x16x32_bf16 a[36:39], v[44:47], v[92:95], a[36:39]
    v_mfma_f32_16x16x32_bf16 a[40:43], v[44:47], v[96:99], a[40:43]
    v_mfma_f32_16x16x32_bf16 a[44:47], v[44:47], v[100:103], a[44:47]
    v_mfma_f32_16x16x32_bf16 a[48:51], v[48:51], v[88:91], a[48:51]
    v_mfma_f32_16x16x32_bf16 a[52:55], v[48:51], v[92:95], a[52:55]
    v_mfma_f32_16x16x32_bf16 a[56:59], v[48:51], v[96:99], a[56:59]
    v_mfma_f32_16x16x32_bf16 a[60:63], v[48:51], v[100:103], a[60:63]
    v_mfma_f32_16x16x32_bf16 a[64:67], v[52:55], v[88:91], a[64:67]
    v_mfma_f32_16x16x32_bf16 a[68:71], v[52:55], v[92:95], a[68:71]
    v_mfma_f32_16x16x32_bf16 a[72:75], v[52:55], v[96:99], a[72:75]
    v_mfma_f32_16x16x32_bf16 a[76:79], v[52:55], v[100:103], a[76:79]
    v_mfma_f32_16x16x32_bf16 a[80:83], v[56:59], v[88:91], a[80:83]
    v_mfma_f32_16x16x32_bf16 a[84:87], v[56:59], v[92:95], a[84:87]
    v_mfma_f32_16x16x32_bf16 a[88:91], v[56:59], v[96:99], a[88:91]
    v_mfma_f32_16x16x32_bf16 a[92:95], v[56:59], v[100:103], a[92:95]
    v_mfma_f32_16x16x32_bf16 a[96:99], v[60:63], v[88:91], a[96:99]
    v_mfma_f32_16x16x32_bf16 a[100:103], v[60:63], v[92:95], a[100:103]
    v_mfma_f32_16x16x32_bf16 a[104:107], v[60:63], v[96:99], a[104:107]
    v_mfma_f32_16x16x32_bf16 a[108:111], v[60:63], v[100:103], a[108:111]
    v_mfma_f32_16x16x32_bf16 a[112:115], v[64:67], v[88:91], a[112:115]
    v_mfma_f32_16x16x32_bf16 a[116:119], v[64:67], v[92:95], a[116:119]
    v_mfma_f32_16x16x32_bf16 a[120:123], v[64:67], v[96:99], a[120:123]
    v_mfma_f32_16x16x32_bf16 a[124:127], v[64:67], v[100:103], a[124:127]
    v_mfma_f32_16x16x32_bf16 a[128:131], v[68:71], v[88:91], a[128:131]
    v_mfma_f32_16x16x32_bf16 a[132:135], v[68:71], v[92:95], a[132:135]
    v_mfma_f32_16x16x32_bf16 a[136:139], v[68:71], v[96:99], a[136:139]
    v_mfma_f32_16x16x32_bf16 a[140:143], v[68:71], v[100:103], a[140:143]
    s_nop 7
    s_nop 7
    v_lshrrev_b32 v0, 4, v104
    v_and_b32 v1, 15, v104
    s_barrier
    s_lshl_b32 s33, s31, 15
    s_mul_i32 s33, s31, 36864
    v_lshlrev_b32 v2, 4, v104
    v_add_u32 v2, s33, v2
    s_cmp_eq_u32 s32, 0
    s_cbranch_scc1 Lg2_red_rd
    v_accvgpr_read_b32 v10, a0
    v_accvgpr_read_b32 v11, a1
    v_accvgpr_read_b32 v12, a2
    v_accvgpr_read_b32 v13, a3
    ds_write_b128 v2, v[10:13] offset:0
    v_accvgpr_read_b32 v10, a4
    v_accvgpr_read_b32 v11, a5
    v_accvgpr_read_b32 v12, a6
    v_accvgpr_read_b32 v13, a7
    ds_write_b128 v2, v[10:13] offset:1024
    v_accvgpr_read_b32 v10, a8
    v_accvgpr_read_b32 v11, a9
    v_accvgpr_read_b32 v12, a10
    v_accvgpr_read_b32 v13, a11
    ds_write_b128 v2, v[10:13] offset:2048
    v_accvgpr_read_b32 v10, a12
    v_accvgpr_read_b32 v11, a13
    v_accvgpr_read_b32 v12, a14
    v_accvgpr_read_b32 v13, a15
    ds_write_b128 v2, v[10:13] offset:3072
    v_accvgpr_read_b32 v10, a16
    v_accvgpr_read_b32 v11, a17
    v_accvgpr_read_b32 v12, a18
    v_accvgpr_read_b32 v13, a19
    ds_write_b128 v2, v[10:13] offset:4096
    v_accvgpr_read_b32 v10, a20
    v_accvgpr_read_b32 v11, a21
    v_accvgpr_read_b32 v12, a22
    v_accvgpr_read_b32 v13, a23
    ds_write_b128 v2, v[10:13] offset:5120
    v_accvgpr_read_b32 v10, a24
    v_accvgpr_read_b32 v11, a25
    v_accvgpr_read_b32 v12, a26
    v_accvgpr_read_b32 v13, a27
    ds_write_b128 v2, v[10:13] offset:6144
    v_accvgpr_read_b32 v10, a28
    v_accvgpr_read_b32 v11, a29
    v_accvgpr_read_b32 v12, a30
    v_accvgpr_read_b32 v13, a31
    ds_write_b128 v2, v[10:13] offset:7168
    v_accvgpr_read_b32 v10, a32
    v_accvgpr_read_b32 v11, a33
    v_accvgpr_read_b32 v12, a34
    v_accvgpr_read_b32 v13, a35
    ds_write_b128 v2, v[10:13] offset:8192
    v_accvgpr_read_b32 v10, a36
    v_accvgpr_read_b32 v11, a37
    v_accvgpr_read_b32 v12, a38
    v_accvgpr_read_b32 v13, a39
    ds_write_b128 v2, v[10:13] offset:9216
    v_accvgpr_read_b32 v10, a40
    v_accvgpr_read_b32 v11, a41
    v_accvgpr_read_b32 v12, a42
    v_accvgpr_read_b32 v13, a43
    ds_write_b128 v2, v[10:13] offset:10240
    v_accvgpr_read_b32 v10, a44
    v_accvgpr_read_b32 v11, a45
    v_accvgpr_read_b32 v12, a46
    v_accvgpr_read_b32 v13, a47
    ds_write_b128 v2, v[10:13] offset:11264
    v_accvgpr_read_b32 v10, a48
    v_accvgpr_read_b32 v11, a49
    v_accvgpr_read_b32 v12, a50
    v_accvgpr_read_b32 v13, a51
    ds_write_b128 v2, v[10:13] offset:12288
    v_accvgpr_read_b32 v10, a52
    v_accvgpr_read_b32 v11, a53
    v_accvgpr_read_b32 v12, a54
    v_accvgpr_read_b32 v13, a55
    ds_write_b128 v2, v[10:13] offset:13312
    v_accvgpr_read_b32 v10, a56
    v_accvgpr_read_b32 v11, a57
    v_accvgpr_read_b32 v12, a58
    v_accvgpr_read_b32 v13, a59
    ds_write_b128 v2, v[10:13] offset:14336
    v_accvgpr_read_b32 v10, a60
    v_accvgpr_read_b32 v11, a61
    v_accvgpr_read_b32 v12, a62
    v_accvgpr_read_b32 v13, a63
    ds_write_b128 v2, v[10:13] offset:15360
    v_accvgpr_read_b32 v10, a64
    v_accvgpr_read_b32 v11, a65
    v_accvgpr_read_b32 v12, a66
    v_accvgpr_read_b32 v13, a67
    ds_write_b128 v2, v[10:13] offset:16384
    v_accvgpr_read_b32 v10, a68
    v_accvgpr_read_b32 v11, a69
    v_accvgpr_read_b32 v12, a70
    v_accvgpr_read_b32 v13, a71
    ds_write_b128 v2, v[10:13] offset:17408
    v_accvgpr_read_b32 v10, a72
    v_accvgpr_read_b32 v11, a73
    v_accvgpr_read_b32 v12, a74
    v_accvgpr_read_b32 v13, a75
    ds_write_b128 v2, v[10:13] offset:18432
    v_accvgpr_read_b32 v10, a76
    v_accvgpr_read_b32 v11, a77
    v_accvgpr_read_b32 v12, a78
    v_accvgpr_read_b32 v13, a79
    ds_write_b128 v2, v[10:13] offset:19456
    v_accvgpr_read_b32 v10, a80
    v_accvgpr_read_b32 v11, a81
    v_accvgpr_read_b32 v12, a82
    v_accvgpr_read_b32 v13, a83
    ds_write_b128 v2, v[10:13] offset:20480
    v_accvgpr_read_b32 v10, a84
    v_accvgpr_read_b32 v11, a85
    v_accvgpr_read_b32 v12, a86
    v_accvgpr_read_b32 v13, a87
    ds_write_b128 v2, v[10:13] offset:21504
    v_accvgpr_read_b32 v10, a88
    v_accvgpr_read_b32 v11, a89
    v_accvgpr_read_b32 v12, a90
    v_accvgpr_read_b32 v13, a91
    ds_write_b128 v2, v[10:13] offset:22528
    v_accvgpr_read_b32 v10, a92
    v_accvgpr_read_b32 v11, a93
    v_accvgpr_read_b32 v12, a94
    v_accvgpr_read_b32 v13, a95
    ds_write_b128 v2, v[10:13] offset:23552
    v_accvgpr_read_b32 v10, a96
    v_accvgpr_read_b32 v11, a97
    v_accvgpr_read_b32 v12, a98
    v_accvgpr_read_b32 v13, a99
    ds_write_b128 v2, v[10:13] offset:24576
    v_accvgpr_read_b32 v10, a100
    v_accvgpr_read_b32 v11, a101
    v_accvgpr_read_b32 v12, a102
    v_accvgpr_read_b32 v13, a103
    ds_write_b128 v2, v[10:13] offset:25600
    v_accvgpr_read_b32 v10, a104
    v_accvgpr_read_b32 v11, a105
    v_accvgpr_read_b32 v12, a106
    v_accvgpr_read_b32 v13, a107
    ds_write_b128 v2, v[10:13] offset:26624
    v_accvgpr_read_b32 v10, a108
    v_accvgpr_read_b32 v11, a109
    v_accvgpr_read_b32 v12, a110
    v_accvgpr_read_b32 v13, a111
    ds_write_b128 v2, v[10:13] offset:27648
    v_accvgpr_read_b32 v10, a112
    v_accvgpr_read_b32 v11, a113
    v_accvgpr_read_b32 v12, a114
    v_accvgpr_read_b32 v13, a115
    ds_write_b128 v2, v[10:13] offset:28672
    v_accvgpr_read_b32 v10, a116
    v_accvgpr_read_b32 v11, a117
    v_accvgpr_read_b32 v12, a118
    v_accvgpr_read_b32 v13, a119
    ds_write_b128 v2, v[10:13] offset:29696
    v_accvgpr_read_b32 v10, a120
    v_accvgpr_read_b32 v11, a121
    v_accvgpr_read_b32 v12, a122
    v_accvgpr_read_b32 v13, a123
    ds_write_b128 v2, v[10:13] offset:30720
    v_accvgpr_read_b32 v10, a124
    v_accvgpr_read_b32 v11, a125
    v_accvgpr_read_b32 v12, a126
    v_accvgpr_read_b32 v13, a127
    ds_write_b128 v2, v[10:13] offset:31744
    v_accvgpr_read_b32 v10, a128
    v_accvgpr_read_b32 v11, a129
    v_accvgpr_read_b32 v12, a130
    v_accvgpr_read_b32 v13, a131
    ds_write_b128 v2, v[10:13] offset:32768
    v_accvgpr_read_b32 v10, a132
    v_accvgpr_read_b32 v11, a133
    v_accvgpr_read_b32 v12, a134
    v_accvgpr_read_b32 v13, a135
    ds_write_b128 v2, v[10:13] offset:33792
    v_accvgpr_read_b32 v10, a136
    v_accvgpr_read_b32 v11, a137
    v_accvgpr_read_b32 v12, a138
    v_accvgpr_read_b32 v13, a139
    ds_write_b128 v2, v[10:13] offset:34816
    v_accvgpr_read_b32 v10, a140
    v_accvgpr_read_b32 v11, a141
    v_accvgpr_read_b32 v12, a142
    v_accvgpr_read_b32 v13, a143
    ds_write_b128 v2, v[10:13] offset:35840
    s_waitcnt lgkmcnt(0)
Lg2_red_rd:
    s_barrier
    s_cmp_eq_u32 s32, 1
    s_cbranch_scc1 Lg2_end
    s_lshl_b32 s33, s22, 7
    s_lshl_b32 s34, s31, 6
    s_add_u32 s33, s33, s34
    v_add_u32 v3, s33, v1
    s_movk_i32 s28, 2304
    v_mul_lo_u32 v3, v3, s28
    s_mul_i32 s34, s21, 576
    s_mul_i32 s35, s23, 4718592
    s_add_u32 s34, s34, s35
    v_add_u32 v3, s34, v3
    v_lshl_add_u32 v4, v0, 5, v3
    v_lshl_add_u32 v5, v0, 4, v3
    s_add_u32 s36, s18, 41943040
    s_addc_u32 s37, s19, 0
    ds_read_b128 v[40:43], v2 offset:0
    ds_read_b128 v[44:47], v2 offset:1024
    ds_read_b128 v[48:51], v2 offset:2048
    ds_read_b128 v[52:55], v2 offset:3072
    ds_read_b128 v[56:59], v2 offset:4096
    ds_read_b128 v[60:63], v2 offset:5120
    v_accvgpr_read_b32 v10, a0
    v_accvgpr_read_b32 v11, a1
    v_accvgpr_read_b32 v12, a2
    v_accvgpr_read_b32 v13, a3
    v_accvgpr_read_b32 v14, a4
    v_accvgpr_read_b32 v15, a5
    v_accvgpr_read_b32 v16, a6
    v_accvgpr_read_b32 v17, a7
    v_accvgpr_read_b32 v18, a8
    v_accvgpr_read_b32 v19, a9
    v_accvgpr_read_b32 v20, a10
    v_accvgpr_read_b32 v21, a11
    v_accvgpr_read_b32 v22, a12
    v_accvgpr_read_b32 v23, a13
    v_accvgpr_read_b32 v24, a14
    v_accvgpr_read_b32 v25, a15
    v_accvgpr_read_b32 v26, a16
    v_accvgpr_read_b32 v27, a17
    v_accvgpr_read_b32 v28, a18
    v_accvgpr_read_b32 v29, a19
    v_accvgpr_read_b32 v30, a20
    v_accvgpr_read_b32 v31, a21
    v_accvgpr_read_b32 v32, a22
    v_accvgpr_read_b32 v33, a23
    s_waitcnt lgkmcnt(0)
    v_pk_add_f32 v[10:11], v[10:11], v[40:41]
    v_pk_add_f32 v[12:13], v[12:13], v[42:43]
    v_add_u32 v6, 0, v4
    global_store_dwordx4 v6, v[10:13], s[36:37]
    v_pk_add_f32 v[14:15], v[14:15], v[44:45]
    v_pk_add_f32 v[16:17], v[16:17], v[46:47]
    v_add_u32 v6, 36864, v4
    global_store_dwordx4 v6, v[14:17], s[36:37]
    v_pk_add_f32 v[18:19], v[18:19], v[48:49]
    v_pk_add_f32 v[20:21], v[20:21], v[50:51]
    v_add_u32 v6, 73728, v4
    global_store_dwordx4 v6, v[18:21], s[36:37]
    v_pk_add_f32 v[22:23], v[22:23], v[52:53]
    v_pk_add_f32 v[24:25], v[24:25], v[54:55]
    v_add_u32 v6, 110592, v4
    global_store_dwordx4 v6, v[22:25], s[36:37]
    v_pk_add_f32 v[26:27], v[26:27], v[56:57]
    v_pk_add_f32 v[28:29], v[28:29], v[58:59]
    v_add_u32 v6, 16, v4
    global_store_dwordx4 v6, v[26:29], s[36:37]
    v_pk_add_f32 v[30:31], v[30:31], v[60:61]
    v_pk_add_f32 v[32:33], v[32:33], v[62:63]
    v_add_u32 v6, 36880, v4
    global_store_dwordx4 v6, v[30:33], s[36:37]
    s_nop 1
    ds_read_b128 v[40:43], v2 offset:6144
    ds_read_b128 v[44:47], v2 offset:7168
    ds_read_b128 v[48:51], v2 offset:8192
    ds_read_b128 v[52:55], v2 offset:9216
    ds_read_b128 v[56:59], v2 offset:10240
    ds_read_b128 v[60:63], v2 offset:11264
    v_accvgpr_read_b32 v10, a24
    v_accvgpr_read_b32 v11, a25
    v_accvgpr_read_b32 v12, a26
    v_accvgpr_read_b32 v13, a27
    v_accvgpr_read_b32 v14, a28
    v_accvgpr_read_b32 v15, a29
    v_accvgpr_read_b32 v16, a30
    v_accvgpr_read_b32 v17, a31
    v_accvgpr_read_b32 v18, a32
    v_accvgpr_read_b32 v19, a33
    v_accvgpr_read_b32 v20, a34
    v_accvgpr_read_b32 v21, a35
    v_accvgpr_read_b32 v22, a36
    v_accvgpr_read_b32 v23, a37
    v_accvgpr_read_b32 v24, a38
    v_accvgpr_read_b32 v25, a39
    v_accvgpr_read_b32 v26, a40
    v_accvgpr_read_b32 v27, a41
    v_accvgpr_read_b32 v28, a42
    v_accvgpr_read_b32 v29, a43
    v_accvgpr_read_b32 v30, a44
    v_accvgpr_read_b32 v31, a45
    v_accvgpr_read_b32 v32, a46
    v_accvgpr_read_b32 v33, a47
    s_waitcnt lgkmcnt(0)
    v_pk_add_f32 v[10:11], v[10:11], v[40:41]
    v_pk_add_f32 v[12:13], v[12:13], v[42:43]
    v_add_u32 v6, 73744, v4
    global_store_dwordx4 v6, v[10:13], s[36:37]
    v_pk_add_f32 v[14:15], v[14:15], v[44:45]
    v_pk_add_f32 v[16:17], v[16:17], v[46:47]
    v_add_u32 v6, 110608, v4
    global_store_dwordx4 v6, v[14:17], s[36:37]
    v_pk_add_f32 v[18:19], v[18:19], v[48:49]
    v_pk_add_f32 v[20:21], v[20:21], v[50:51]
    v_add_u32 v6, 128, v4
    global_store_dwordx4 v6, v[18:21], s[36:37]
    v_pk_add_f32 v[22:23], v[22:23], v[52:53]
    v_pk_add_f32 v[24:25], v[24:25], v[54:55]
    v_add_u32 v6, 36992, v4
    global_store_dwordx4 v6, v[22:25], s[36:37]
    v_pk_add_f32 v[26:27], v[26:27], v[56:57]
    v_pk_add_f32 v[28:29], v[28:29], v[58:59]
    v_add_u32 v6, 73856, v4
    global_store_dwordx4 v6, v[26:29], s[36:37]
    v_pk_add_f32 v[30:31], v[30:31], v[60:61]
    v_pk_add_f32 v[32:33], v[32:33], v[62:63]
    v_add_u32 v6, 110720, v4
    global_store_dwordx4 v6, v[30:33], s[36:37]
    s_nop 1
    ds_read_b128 v[40:43], v2 offset:12288
    ds_read_b128 v[44:47], v2 offset:13312
    ds_read_b128 v[48:51], v2 offset:14336
    ds_read_b128 v[52:55], v2 offset:15360
    ds_read_b128 v[56:59], v2 offset:16384
    ds_read_b128 v[60:63], v2 offset:17408
    v_accvgpr_read_b32 v10, a48
    v_accvgpr_read_b32 v11, a49
    v_accvgpr_read_b32 v12, a50
    v_accvgpr_read_b32 v13, a51
    v_accvgpr_read_b32 v14, a52
    v_accvgpr_read_b32 v15, a53
    v_accvgpr_read_b32 v16, a54
    v_accvgpr_read_b32 v17, a55
    v_accvgpr_read_b32 v18, a56
    v_accvgpr_read_b32 v19, a57
    v_accvgpr_read_b32 v20, a58
    v_accvgpr_read_b32 v21, a59
    v_accvgpr_read_b32 v22, a60
    v_accvgpr_read_b32 v23, a61
    v_accvgpr_read_b32 v24, a62
    v_accvgpr_read_b32 v25, a63
    v_accvgpr_read_b32 v26, a64
    v_accvgpr_read_b32 v27, a65
    v_accvgpr_read_b32 v28, a66
    v_accvgpr_read_b32 v29, a67
    v_accvgpr_read_b32 v30, a68
    v_accvgpr_read_b32 v31, a69
    v_accvgpr_read_b32 v32, a70
    v_accvgpr_read_b32 v33, a71
    s_waitcnt lgkmcnt(0)
    v_pk_add_f32 v[10:11], v[10:11], v[40:41]
    v_pk_add_f32 v[12:13], v[12:13], v[42:43]
    v_add_u32 v6, 144, v4
    global_store_dwordx4 v6, v[10:13], s[36:37]
    v_pk_add_f32 v[14:15], v[14:15], v[44:45]
    v_pk_add_f32 v[16:17], v[16:17], v[46:47]
    v_add_u32 v6, 37008, v4
    global_store_dwordx4 v6, v[14:17], s[36:37]
    v_pk_add_f32 v[18:19], v[18:19], v[48:49]
    v_pk_add_f32 v[20:21], v[20:21], v[50:51]
    v_add_u32 v6, 73872, v4
    global_store_dwordx4 v6, v[18:21], s[36:37]
    v_pk_add_f32 v[22:23], v[22:23], v[52:53]
    v_pk_add_f32 v[24:25], v[24:25], v[54:55]
    v_add_u32 v6, 110736, v4
    global_store_dwordx4 v6, v[22:25], s[36:37]
    v_pk_add_f32 v[26:27], v[26:27], v[56:57]
    v_pk_add_f32 v[28:29], v[28:29], v[58:59]
    v_add_u32 v6, 256, v4
    global_store_dwordx4 v6, v[26:29], s[36:37]
    v_pk_add_f32 v[30:31], v[30:31], v[60:61]
    v_pk_add_f32 v[32:33], v[32:33], v[62:63]
    v_add_u32 v6, 37120, v4
    global_store_dwordx4 v6, v[30:33], s[36:37]
    s_nop 1
    ds_read_b128 v[40:43], v2 offset:18432
    ds_read_b128 v[44:47], v2 offset:19456
    ds_read_b128 v[48:51], v2 offset:20480
    ds_read_b128 v[52:55], v2 offset:21504
    ds_read_b128 v[56:59], v2 offset:22528
    ds_read_b128 v[60:63], v2 offset:23552
    v_accvgpr_read_b32 v10, a72
    v_accvgpr_read_b32 v11, a73
    v_accvgpr_read_b32 v12, a74
    v_accvgpr_read_b32 v13, a75
    v_accvgpr_read_b32 v14, a76
    v_accvgpr_read_b32 v15, a77
    v_accvgpr_read_b32 v16, a78
    v_accvgpr_read_b32 v17, a79
    v_accvgpr_read_b32 v18, a80
    v_accvgpr_read_b32 v19, a81
    v_accvgpr_read_b32 v20, a82
    v_accvgpr_read_b32 v21, a83
    v_accvgpr_read_b32 v22, a84
    v_accvgpr_read_b32 v23, a85
    v_accvgpr_read_b32 v24, a86
    v_accvgpr_read_b32 v25, a87
    v_accvgpr_read_b32 v26, a88
    v_accvgpr_read_b32 v27, a89
    v_accvgpr_read_b32 v28, a90
    v_accvgpr_read_b32 v29, a91
    v_accvgpr_read_b32 v30, a92
    v_accvgpr_read_b32 v31, a93
    v_accvgpr_read_b32 v32, a94
    v_accvgpr_read_b32 v33, a95
    s_waitcnt lgkmcnt(0)
    v_pk_add_f32 v[10:11], v[10:11], v[40:41]
    v_pk_add_f32 v[12:13], v[12:13], v[42:43]
    v_add_u32 v6, 73984, v4
    global_store_dwordx4 v6, v[10:13], s[36:37]
    v_pk_add_f32 v[14:15], v[14:15], v[44:45]
    v_pk_add_f32 v[16:17], v[16:17], v[46:47]
    v_add_u32 v6, 110848, v4
    global_store_dwordx4 v6, v[14:17], s[36:37]
    v_pk_add_f32 v[18:19], v[18:19], v[48:49]
    v_pk_add_f32 v[20:21], v[20:21], v[50:51]
    v_add_u32 v6, 272, v4
    global_store_dwordx4 v6, v[18:21], s[36:37]
    v_pk_add_f32 v[22:23], v[22:23], v[52:53]
    v_pk_add_f32 v[24:25], v[24:25], v[54:55]
    v_add_u32 v6, 37136, v4
    global_store_dwordx4 v6, v[22:25], s[36:37]
    v_pk_add_f32 v[26:27], v[26:27], v[56:57]
    v_pk_add_f32 v[28:29], v[28:29], v[58:59]
    v_add_u32 v6, 74000, v4
    global_store_dwordx4 v6, v[26:29], s[36:37]
    v_pk_add_f32 v[30:31], v[30:31], v[60:61]
    v_pk_add_f32 v[32:33], v[32:33], v[62:63]
    v_add_u32 v6, 110864, v4
    global_store_dwordx4 v6, v[30:33], s[36:37]
    s_nop 1
    ds_read_b128 v[40:43], v2 offset:24576
    ds_read_b128 v[44:47], v2 offset:25600
    ds_read_b128 v[48:51], v2 offset:26624
    ds_read_b128 v[52:55], v2 offset:27648
    ds_read_b128 v[56:59], v2 offset:28672
    ds_read_b128 v[60:63], v2 offset:29696
    v_accvgpr_read_b32 v10, a96
    v_accvgpr_read_b32 v11, a97
    v_accvgpr_read_b32 v12, a98
    v_accvgpr_read_b32 v13, a99
    v_accvgpr_read_b32 v14, a100
    v_accvgpr_read_b32 v15, a101
    v_accvgpr_read_b32 v16, a102
    v_accvgpr_read_b32 v17, a103
    v_accvgpr_read_b32 v18, a104
    v_accvgpr_read_b32 v19, a105
    v_accvgpr_read_b32 v20, a106
    v_accvgpr_read_b32 v21, a107
    v_accvgpr_read_b32 v22, a108
    v_accvgpr_read_b32 v23, a109
    v_accvgpr_read_b32 v24, a110
    v_accvgpr_read_b32 v25, a111
    v_accvgpr_read_b32 v26, a112
    v_accvgpr_read_b32 v27, a113
    v_accvgpr_read_b32 v28, a114
    v_accvgpr_read_b32 v29, a115
    v_accvgpr_read_b32 v30, a116
    v_accvgpr_read_b32 v31, a117
    v_accvgpr_read_b32 v32, a118
    v_accvgpr_read_b32 v33, a119
    s_waitcnt lgkmcnt(0)
    v_pk_add_f32 v[10:11], v[10:11], v[40:41]
    v_pk_add_f32 v[12:13], v[12:13], v[42:43]
    v_add_u32 v6, 384, v4
    global_store_dwordx4 v6, v[10:13], s[36:37]
    v_pk_add_f32 v[14:15], v[14:15], v[44:45]
    v_pk_add_f32 v[16:17], v[16:17], v[46:47]
    v_add_u32 v6, 37248, v4
    global_store_dwordx4 v6, v[14:17], s[36:37]
    v_pk_add_f32 v[18:19], v[18:19], v[48:49]
    v_pk_add_f32 v[20:21], v[20:21], v[50:51]
    v_add_u32 v6, 74112, v4
    global_store_dwordx4 v6, v[18:21], s[36:37]
    v_pk_add_f32 v[22:23], v[22:23], v[52:53]
    v_pk_add_f32 v[24:25], v[24:25], v[54:55]
    v_add_u32 v6, 110976, v4
    global_store_dwordx4 v6, v[22:25], s[36:37]
    v_pk_add_f32 v[26:27], v[26:27], v[56:57]
    v_pk_add_f32 v[28:29], v[28:29], v[58:59]
    v_add_u32 v6, 400, v4
    global_store_dwordx4 v6, v[26:29], s[36:37]
    v_pk_add_f32 v[30:31], v[30:31], v[60:61]
    v_pk_add_f32 v[32:33], v[32:33], v[62:63]
    v_add_u32 v6, 37264, v4
    global_store_dwordx4 v6, v[30:33], s[36:37]
    s_nop 1
    ds_read_b128 v[40:43], v2 offset:30720
    ds_read_b128 v[44:47], v2 offset:31744
    ds_read_b128 v[48:51], v2 offset:32768
    ds_read_b128 v[52:55], v2 offset:33792
    ds_read_b128 v[56:59], v2 offset:34816
    ds_read_b128 v[60:63], v2 offset:35840
    v_accvgpr_read_b32 v10, a120
    v_accvgpr_read_b32 v11, a121
    v_accvgpr_read_b32 v12, a122
    v_accvgpr_read_b32 v13, a123
    v_accvgpr_read_b32 v14, a124
    v_accvgpr_read_b32 v15, a125
    v_accvgpr_read_b32 v16, a126
    v_accvgpr_read_b32 v17, a127
    v_accvgpr_read_b32 v18, a128
    v_accvgpr_read_b32 v19, a129
    v_accvgpr_read_b32 v20, a130
    v_accvgpr_read_b32 v21, a131
    v_accvgpr_read_b32 v22, a132
    v_accvgpr_read_b32 v23, a133
    v_accvgpr_read_b32 v24, a134
    v_accvgpr_read_b32 v25, a135
    v_accvgpr_read_b32 v26, a136
    v_accvgpr_read_b32 v27, a137
    v_accvgpr_read_b32 v28, a138
    v_accvgpr_read_b32 v29, a139
    v_accvgpr_read_b32 v30, a140
    v_accvgpr_read_b32 v31, a141
    v_accvgpr_read_b32 v32, a142
    v_accvgpr_read_b32 v33, a143
    s_waitcnt lgkmcnt(0)
    v_pk_add_f32 v[10:11], v[10:11], v[40:41]
    v_pk_add_f32 v[12:13], v[12:13], v[42:43]
    v_add_u32 v6, 74128, v4
    global_store_dwordx4 v6, v[10:13], s[36:37]
    v_pk_add_f32 v[14:15], v[14:15], v[44:45]
    v_pk_add_f32 v[16:17], v[16:17], v[46:47]
    v_add_u32 v6, 110992, v4
    global_store_dwordx4 v6, v[14:17], s[36:37]
    v_pk_add_f32 v[18:19], v[18:19], v[48:49]
    v_pk_add_f32 v[20:21], v[20:21], v[50:51]
    v_add_u32 v6, 512, v5
    global_store_dwordx4 v6, v[18:21], s[36:37]
    v_pk_add_f32 v[22:23], v[22:23], v[52:53]
    v_pk_add_f32 v[24:25], v[24:25], v[54:55]
    v_add_u32 v6, 37376, v5
    global_store_dwordx4 v6, v[22:25], s[36:37]
    v_pk_add_f32 v[26:27], v[26:27], v[56:57]
    v_pk_add_f32 v[28:29], v[28:29], v[58:59]
    v_add_u32 v6, 74240, v5
    global_store_dwordx4 v6, v[26:29], s[36:37]
    v_pk_add_f32 v[30:31], v[30:31], v[60:61]
    v_pk_add_f32 v[32:33], v[32:33], v[62:63]
    v_add_u32 v6, 111104, v5
    global_store_dwordx4 v6, v[30:33], s[36:37]
    s_nop 1
    s_waitcnt vmcnt(0)
Lg2_end:
    s_endpgm
.globl k7_final_kernel
.p2align 8
.type k7_final_kernel,@function
k7_final_kernel:
    s_cmp_ge_u32 s2, 576
    s_cbranch_scc1 Lk7_end
    s_load_dwordx2 s[4:5], s[0:1], 64
    s_load_dwordx2 s[6:7], s[0:1], 80
    s_lshl_b32 s3, s2, 8
    v_add_u32 v1, s3, v0
    v_lshlrev_b32 v2, 5, v1
    v_lshlrev_b32 v3, 4, v1
    s_waitcnt lgkmcnt(0)
    s_add_u32 s8, s6, 41943040
    s_addc_u32 s9, s7, 0
    global_load_dwordx4 v[10:13], v2, s[8:9]
    global_load_dwordx4 v[14:17], v2, s[8:9] offset:16
    s_add_u32 s8, s8, 4718592
    s_addc_u32 s9, s9, 0
    global_load_dwordx4 v[18:21], v2, s[8:9]
    global_load_dwordx4 v[22:25], v2, s[8:9] offset:16
    s_add_u32 s8, s8, 4718592
    s_addc_u32 s9, s9, 0
    global_load_dwordx4 v[26:29], v2, s[8:9]
    global_load_dwordx4 v[30:33], v2, s[8:9] offset:16
    s_add_u32 s8, s8, 4718592
    s_addc_u32 s9, s9, 0
    global_load_dwordx4 v[34:37], v2, s[8:9]
    global_load_dwordx4 v[38:41], v2, s[8:9] offset:16
    s_add_u32 s8, s8, 4718592
    s_addc_u32 s9, s9, 0
    s_add_u32 s10, s6, 14680064
    s_addc_u32 s11, s7, 0
    global_load_dwordx4 v[44:47], v3, s[10:11]
    v_mul_u32_u24 v4, 910, v1
    v_lshrrev_b32 v4, 16, v4
    v_mul_u32_u24 v5, 72, v4
    v_sub_u32 v5, v1, v5
    v_cmp_le_u32 vcc, 72, v5
    v_subrev_u32 v6, 72, v5
    s_nop 0
    v_cndmask_b32 v5, v5, v6, vcc
    v_lshlrev_b32 v5, 5, v5
    s_add_u32 s12, s6, 11520
    s_addc_u32 s13, s7, 0
    global_load_dwordx4 v[48:51], v5, s[12:13]
    global_load_dwordx4 v[52:55], v5, s[12:13] offset:16
    s_waitcnt vmcnt(0)
    v_add_f32 v10, v10, v18
    v_add_f32 v26, v26, v34
    v_add_f32 v10, v10, v26
    v_add_f32 v11, v11, v19
    v_add_f32 v27, v27, v35
    v_add_f32 v11, v11, v27
    v_add_f32 v12, v12, v20
    v_add_f32 v28, v28, v36
    v_add_f32 v12, v12, v28
    v_add_f32 v13, v13, v21
    v_add_f32 v29, v29, v37
    v_add_f32 v13, v13, v29
    v_add_f32 v14, v14, v22
    v_add_f32 v30, v30, v38
    v_add_f32 v14, v14, v30
    v_add_f32 v15, v15, v23
    v_add_f32 v31, v31, v39
    v_add_f32 v15, v15, v31
    v_add_f32 v16, v16, v24
    v_add_f32 v32, v32, v40
    v_add_f32 v16, v16, v32
    v_add_f32 v17, v17, v25
    v_add_f32 v33, v33, v41
    v_add_f32 v17, v17, v33
    v_cvt_pk_bf16_f32 v60, v10, v11
    v_lshlrev_b32 v10, 16, v60
    v_and_b32 v11, 0xffff0000, v60
    v_cvt_pk_bf16_f32 v60, v12, v13
    v_lshlrev_b32 v12, 16, v60
    v_and_b32 v13, 0xffff0000, v60
    v_cvt_pk_bf16_f32 v60, v14, v15
    v_lshlrev_b32 v14, 16, v60
    v_and_b32 v15, 0xffff0000, v60
    v_cvt_pk_bf16_f32 v60, v16, v17
    v_lshlrev_b32 v16, 16, v60
    v_and_b32 v17, 0xffff0000, v60
    v_mul_f32 v10, v10, v48
    v_mul_f32 v11, v11, v49
    v_mul_f32 v12, v12, v50
    v_mul_f32 v13, v13, v51
    v_mul_f32 v14, v14, v52
    v_mul_f32 v15, v15, v53
    v_mul_f32 v16, v16, v54
    v_mul_f32 v17, v17, v55
    v_cvt_pk_bf16_f32 v60, v10, v11
    v_lshlrev_b32 v10, 16, v60
    v_and_b32 v11, 0xffff0000, v60
    v_cvt_pk_bf16_f32 v60, v12, v13
    v_lshlrev_b32 v12, 16, v60
    v_and_b32 v13, 0xffff0000, v60
    v_cvt_pk_bf16_f32 v60, v14, v15
    v_lshlrev_b32 v14, 16, v60
    v_and_b32 v15, 0xffff0000, v60
    v_cvt_pk_bf16_f32 v60, v16, v17
    v_lshlrev_b32 v16, 16, v60
    v_and_b32 v17, 0xffff0000, v60
    v_lshlrev_b32 v61, 16, v44
    v_and_b32 v62, 0xffff0000, v44
    v_add_f32 v10, v10, v61
    v_add_f32 v11, v11, v62
    v_cvt_pk_bf16_f32 v20, v10, v11
    v_lshlrev_b32 v61, 16, v45
    v_and_b32 v62, 0xffff0000, v45
    v_add_f32 v12, v12, v61
    v_add_f32 v13, v13, v62
    v_cvt_pk_bf16_f32 v21, v12, v13
    v_lshlrev_b32 v61, 16, v46
    v_and_b32 v62, 0xffff0000, v46
    v_add_f32 v14, v14, v61
    v_add_f32 v15, v15, v62
    v_cvt_pk_bf16_f32 v22, v14, v15
    v_lshlrev_b32 v61, 16, v47
    v_and_b32 v62, 0xffff0000, v47
    v_add_f32 v16, v16, v61
    v_add_f32 v17, v17, v62
    v_cvt_pk_bf16_f32 v23, v16, v17
    global_store_dwordx4 v3, v[20:23], s[4:5]
    s_waitcnt vmcnt(0)
Lk7_end:
    s_endpgm
.section .rodata,"a"
.p2align 6
.amdhsa_kernel k1_prep_kernel
  .amdhsa_next_free_vgpr 72
  .amdhsa_next_free_sgpr 96
  .amdhsa_accum_offset 72
  .amdhsa_group_segment_fixed_size 0
  .amdhsa_kernarg_size 88
  .amdhsa_user_sgpr_count 2
  .amdhsa_user_sgpr_kernarg_segment_ptr 1
  .amdhsa_system_sgpr_workgroup_id_x 1
  .amdhsa_float_denorm_mode_32 3
  .amdhsa_float_denorm_mode_16_64 3
.end_amdhsa_kernel
.p2align 6
.amdhsa_kernel k2_rowfft_kernel
  .amdhsa_next_free_vgpr 128
  .amdhsa_next_free_sgpr 96
  .amdhsa_accum_offset 128
  .amdhsa_group_segment_fixed_size 0
  .amdhsa_kernarg_size 88
  .amdhsa_user_sgpr_count 2
  .amdhsa_user_sgpr_kernarg_segment_ptr 1
  .amdhsa_system_sgpr_workgroup_id_x 1
  .amdhsa_float_denorm_mode_32 3
  .amdhsa_float_denorm_mode_16_64 3
.end_amdhsa_kernel
.p2align 6
.amdhsa_kernel k3_colfft_kernel
  .amdhsa_next_free_vgpr 128
  .amdhsa_next_free_sgpr 96
  .amdhsa_accum_offset 128
  .amdhsa_group_segment_fixed_size 0
  .amdhsa_kernarg_size 88
  .amdhsa_user_sgpr_count 2
  .amdhsa_user_sgpr_kernarg_segment_ptr 1
  .amdhsa_system_sgpr_workgroup_id_x 1
  .amdhsa_float_denorm_mode_32 3
  .amdhsa_float_denorm_mode_16_64 3
.end_amdhsa_kernel
.p2align 6
.amdhsa_kernel k4_rowifft_kernel
  .amdhsa_next_free_vgpr 140
  .amdhsa_next_free_sgpr 96
  .amdhsa_accum_offset 140
  .amdhsa_group_segment_fixed_size 0
  .amdhsa_kernarg_size 88
  .amdhsa_user_sgpr_count 2
  .amdhsa_user_sgpr_kernarg_segment_ptr 1
  .amdhsa_system_sgpr_workgroup_id_x 1
  .amdhsa_float_denorm_mode_32 3
  .amdhsa_float_denorm_mode_16_64 3
.end_amdhsa_kernel
.p2align 6
.amdhsa_kernel k5_gemm1_kernel
  .amdhsa_next_free_vgpr 284
  .amdhsa_next_free_sgpr 96
  .amdhsa_accum_offset 140
  .amdhsa_group_segment_fixed_size 0
  .amdhsa_kernarg_size 88
  .amdhsa_user_sgpr_count 2
  .amdhsa_user_sgpr_kernarg_segment_ptr 1
  .amdhsa_system_sgpr_workgroup_id_x 1
  .amdhsa_float_denorm_mode_32 3
  .amdhsa_float_denorm_mode_16_64 3
.end_amdhsa_kernel
.p2align 6
.amdhsa_kernel k6_gemm2_kernel
  .amdhsa_next_free_vgpr 284
  .amdhsa_next_free_sgpr 96
  .amdhsa_accum_offset 140
  .amdhsa_group_segment_fixed_size 0
  .amdhsa_kernarg_size 88
  .amdhsa_user_sgpr_count 2
  .amdhsa_user_sgpr_kernarg_segment_ptr 1
  .amdhsa_system_sgpr_workgroup_id_x 1
  .amdhsa_float_denorm_mode_32 3
  .amdhsa_float_denorm_mode_16_64 3
.end_amdhsa_kernel
.p2align 6
.amdhsa_kernel k7_final_kernel
  .amdhsa_next_free_vgpr 64
  .amdhsa_next_free_sgpr 96
  .amdhsa_accum_offset 64
  .amdhsa_group_segment_fixed_size 0
  .amdhsa_kernarg_size 88
  .amdhsa_user_sgpr_count 2
  .amdhsa_user_sgpr_kernarg_segment_ptr 1
  .amdhsa_system_sgpr_workgroup_id_x 1
  .amdhsa_float_denorm_mode_32 3
  .amdhsa_float_denorm_mode_16_64 3
.end_amdhsa_kernel
```
